```python
import torch

def _softmax(x, axis=-1):
    return torch.softmax(x, dim=axis)
def _gelu(x):
    return torch.nn.functional.gelu(x, approximate="tanh")
def _silu(x):
    return torch.nn.functional.silu(x)
def _sigmoid(x):
    return torch.sigmoid(x)
def _layernorm(x, axis=-1, eps=1e-5):
    m = x.mean(dim=axis, keepdim=True)
    v = x.var(dim=axis, keepdim=True, unbiased=False)
    return (x - m) / torch.sqrt(v + eps)
def _scatter_add(tgt, idx, src, axis=0):
    return tgt.clone().index_add_(axis, idx, src)
def _segment_sum(src, seg, n):
    out = torch.zeros((n,) + src.shape[1:], dtype=src.dtype)
    return out.index_add_(0, seg, src)
def _pad(x, pw):
    flat = tuple(v for pair in reversed(pw) for v in pair)
    return torch.nn.functional.pad(x, flat)

kernel_name = 'parallel_sum__spectral_gfnet__dense_activation_mish__prompt'

def setup_inputs():

    _w = (lambda a: (lambda t: t.to(torch.bfloat16) if t.is_floating_point() else t)(torch.as_tensor(a)))
    def _A_setup():
        B, S, D = 1, 2048, 1024
        Df = D // 2 + 1
        return {
            "x": _w((lambda *s: torch.randn(*s, dtype=torch.bfloat16) * 0.05)(B, S, D)),
            "w_r": _w((lambda *s: torch.randn(*s, dtype=torch.bfloat16) * 0.8)(S, Df) * 0.02),
            "w_i": _w((lambda *s: torch.randn(*s, dtype=torch.bfloat16) * 0.8)(S, Df) * 0.02),
        }
    _A_in = _A_setup()

    def _B_setup():
        B, S, D, F = 1, 2048, 1024, 3584
        return {
            "x": _w((lambda *s: torch.randn(*s, dtype=torch.bfloat16) * 0.05)(B, S, D)),
            "w1": _w((lambda *s: torch.randn(*s, dtype=torch.bfloat16) * 0.8)(D, F) * (D ** -0.5)),
            "b1": _w((lambda *s: torch.randn(*s, dtype=torch.bfloat16) * 0.2)(F)),
            "w2": _w((lambda *s: torch.randn(*s, dtype=torch.bfloat16) * 0.1)(F, D) * (F ** -0.5)),
        }
    _B_in = _B_setup()

    return {
        "A_x": _A_in["x"],
        "A_w_r": _A_in["w_r"],
        "A_w_i": _A_in["w_i"],
        "B_x": _B_in["x"],
        "B_w1": _B_in["w1"],
        "B_b1": _B_in["b1"],
        "B_w2": _B_in["w2"],
    }

def reference(A_x, A_w_r, A_w_i, B_x, B_w1, B_b1, B_w2):
    def _A_ref(x, w_r, w_i):
        B, S, D = x.shape
        X = (lambda x, axes=(-2,-1): torch.fft.rfft2(x.float(), dim=axes))(x, axes=(-2, -1))
        W = w_r + 1j * w_i
        X = X * W
        y = (lambda x, s, axes=(-2,-1): torch.fft.irfft2(x, s=s, dim=axes).to(torch.bfloat16))(X, (S, D), axes=(-2, -1))
        return y

    def _B_ref(x, w1, b1, w2):
        h = torch.einsum("bsd,df->bsf", x, w1) + b1
        sp = torch.log1p(torch.exp(-torch.abs(h))) + torch.where(h > 0, h, torch.zeros_like(h))
        act = h * torch.tanh(sp)
        return torch.einsum("bsf,fd->bsd", act, w2)

    x = A_x
    xn = _layernorm(x, axis=-1)
    return x + _A_ref(xn, A_w_r, A_w_i) + _B_ref(xn, B_w1, B_b1, B_w2)
```

```asm
; @launch grid=(256,1,1) block=(512,1,1) lds=163840
.amdgcn_target "amdgcn-amd-amdhsa--gfx950"
.text
.p2align 8
.globl parallel_sum__spectral_gfnet__dense_activation_mish__prompt_kernel
.type parallel_sum__spectral_gfnet__dense_activation_mish__prompt_kernel,@function
parallel_sum__spectral_gfnet__dense_activation_mish__prompt_kernel:
    s_cmp_lt_u32 s2, 256
    s_cbranch_scc1 L_ka_g1
    s_endpgm
L_ka_g1:
    v_cmp_le_u32 vcc, 448, v0
    s_nop 4
    s_cbranch_vccz L_ka_nt
    s_getpc_b64 s[76:77]
L_pc_1:
    s_lshr_b32 s78, s2, 3
    s_and_b32 s78, s78, 3
    s_lshl_b32 s78, s78, 13
    s_sub_u32 s76, s76, L_pc_1-parallel_sum__spectral_gfnet__dense_activation_mish__prompt_kernel
    s_subb_u32 s77, s77, 0
    v_and_b32 v250, 63, v0
    v_lshl_add_u32 v250, v250, 7, s78
    v_min_u32 v250, L_code_end-parallel_sum__spectral_gfnet__dense_activation_mish__prompt_kernel-4, v250
    v_mov_b32 v251, s77
    v_add_co_u32 v250, vcc, s76, v250
    s_nop 1
    v_addc_co_u32 v251, vcc, 0, v251, vcc
    global_load_dword v252, v[250:251], off
L_ka_nt:
    s_load_dwordx2 s[24:25], s[0:1], 0
    s_load_dwordx4 s[20:23], s[0:1], 32
    s_load_dwordx2 s[10:11], s[0:1], 72
    s_load_dwordx4 s[68:71], s[0:1], 48
    s_load_dwordx4 s[4:7], s[0:1], 8
    v_lshrrev_b32 v1, 6, v0
    v_and_b32 v2, 63, v0
    v_readfirstlane_b32 s16, v1
    s_mov_b32 s50, 4294868992
    s_mov_b32 s51, 49152
    s_mov_b32 s48, 0
    s_and_b32 s18, s16, 1
    s_bfe_u32 s19, s16, 0x10001
    v_lshlrev_b32 v5, 2, v1
    v_add_u32 v5, 163776, v5
    v_mov_b32 v6, 0
    ds_write_b32 v5, v6
    s_waitcnt lgkmcnt(0)
    s_barrier
    s_and_b32 s12, s2, 7
    s_lshr_b32 s13, s2, 3
    s_sub_u32 s13, s13, 4
    s_lshr_b32 s15, s13, 2
    s_and_b32 s14, s12, 1
    s_mul_i32 s14, s14, 7
    s_add_u32 s15, s15, s14
    s_and_b32 s14, s13, 3
    s_and_b32 s12, s12, 6
    s_lshl_b32 s12, s12, 1
    s_add_u32 s14, s14, s12
    s_mul_i32 s17, s15, 52
    s_lshr_b32 s17, s17, 8
    s_mul_i32 s13, s17, 5
    s_sub_u32 s13, s15, s13
    s_mov_b32 s26, 4194304
    s_mov_b32 s27, 0x20000
    s_cmp_lt_u32 s16, 4
    s_cbranch_scc1 L_g1_c
    s_cmp_lt_u32 s2, 32
    s_cbranch_scc1 L_fa_hi
    s_cmp_ge_u32 s16, 6
    s_cbranch_scc1 L_g1_aux
    s_sub_u32 s54, s2, 32
    s_lshl_b32 s54, s54, 1
    s_add_u32 s54, s54, s18
    s_mul_i32 s55, s54, 8192
    s_lshl_b32 s54, s54, 13
    v_lshlrev_b32 v12, 7, v2
    v_lshrrev_b32 v5, 5, v2
    s_lshl_b32 s36, s18, 1
    v_add_u32 v5, s36, v5
    v_bfe_u32 v7, v2, 1, 4
    v_xor_b32 v7, v7, v5
    v_lshlrev_b32 v7, 5, v7
    v_and_b32 v8, 1, v2
    v_lshl_add_u32 v7, v8, 4, v7
    v_mul_u32_u24 v5, 7168, v5
    v_add_u32 v3, v5, v7
    v_xor_b32 v7, 128, v7
    v_add_u32 v9, v5, v7
    s_lshl_b32 s40, s18, 10
    s_add_u32 s41, s40, 32768
    v_lshrrev_b32 v5, 3, v2
    v_lshrrev_b32 v6, 1, v5
    s_lshl_b32 s36, s18, 2
    v_or_b32 v6, s36, v6
    v_and_b32 v7, 7, v2
    v_xor_b32 v7, v7, v6
    v_lshlrev_b32 v7, 4, v7
    v_lshl_add_u32 v4, v5, 11, v7
    s_lshl_b32 s42, s15, 9
    s_lshl_b32 s43, s14, 7
    s_lshl_b32 s37, s18, 3
    s_add_u32 s43, s43, s37
    s_lshl_b32 s43, s43, 11
    s_waitcnt lgkmcnt(0)
    s_mov_b32 s22, 7340032
    s_mov_b32 s23, 0x20000
    s_add_u32 s72, s10, 15040512
    s_addc_u32 s73, s11, 0
    s_load_dword s74, s[72:73], 0
    s_mov_b32 s28, s10
    s_mov_b32 s29, s11
    s_mov_b32 s30, 268435456
    s_mov_b32 s31, 0x20000
    s_and_b32 s60, s14, 12
    s_mov_b32 s62, s42
    s_mov_b32 s63, s43
    s_mul_i32 s42, s60, 458752
    s_add_u32 s42, s42, s62
    s_lshl_b32 s43, s60, 7
    s_add_u32 s43, s43, s63
    s_mov_b32 s47, 0
.p2alignl 6, 0xbf800000
L_g1_ld:
    s_add_u32 m0, s40, 0
    s_add_u32 s46, s42, 0
    buffer_load_dwordx4 v3, s[20:23], s46 offen lds
    s_add_u32 m0, s40, 2048
    s_add_u32 s46, s42, 28672
    buffer_load_dwordx4 v3, s[20:23], s46 offen lds
    s_add_u32 m0, s40, 4096
    s_add_u32 s46, s42, 57344
    buffer_load_dwordx4 v9, s[20:23], s46 offen lds
    s_add_u32 m0, s40, 6144
    s_add_u32 s46, s42, 86016
    buffer_load_dwordx4 v9, s[20:23], s46 offen lds
    s_add_u32 m0, s40, 8192
    s_add_u32 s46, s42, 114688
    buffer_load_dwordx4 v3, s[20:23], s46 offen lds
    s_add_u32 m0, s40, 10240
    s_add_u32 s46, s42, 143360
    buffer_load_dwordx4 v3, s[20:23], s46 offen lds
    s_add_u32 m0, s40, 12288
    s_add_u32 s46, s42, 172032
    buffer_load_dwordx4 v9, s[20:23], s46 offen lds
    s_add_u32 m0, s40, 14336
    s_add_u32 s46, s42, 200704
    buffer_load_dwordx4 v9, s[20:23], s46 offen lds
    s_add_u32 m0, s40, 16384
    s_add_u32 s46, s42, 229376
    buffer_load_dwordx4 v3, s[20:23], s46 offen lds
    s_add_u32 m0, s40, 18432
    s_add_u32 s46, s42, 258048
    buffer_load_dwordx4 v3, s[20:23], s46 offen lds
    s_add_u32 m0, s40, 20480
    s_add_u32 s46, s42, 286720
    buffer_load_dwordx4 v9, s[20:23], s46 offen lds
    s_add_u32 m0, s40, 22528
    s_add_u32 s46, s42, 315392
    buffer_load_dwordx4 v9, s[20:23], s46 offen lds
    s_add_u32 m0, s40, 24576
    s_add_u32 s46, s42, 344064
    buffer_load_dwordx4 v3, s[20:23], s46 offen lds
    s_add_u32 m0, s40, 26624
    s_add_u32 s46, s42, 372736
    buffer_load_dwordx4 v3, s[20:23], s46 offen lds
    s_add_u32 m0, s40, 28672
    s_add_u32 s46, s42, 401408
    buffer_load_dwordx4 v9, s[20:23], s46 offen lds
    s_add_u32 m0, s40, 30720
    s_add_u32 s46, s42, 430080
    buffer_load_dwordx4 v9, s[20:23], s46 offen lds
    s_add_u32 m0, s41, 0
    s_add_u32 s46, s43, 0
    buffer_load_dwordx4 v4, s[24:27], s46 offen lds
    s_add_u32 m0, s41, 2048
    s_add_u32 s46, s43, 32768
    buffer_load_dwordx4 v4, s[24:27], s46 offen lds
    s_add_u32 m0, s41, 4096
    s_add_u32 s46, s43, 65536
    buffer_load_dwordx4 v4, s[24:27], s46 offen lds
    s_add_u32 m0, s41, 6144
    s_add_u32 s46, s43, 98304
    buffer_load_dwordx4 v4, s[24:27], s46 offen lds
    s_add_u32 m0, s41, 8192
    s_add_u32 s46, s43, 131072
    buffer_load_dwordx4 v4, s[24:27], s46 offen lds
    s_add_u32 m0, s41, 10240
    s_add_u32 s46, s43, 163840
    buffer_load_dwordx4 v4, s[24:27], s46 offen lds
    s_add_u32 m0, s41, 12288
    s_add_u32 s46, s43, 196608
    buffer_load_dwordx4 v4, s[24:27], s46 offen lds
    s_add_u32 m0, s41, 14336
    s_add_u32 s46, s43, 229376
    buffer_load_dwordx4 v4, s[24:27], s46 offen lds
    s_add_u32 s60, s60, 1
    s_and_b32 s60, s60, 15
    s_mul_i32 s42, s60, 458752
    s_add_u32 s42, s42, s62
    s_lshl_b32 s43, s60, 7
    s_add_u32 s43, s43, s63
    s_add_u32 s48, s48, 1
    s_cmp_eq_u32 s48, 3
    s_cselect_b32 s45, s50, s51
    s_cselect_b32 s48, 0, s48
    s_add_u32 s40, s40, s45
    s_add_u32 s41, s41, s45
    s_add_u32 s47, s47, 1
    s_cmp_lg_u32 s47, 1
    s_cbranch_scc1 L_g1_h0
    s_waitcnt lgkmcnt(0)
    s_add_u32 s74, s74, 1
L_g1_h0:
    s_cmp_lg_u32 s47, 16
    s_cbranch_scc1 L_g1_h2
    s_lshl_b32 s54, s54, 1
    s_add_u32 s55, s54, 8192
    s_mov_b32 s70, 7340032
    s_mov_b32 s71, 0x20000
    buffer_load_dword v15, v12, s[68:71], s54 offen
    buffer_load_dword v15, v12, s[68:71], s55 offen
    s_getpc_b64 s[76:77]
L_pc_2:
    s_lshr_b32 s78, s2, 3
    s_and_b32 s78, s78, 7
    s_lshl_b32 s78, s78, 13
    s_add_u32 s76, s76, L_phaseB-L_pc_2
    s_addc_u32 s77, s77, 0
    v_and_b32 v250, 63, v0
    v_lshl_add_u32 v250, v250, 7, s78
    v_min_u32 v250, L_code_end-L_phaseB-4, v250
    v_mov_b32 v251, s77
    v_add_co_u32 v250, vcc, s76, v250
    s_nop 1
    v_addc_co_u32 v251, vcc, 0, v251, vcc
    global_load_dword v252, v[250:251], off
    s_branch L_g2_dma
L_g1_h2:
    s_cmp_lt_u32 s47, 2
    s_cbranch_scc1 L_g1_ld
    s_waitcnt vmcnt(24)
    s_barrier
    s_branch L_g1_ld
L_g1_aux:
    s_waitcnt lgkmcnt(0)
    s_add_u32 s72, s10, 15040512
    s_addc_u32 s73, s11, 0
    s_load_dword s74, s[72:73], 0
    s_mov_b32 s28, s10
    s_mov_b32 s29, s11
    s_mov_b32 s30, 268435456
    s_mov_b32 s31, 0x20000
    v_lshlrev_b32 v11, 4, v2
    s_cmp_eq_u32 s18, 0
    s_cbranch_scc1 L_g1_a6
    s_mov_b32 s40, s22
    s_mov_b32 s41, s23
    s_mov_b32 s42, 7168
    s_mov_b32 s43, 0x20000
    v_lshlrev_b32 v4, 3, v2
    s_lshl_b32 s36, s15, 9
    buffer_load_dwordx2 v[96:97], v4, s[40:43], s36 offen
    s_bfe_u32 s37, s2, 0x30004
    v_and_b32 v5, 7, v2
    v_lshrrev_b32 v6, 3, v2
    v_lshlrev_b32 v9, 15, v6
    v_lshl_add_u32 v9, v5, 4, v9
    v_xor_b32 v5, s37, v5
    v_and_b32 v7, 1, v5
    v_lshlrev_b32 v7, 4, v7
    v_and_b32 v5, 6, v5
    v_add_u32 v7, v7, v5
    v_bfe_u32 v5, v2, 4, 1
    v_lshl_add_u32 v7, v5, 3, v7
    v_and_b32 v5, 1, v6
    v_add_u32 v7, v7, v5
    v_mul_u32_u24 v7, 144, v7
    v_lshrrev_b32 v5, 5, v2
    v_lshl_add_u32 v7, v5, 2, v7
    v_add_u32 v7, 98304, v7
    v_lshlrev_b32 v3, 4, v2
    v_add_u32 v6, 116736, v3
    s_lshl_b32 s46, s2, 7
    v_lshrrev_b32 v5, 2, v2
    v_lshlrev_b32 v5, 11, v5
    v_and_b32 v8, 1, v2
    v_lshl_add_u32 v5, v8, 10, v5
    v_bfe_u32 v8, v2, 1, 1
    v_lshl_add_u32 v5, v8, 7, v5
    s_lshr_b32 s37, s14, 3
    s_lshl_b32 s37, s37, 9
    s_bfe_u32 s36, s14, 0x10001
    s_lshl_b32 s36, s36, 8
    s_add_u32 s37, s37, s36
    s_bfe_u32 s36, s14, 0x10002
    s_lshl_b32 s36, s36, 6
    s_add_u32 s37, s37, s36
    s_and_b32 s36, s14, 1
    s_lshl_b32 s36, s36, 5
    s_add_u32 s37, s37, s36
    s_add_u32 s37, s37, 14680064
    s_add_u32 s58, s46, 15106048
    s_mov_b32 s59, 0x3fb8aa3b
    s_waitcnt lgkmcnt(0)
    s_add_u32 s74, s74, 1
    v_and_b32 v8, 3, v2
    v_lshlrev_b32 v8, 2, v8
    v_add_u32 v8, 163776, v8
    s_mov_b32 s83, 0x400000
L_g1_sp:
    s_sleep 1
    ds_read_b32 v10, v8
    s_sub_u32 s83, s83, 1
    s_cmp_eq_u32 s83, 0
    s_cbranch_scc1 L_g1_spx
    s_waitcnt lgkmcnt(0)
    v_cmp_ne_u32 vcc, 1, v10
    s_nop 4
    s_cbranch_vccnz L_g1_sp
L_g1_spx:
    s_setprio 3
    ds_read2st64_b32 v[16:17], v7 offset0:0 offset1:18
    ds_read2st64_b32 v[18:19], v7 offset0:36 offset1:54
    v_add_u32 v7, 8, v7
    ds_read2st64_b32 v[20:21], v7 offset0:0 offset1:18
    ds_read2st64_b32 v[22:23], v7 offset0:36 offset1:54
    v_add_u32 v7, 8, v7
    ds_read2st64_b32 v[24:25], v7 offset0:0 offset1:18
    ds_read2st64_b32 v[26:27], v7 offset0:36 offset1:54
    v_add_u32 v7, 8, v7
    ds_read2st64_b32 v[28:29], v7 offset0:0 offset1:18
    ds_read2st64_b32 v[30:31], v7 offset0:36 offset1:54
    v_add_u32 v7, 8, v7
    ds_read2st64_b32 v[32:33], v7 offset0:0 offset1:18
    ds_read2st64_b32 v[34:35], v7 offset0:36 offset1:54
    v_add_u32 v7, 8, v7
    ds_read2st64_b32 v[36:37], v7 offset0:0 offset1:18
    ds_read2st64_b32 v[38:39], v7 offset0:36 offset1:54
    v_add_u32 v7, 8, v7
    ds_read2st64_b32 v[40:41], v7 offset0:0 offset1:18
    ds_read2st64_b32 v[42:43], v7 offset0:36 offset1:54
    v_add_u32 v7, 8, v7
    ds_read2st64_b32 v[44:45], v7 offset0:0 offset1:18
    ds_read2st64_b32 v[46:47], v7 offset0:36 offset1:54
    v_add_u32 v7, 8, v7
    ds_read2st64_b32 v[48:49], v7 offset0:0 offset1:18
    ds_read2st64_b32 v[50:51], v7 offset0:36 offset1:54
    v_add_u32 v7, 8, v7
    ds_read2st64_b32 v[52:53], v7 offset0:0 offset1:18
    ds_read2st64_b32 v[54:55], v7 offset0:36 offset1:54
    v_add_u32 v7, 8, v7
    ds_read2st64_b32 v[56:57], v7 offset0:0 offset1:18
    ds_read2st64_b32 v[58:59], v7 offset0:36 offset1:54
    v_add_u32 v7, 8, v7
    ds_read2st64_b32 v[60:61], v7 offset0:0 offset1:18
    ds_read2st64_b32 v[62:63], v7 offset0:36 offset1:54
    v_add_u32 v7, 8, v7
    ds_read2st64_b32 v[64:65], v7 offset0:0 offset1:18
    ds_read2st64_b32 v[66:67], v7 offset0:36 offset1:54
    v_add_u32 v7, 8, v7
    ds_read2st64_b32 v[68:69], v7 offset0:0 offset1:18
    ds_read2st64_b32 v[70:71], v7 offset0:36 offset1:54
    v_add_u32 v7, 8, v7
    ds_read2st64_b32 v[72:73], v7 offset0:0 offset1:18
    ds_read2st64_b32 v[74:75], v7 offset0:36 offset1:54
    v_add_u32 v7, 8, v7
    ds_read2st64_b32 v[76:77], v7 offset0:0 offset1:18
    ds_read2st64_b32 v[78:79], v7 offset0:36 offset1:54
    ds_read_b128 v[80:83], v6
    s_waitcnt lgkmcnt(0)
    s_add_u32 s47, s46, 16777216
    buffer_store_dwordx4 v[16:19], v9, s[28:31], s47 offen sc1
    s_add_u32 s47, s46, 17039360
    buffer_store_dwordx4 v[20:23], v9, s[28:31], s47 offen sc1
    s_add_u32 s47, s46, 17301504
    buffer_store_dwordx4 v[24:27], v9, s[28:31], s47 offen sc1
    s_add_u32 s47, s46, 17563648
    buffer_store_dwordx4 v[28:31], v9, s[28:31], s47 offen sc1
    s_add_u32 s47, s46, 17825792
    buffer_store_dwordx4 v[32:35], v9, s[28:31], s47 offen sc1
    s_add_u32 s47, s46, 18087936
    buffer_store_dwordx4 v[36:39], v9, s[28:31], s47 offen sc1
    s_add_u32 s47, s46, 18350080
    buffer_store_dwordx4 v[40:43], v9, s[28:31], s47 offen sc1
    s_add_u32 s47, s46, 18612224
    buffer_store_dwordx4 v[44:47], v9, s[28:31], s47 offen sc1
    s_add_u32 s47, s46, 18874368
    buffer_store_dwordx4 v[48:51], v9, s[28:31], s47 offen sc1
    s_add_u32 s47, s46, 19136512
    buffer_store_dwordx4 v[52:55], v9, s[28:31], s47 offen sc1
    s_add_u32 s47, s46, 19398656
    buffer_store_dwordx4 v[56:59], v9, s[28:31], s47 offen sc1
    s_add_u32 s47, s46, 19660800
    buffer_store_dwordx4 v[60:63], v9, s[28:31], s47 offen sc1
    s_add_u32 s47, s46, 19922944
    buffer_store_dwordx4 v[64:67], v9, s[28:31], s47 offen sc1
    s_add_u32 s47, s46, 20185088
    buffer_store_dwordx4 v[68:71], v9, s[28:31], s47 offen sc1
    s_add_u32 s47, s46, 20447232
    buffer_store_dwordx4 v[72:75], v9, s[28:31], s47 offen sc1
    s_barrier
    s_add_u32 s47, s46, 20709376
    buffer_store_dwordx4 v[76:79], v9, s[28:31], s47 offen sc1
    s_add_u32 s47, s46, 14680064
    s_mov_b64 exec, 0xff
    buffer_store_dwordx4 v[80:83], v3, s[28:31], s47 offen sc1
    s_mov_b64 exec, -1
    s_setprio 0
    s_barrier
    s_waitcnt vmcnt(0)
    v_mov_b32 v8, s74
    v_mov_b32 v10, 0
    s_mov_b64 exec, 1
    buffer_store_dword v8, v10, s[28:31], s58 offen sc1
    s_mov_b64 exec, -1
    v_lshlrev_b32 v20, 16, v96
    v_and_b32 v21, 0xffff0000, v96
    v_lshlrev_b32 v22, 16, v97
    v_and_b32 v23, 0xffff0000, v97
    v_mul_f32 v20, s59, v20
    v_mul_f32 v21, s59, v21
    v_mul_f32 v22, s59, v22
    v_mul_f32 v23, s59, v23
    v_add_u32 v10, 148480, v11
    ds_write_b128 v10, v[20:23]
    s_barrier
    s_barrier
    s_barrier
    s_barrier
    s_barrier
    s_barrier
    s_barrier
    buffer_load_dwordx4 v[16:19], v5, s[28:31], s37 offen sc1
    buffer_load_dwordx4 v[20:23], v5, s[28:31], s37 offen offset:16 sc1
    s_barrier
    s_barrier
    s_mov_b32 s83, 0x20000
    s_waitcnt vmcnt(0)
    s_branch L_g1_tw7_w
L_g1_tw7:
    buffer_load_dwordx4 v[16:19], v5, s[28:31], s37 offen sc1
    buffer_load_dwordx4 v[20:23], v5, s[28:31], s37 offen offset:16 sc1
    s_waitcnt vmcnt(0)
L_g1_tw7_w:
    v_cmp_ne_u32 vcc, s74, v18
    s_nop 0
    s_mov_b64 s[80:81], vcc
    v_cmp_ne_u32 vcc, s74, v22
    s_nop 0
    s_or_b64 s[80:81], s[80:81], vcc
    s_cmp_eq_u64 s[80:81], 0
    s_cbranch_scc1 L_g1_tw7_ok
    s_sleep 2
    s_sub_u32 s83, s83, 1
    s_cmp_lg_u32 s83, 0
    s_cbranch_scc1 L_g1_tw7
L_g1_tw7_ok:
    v_add_u32 v10, 149504, v4
    ds_write_b64 v10, v[16:17]
    ds_write_b64 v10, v[20:21] offset:512
    s_waitcnt lgkmcnt(0)
    s_barrier
    s_cmp_eq_u32 s13, 4
    s_cbranch_scc1 L_g1_a7c
    s_endpgm
L_g1_a7c:
    s_barrier
    s_barrier
    s_barrier
    s_barrier
    s_branch L_f3_x
L_g1_a6:
    v_lshrrev_b32 v14, 5, v2
    v_bfe_u32 v7, v2, 1, 4
    v_xor_b32 v7, v7, v14
    v_lshlrev_b32 v7, 5, v7
    v_and_b32 v8, 1, v2
    v_lshl_add_u32 v7, v8, 4, v7
    v_lshl_add_u32 v12, v14, 9, v7
    s_and_b32 s60, s14, 3
    s_mul_i32 s61, s60, 43
    s_lshr_b32 s61, s61, 7
    s_mul_i32 s61, s61, 3
    s_sub_u32 s61, s60, s61
    s_mul_i32 s61, s61, 49152
    v_add_u32 v12, s61, v12
    v_xor_b32 v13, 64, v12
    v_xor_b32 v14, 128, v12
    v_xor_b32 v15, 192, v12
    s_waitcnt lgkmcnt(0)
    s_add_u32 s74, s74, 1
    v_and_b32 v5, 1, v2
    v_lshlrev_b32 v5, 4, v5
    v_mov_b32 v6, 0x3f80
    v_lshlrev_b32 v5, v5, v6
    v_bfe_u32 v6, v2, 3, 1
    v_bfe_u32 v7, v2, 4, 1
    v_xor_b32 v6, v6, v7
    v_bfe_u32 v7, v2, 1, 2
    v_lshl_or_b32 v6, v6, 2, v7
    v_cmp_eq_u32 vcc, 0, v6
    s_nop 1
    v_cndmask_b32 v148, 0, v5, vcc
    v_cmp_eq_u32 vcc, 1, v6
    s_nop 1
    v_cndmask_b32 v149, 0, v5, vcc
    v_cmp_eq_u32 vcc, 2, v6
    s_nop 1
    v_cndmask_b32 v150, 0, v5, vcc
    v_cmp_eq_u32 vcc, 3, v6
    s_nop 1
    v_cndmask_b32 v151, 0, v5, vcc
    s_lshl_b32 s52, s15, 14
    s_add_u32 s52, s52, 14745600
    s_lshl_b32 s53, s14, 10
    s_add_u32 s53, s53, s52
    s_lshl_b32 s56, s15, 11
    s_add_u32 s56, s56, 15007744
    s_lshl_b32 s57, s14, 7
    s_add_u32 s57, s57, s56
    v_and_b32 v5, 15, v2
    v_lshlrev_b32 v5, 7, v5
    s_mov_b32 s61, 0
L_g1_cb:
    s_barrier
    s_add_u32 s61, s61, 1
    s_cmp_le_u32 s61, s60
    s_cbranch_scc1 L_g1_cb
    ds_read_b128 v[16:19], v12 offset:0
    ds_read_b128 v[20:23], v13 offset:1024
    ds_read_b128 v[24:27], v12 offset:2048
    ds_read_b128 v[28:31], v13 offset:3072
    ds_read_b128 v[32:35], v14 offset:4096
    ds_read_b128 v[36:39], v15 offset:5120
    ds_read_b128 v[40:43], v14 offset:6144
    ds_read_b128 v[44:47], v15 offset:7168
    ds_read_b128 v[48:51], v12 offset:8192
    ds_read_b128 v[52:55], v13 offset:9216
    ds_read_b128 v[56:59], v12 offset:10240
    ds_read_b128 v[60:63], v13 offset:11264
    ds_read_b128 v[64:67], v14 offset:12288
    ds_read_b128 v[68:71], v15 offset:13312
    ds_read_b128 v[72:75], v14 offset:14336
    ds_read_b128 v[76:79], v15 offset:15360
    ds_read_b128 v[80:83], v12 offset:16384
    ds_read_b128 v[84:87], v13 offset:17408
    ds_read_b128 v[88:91], v12 offset:18432
    ds_read_b128 v[92:95], v13 offset:19456
    ds_read_b128 v[96:99], v14 offset:20480
    ds_read_b128 v[100:103], v15 offset:21504
    ds_read_b128 v[104:107], v14 offset:22528
    ds_read_b128 v[108:111], v15 offset:23552
    ds_read_b128 v[112:115], v12 offset:24576
    ds_read_b128 v[116:119], v13 offset:25600
    ds_read_b128 v[120:123], v12 offset:26624
    ds_read_b128 v[124:127], v13 offset:27648
    ds_read_b128 v[128:131], v14 offset:28672
    ds_read_b128 v[132:135], v15 offset:29696
    ds_read_b128 v[136:139], v14 offset:30720
    ds_read_b128 v[140:143], v15 offset:31744
    s_waitcnt lgkmcnt(0)
    v_mfma_f32_16x16x32_bf16 v[144:147], v[16:19], v[148:151], 0
    v_mfma_f32_16x16x32_bf16 v[144:147], v[20:23], v[148:151], v[144:147]
    v_mfma_f32_16x16x32_bf16 v[144:147], v[24:27], v[148:151], v[144:147]
    v_mfma_f32_16x16x32_bf16 v[144:147], v[28:31], v[148:151], v[144:147]
    v_mfma_f32_16x16x32_bf16 v[144:147], v[32:35], v[148:151], v[144:147]
    v_mfma_f32_16x16x32_bf16 v[144:147], v[36:39], v[148:151], v[144:147]
    v_mfma_f32_16x16x32_bf16 v[144:147], v[40:43], v[148:151], v[144:147]
    v_mfma_f32_16x16x32_bf16 v[144:147], v[44:47], v[148:151], v[144:147]
    v_mfma_f32_16x16x32_bf16 v[144:147], v[48:51], v[148:151], v[144:147]
    v_mfma_f32_16x16x32_bf16 v[144:147], v[52:55], v[148:151], v[144:147]
    v_mfma_f32_16x16x32_bf16 v[144:147], v[56:59], v[148:151], v[144:147]
    v_mfma_f32_16x16x32_bf16 v[144:147], v[60:63], v[148:151], v[144:147]
    v_mfma_f32_16x16x32_bf16 v[144:147], v[64:67], v[148:151], v[144:147]
    v_mfma_f32_16x16x32_bf16 v[144:147], v[68:71], v[148:151], v[144:147]
    v_mfma_f32_16x16x32_bf16 v[144:147], v[72:75], v[148:151], v[144:147]
    v_mfma_f32_16x16x32_bf16 v[144:147], v[76:79], v[148:151], v[144:147]
    v_mfma_f32_16x16x32_bf16 v[144:147], v[80:83], v[148:151], v[144:147]
    v_mfma_f32_16x16x32_bf16 v[144:147], v[84:87], v[148:151], v[144:147]
    v_mfma_f32_16x16x32_bf16 v[144:147], v[88:91], v[148:151], v[144:147]
    v_mfma_f32_16x16x32_bf16 v[144:147], v[92:95], v[148:151], v[144:147]
    v_mfma_f32_16x16x32_bf16 v[144:147], v[96:99], v[148:151], v[144:147]
    v_mfma_f32_16x16x32_bf16 v[144:147], v[100:103], v[148:151], v[144:147]
    v_mfma_f32_16x16x32_bf16 v[144:147], v[104:107], v[148:151], v[144:147]
    v_mfma_f32_16x16x32_bf16 v[144:147], v[108:111], v[148:151], v[144:147]
    v_mfma_f32_16x16x32_bf16 v[144:147], v[112:115], v[148:151], v[144:147]
    v_mfma_f32_16x16x32_bf16 v[144:147], v[116:119], v[148:151], v[144:147]
    v_mfma_f32_16x16x32_bf16 v[144:147], v[120:123], v[148:151], v[144:147]
    v_mfma_f32_16x16x32_bf16 v[144:147], v[124:127], v[148:151], v[144:147]
    v_mfma_f32_16x16x32_bf16 v[144:147], v[128:131], v[148:151], v[144:147]
    v_mfma_f32_16x16x32_bf16 v[144:147], v[132:135], v[148:151], v[144:147]
    v_mfma_f32_16x16x32_bf16 v[144:147], v[136:139], v[148:151], v[144:147]
    v_mfma_f32_16x16x32_bf16 v[144:147], v[140:143], v[148:151], v[144:147]
    s_barrier
    s_nop 6
    buffer_store_dwordx4 v[144:147], v11, s[28:31], s53 offen sc1
    s_barrier
    s_waitcnt vmcnt(0)
    v_mov_b32 v6, s74
    v_mov_b32 v7, 0
    s_mov_b64 exec, 1
    buffer_store_dword v6, v7, s[28:31], s57 offen sc1
    s_mov_b64 exec, -1
L_g1_cb2:
    s_barrier
    s_add_u32 s60, s60, 1
    s_cmp_lt_u32 s60, 8
    s_cbranch_scc1 L_g1_cb2
    buffer_load_dword v7, v5, s[28:31], s56 offen sc1
    s_barrier
    s_mov_b32 s83, 0x20000
    s_waitcnt vmcnt(0)
    s_branch L_g1_tw6_w
L_g1_tw6:
    buffer_load_dword v7, v5, s[28:31], s56 offen sc1
    s_waitcnt vmcnt(0)
L_g1_tw6_w:
    v_cmp_ne_u32 vcc, s74, v7
    s_nop 0
    s_mov_b64 s[80:81], vcc
    s_cmp_eq_u64 s[80:81], 0
    s_cbranch_scc1 L_g1_tw6_ok
    s_sleep 2
    s_sub_u32 s83, s83, 1
    s_cmp_lg_u32 s83, 0
    s_cbranch_scc1 L_g1_tw6
L_g1_tw6_ok:
    s_add_u32 s46, s52, 0
    buffer_load_dwordx4 v[16:19], v11, s[28:31], s46 offen offset:0 sc1
    buffer_load_dwordx4 v[20:23], v11, s[28:31], s46 offen offset:1024 sc1
    buffer_load_dwordx4 v[24:27], v11, s[28:31], s46 offen offset:2048 sc1
    buffer_load_dwordx4 v[28:31], v11, s[28:31], s46 offen offset:3072 sc1
    s_add_u32 s46, s52, 4096
    buffer_load_dwordx4 v[32:35], v11, s[28:31], s46 offen offset:0 sc1
    buffer_load_dwordx4 v[36:39], v11, s[28:31], s46 offen offset:1024 sc1
    buffer_load_dwordx4 v[40:43], v11, s[28:31], s46 offen offset:2048 sc1
    buffer_load_dwordx4 v[44:47], v11, s[28:31], s46 offen offset:3072 sc1
    s_add_u32 s46, s52, 8192
    buffer_load_dwordx4 v[48:51], v11, s[28:31], s46 offen offset:0 sc1
    buffer_load_dwordx4 v[52:55], v11, s[28:31], s46 offen offset:1024 sc1
    buffer_load_dwordx4 v[56:59], v11, s[28:31], s46 offen offset:2048 sc1
    buffer_load_dwordx4 v[60:63], v11, s[28:31], s46 offen offset:3072 sc1
    s_add_u32 s46, s52, 12288
    buffer_load_dwordx4 v[64:67], v11, s[28:31], s46 offen offset:0 sc1
    buffer_load_dwordx4 v[68:71], v11, s[28:31], s46 offen offset:1024 sc1
    buffer_load_dwordx4 v[72:75], v11, s[28:31], s46 offen offset:2048 sc1
    buffer_load_dwordx4 v[76:79], v11, s[28:31], s46 offen offset:3072 sc1
    v_bfe_u32 v10, v2, 3, 1
    v_lshlrev_b32 v10, 9, v10
    v_lshrrev_b32 v5, 4, v2
    v_lshl_add_u32 v10, v5, 7, v10
    v_and_b32 v5, 7, v2
    v_lshl_add_u32 v10, v5, 2, v10
    v_add_u32 v10, 147456, v10
    s_barrier
    s_barrier
    s_waitcnt vmcnt(0)
    v_add_f32 v16, v16, v48
    v_add_f32 v17, v17, v49
    v_add_f32 v18, v18, v50
    v_add_f32 v19, v19, v51
    v_add_f32 v20, v20, v52
    v_add_f32 v21, v21, v53
    v_add_f32 v22, v22, v54
    v_add_f32 v23, v23, v55
    v_add_f32 v24, v24, v56
    v_add_f32 v25, v25, v57
    v_add_f32 v26, v26, v58
    v_add_f32 v27, v27, v59
    v_add_f32 v28, v28, v60
    v_add_f32 v29, v29, v61
    v_add_f32 v30, v30, v62
    v_add_f32 v31, v31, v63
    v_add_f32 v32, v32, v64
    v_add_f32 v33, v33, v65
    v_add_f32 v34, v34, v66
    v_add_f32 v35, v35, v67
    v_add_f32 v36, v36, v68
    v_add_f32 v37, v37, v69
    v_add_f32 v38, v38, v70
    v_add_f32 v39, v39, v71
    v_add_f32 v40, v40, v72
    v_add_f32 v41, v41, v73
    v_add_f32 v42, v42, v74
    v_add_f32 v43, v43, v75
    v_add_f32 v44, v44, v76
    v_add_f32 v45, v45, v77
    v_add_f32 v46, v46, v78
    v_add_f32 v47, v47, v79
    s_barrier
    v_add_f32 v16, v16, v32
    v_add_f32 v17, v17, v33
    v_add_f32 v18, v18, v34
    v_add_f32 v19, v19, v35
    v_add_f32 v20, v20, v36
    v_add_f32 v21, v21, v37
    v_add_f32 v22, v22, v38
    v_add_f32 v23, v23, v39
    v_add_f32 v24, v24, v40
    v_add_f32 v25, v25, v41
    v_add_f32 v26, v26, v42
    v_add_f32 v27, v27, v43
    v_add_f32 v28, v28, v44
    v_add_f32 v29, v29, v45
    v_add_f32 v30, v30, v46
    v_add_f32 v31, v31, v47
    v_add_f32 v16, v16, v24
    v_add_f32 v17, v17, v25
    v_add_f32 v18, v18, v26
    v_add_f32 v19, v19, v27
    v_add_f32 v20, v20, v28
    v_add_f32 v21, v21, v29
    v_add_f32 v22, v22, v30
    v_add_f32 v23, v23, v31
    v_add_f32 v16, v16, v20
    v_add_f32 v17, v17, v21
    v_add_f32 v18, v18, v22
    v_add_f32 v19, v19, v23
    ds_write2_b32 v10, v16, v17 offset0:0 offset1:8
    ds_write2_b32 v10, v18, v19 offset0:16 offset1:24
    s_waitcnt lgkmcnt(0)
    s_barrier
    s_cmp_eq_u32 s13, 4
    s_cbranch_scc1 L_f3_x
    s_endpgm
L_g1_c:
    v_lshlrev_b32 v3, 4, v2
    s_lshr_b32 s36, s2, 4
    s_lshl_b32 s36, s36, 2
    s_and_b32 s37, s2, 1
    s_lshl_b32 s37, s37, 1
    s_add_u32 s36, s36, s37
    s_bfe_u32 s37, s2, 0x10003
    s_add_u32 s36, s36, s37
    s_bfe_u32 s37, s2, 0x10002
    s_lshl_b32 s37, s37, 10
    s_add_u32 s36, s36, s37
    s_bfe_u32 s37, s2, 0x10001
    s_lshl_b32 s37, s37, 8
    s_add_u32 s36, s36, s37
    s_lshl_b32 s37, s19, 9
    s_add_u32 s36, s36, s37
    s_lshl_b32 s37, s18, 7
    s_add_u32 s36, s36, s37
    s_lshl_b32 s38, s36, 11
    s_cmp_lt_u32 s2, 32
    s_mov_b32 s40, 98304
    s_cselect_b32 s40, 139776, s40
    s_mul_i32 s39, s16, 4608
    s_add_u32 s39, s39, s40
    s_add_u32 s42, s38, 0x20000
    s_waitcnt lgkmcnt(0)
    s_mov_b32 m0, s39
    s_add_u32 s72, s10, 15040512
    s_addc_u32 s73, s11, 0
    s_load_dword s74, s[72:73], 0
    buffer_load_dwordx4 v3, s[24:27], s38 offen lds
    buffer_load_dwordx4 v3, s[24:27], s38 offen offset:1024 lds
    s_add_u32 m0, s39, 2048
    s_mov_b32 s28, s10
    s_mov_b32 s29, s11
    s_mov_b32 s30, 268435456
    s_mov_b32 s31, 0x20000
    buffer_load_dwordx4 v3, s[24:27], s42 offen lds
    buffer_load_dwordx4 v3, s[24:27], s42 offen offset:1024 lds
    v_and_b32 v13, 31, v2
    v_lshrrev_b32 v14, 5, v2
    v_cvt_f32_u32 v10, v13
    v_mul_u32_u24 v11, v13, v14
    v_cvt_f32_u32 v11, v11
    v_mul_f32 v11, 0x3e000000, v11
    v_mov_b32 v168, v11
    v_fmamk_f32 v169, v10, 0x3d000000, v11
    v_fmamk_f32 v170, v10, 0x3d800000, v11
    v_fmamk_f32 v171, v10, 0x3dc00000, v11
    v_fmamk_f32 v172, v10, 0x3e800000, v11
    v_fmamk_f32 v173, v10, 0x3e900000, v11
    v_fmamk_f32 v174, v10, 0x3ea00000, v11
    v_fmamk_f32 v175, v10, 0x3eb00000, v11
    v_fmamk_f32 v176, v10, 0x3f000000, v11
    v_fmamk_f32 v177, v10, 0x3f080000, v11
    v_fmamk_f32 v178, v10, 0x3f100000, v11
    v_fmamk_f32 v179, v10, 0x3f180000, v11
    v_fmamk_f32 v180, v10, 0x3f400000, v11
    v_fmamk_f32 v181, v10, 0x3f480000, v11
    v_fmamk_f32 v182, v10, 0x3f500000, v11
    v_fmamk_f32 v183, v10, 0x3f580000, v11
    v_fract_f32 v168, v168
    v_fract_f32 v169, v169
    v_fract_f32 v170, v170
    v_fract_f32 v171, v171
    v_fract_f32 v172, v172
    v_fract_f32 v173, v173
    v_fract_f32 v174, v174
    v_fract_f32 v175, v175
    v_fract_f32 v176, v176
    v_fract_f32 v177, v177
    v_fract_f32 v178, v178
    v_fract_f32 v179, v179
    v_fract_f32 v180, v180
    v_fract_f32 v181, v181
    v_fract_f32 v182, v182
    v_fract_f32 v183, v183
    v_cos_f32 v184, v168
    v_cos_f32 v185, v169
    v_cos_f32 v186, v170
    v_cos_f32 v187, v171
    v_cos_f32 v188, v172
    v_cos_f32 v189, v173
    v_cos_f32 v190, v174
    v_cos_f32 v191, v175
    v_cos_f32 v192, v176
    v_cos_f32 v193, v177
    v_cos_f32 v194, v178
    v_cos_f32 v195, v179
    v_cos_f32 v196, v180
    v_cos_f32 v197, v181
    v_cos_f32 v198, v182
    v_cos_f32 v199, v183
    v_sin_f32 v200, v168
    v_sin_f32 v201, v169
    v_sin_f32 v202, v170
    v_sin_f32 v203, v171
    v_sin_f32 v204, v172
    v_sin_f32 v205, v173
    v_sin_f32 v206, v174
    v_sin_f32 v207, v175
    v_sin_f32 v208, v176
    v_sin_f32 v209, v177
    v_sin_f32 v210, v178
    v_sin_f32 v211, v179
    v_sin_f32 v212, v180
    v_sin_f32 v213, v181
    v_sin_f32 v214, v182
    v_sin_f32 v215, v183
    v_cvt_pk_bf16_f32 v16, v184, v185
    v_cvt_pk_bf16_f32 v24, v200, v201
    v_cvt_pk_bf16_f32 v32, -v200, -v201
    v_cvt_pk_bf16_f32 v17, v186, v187
    v_cvt_pk_bf16_f32 v25, v202, v203
    v_cvt_pk_bf16_f32 v33, -v202, -v203
    v_cvt_pk_bf16_f32 v18, v188, v189
    v_cvt_pk_bf16_f32 v26, v204, v205
    v_cvt_pk_bf16_f32 v34, -v204, -v205
    v_cvt_pk_bf16_f32 v19, v190, v191
    v_cvt_pk_bf16_f32 v27, v206, v207
    v_cvt_pk_bf16_f32 v35, -v206, -v207
    v_cvt_pk_bf16_f32 v20, v192, v193
    v_cvt_pk_bf16_f32 v28, v208, v209
    v_cvt_pk_bf16_f32 v36, -v208, -v209
    v_cvt_pk_bf16_f32 v21, v194, v195
    v_cvt_pk_bf16_f32 v29, v210, v211
    v_cvt_pk_bf16_f32 v37, -v210, -v211
    v_cvt_pk_bf16_f32 v22, v196, v197
    v_cvt_pk_bf16_f32 v30, v212, v213
    v_cvt_pk_bf16_f32 v38, -v212, -v213
    v_cvt_pk_bf16_f32 v23, v198, v199
    v_cvt_pk_bf16_f32 v31, v214, v215
    v_cvt_pk_bf16_f32 v39, -v214, -v215
    v_mov_b32 v72, v16
    v_mov_b32 v120, v32
    v_mov_b32 v80, v24
    v_mov_b32 v128, v16
    v_mov_b32 v73, v17
    v_mov_b32 v121, v33
    v_mov_b32 v81, v25
    v_mov_b32 v129, v17
    v_mov_b32 v74, v18
    v_mov_b32 v122, v34
    v_mov_b32 v82, v26
    v_mov_b32 v130, v18
    v_mov_b32 v75, v19
    v_mov_b32 v123, v35
    v_mov_b32 v83, v27
    v_mov_b32 v131, v19
    v_mov_b32 v76, v20
    v_mov_b32 v124, v36
    v_mov_b32 v84, v28
    v_mov_b32 v132, v20
    v_mov_b32 v77, v21
    v_mov_b32 v125, v37
    v_mov_b32 v85, v29
    v_mov_b32 v133, v21
    v_mov_b32 v78, v22
    v_mov_b32 v126, v38
    v_mov_b32 v86, v30
    v_mov_b32 v134, v22
    v_mov_b32 v79, v23
    v_mov_b32 v127, v39
    v_mov_b32 v87, v31
    v_mov_b32 v135, v23
    v_permlane16_swap_b32 v72, v120
    v_permlane16_swap_b32 v80, v128
    v_permlane16_swap_b32 v73, v121
    v_permlane16_swap_b32 v81, v129
    v_permlane16_swap_b32 v74, v122
    v_permlane16_swap_b32 v82, v130
    v_permlane16_swap_b32 v75, v123
    v_permlane16_swap_b32 v83, v131
    v_permlane16_swap_b32 v76, v124
    v_permlane16_swap_b32 v84, v132
    v_permlane16_swap_b32 v77, v125
    v_permlane16_swap_b32 v85, v133
    v_permlane16_swap_b32 v78, v126
    v_permlane16_swap_b32 v86, v134
    v_permlane16_swap_b32 v79, v127
    v_permlane16_swap_b32 v87, v135
    v_cvt_f32_u32 v10, v13
    v_mul_u32_u24 v11, v13, v14
    v_cvt_f32_u32 v11, v11
    v_mul_f32 v11, 0x3b800000, v11
    v_mov_b32 v56, v11
    v_fmamk_f32 v57, v10, 0x3a800000, v11
    v_fmamk_f32 v58, v10, 0x3b000000, v11
    v_fmamk_f32 v59, v10, 0x3b400000, v11
    v_fmamk_f32 v60, v10, 0x3c000000, v11
    v_fmamk_f32 v61, v10, 0x3c100000, v11
    v_fmamk_f32 v62, v10, 0x3c200000, v11
    v_fmamk_f32 v63, v10, 0x3c300000, v11
    v_fmamk_f32 v64, v10, 0x3c800000, v11
    v_fmamk_f32 v65, v10, 0x3c880000, v11
    v_fmamk_f32 v66, v10, 0x3c900000, v11
    v_fmamk_f32 v67, v10, 0x3c980000, v11
    v_fmamk_f32 v68, v10, 0x3cc00000, v11
    v_fmamk_f32 v69, v10, 0x3cc80000, v11
    v_fmamk_f32 v70, v10, 0x3cd00000, v11
    v_fmamk_f32 v71, v10, 0x3cd80000, v11
    v_cos_f32 v40, v56
    v_cos_f32 v41, v57
    v_cos_f32 v42, v58
    v_cos_f32 v43, v59
    v_cos_f32 v44, v60
    v_cos_f32 v45, v61
    v_cos_f32 v46, v62
    v_cos_f32 v47, v63
    v_cos_f32 v48, v64
    v_cos_f32 v49, v65
    v_cos_f32 v50, v66
    v_cos_f32 v51, v67
    v_cos_f32 v52, v68
    v_cos_f32 v53, v69
    v_cos_f32 v54, v70
    v_cos_f32 v55, v71
    v_sin_f32 v56, v56
    v_sin_f32 v57, v57
    v_sin_f32 v58, v58
    v_sin_f32 v59, v59
    v_sin_f32 v60, v60
    v_sin_f32 v61, v61
    v_sin_f32 v62, v62
    v_sin_f32 v63, v63
    v_sin_f32 v64, v64
    v_sin_f32 v65, v65
    v_sin_f32 v66, v66
    v_sin_f32 v67, v67
    v_sin_f32 v68, v68
    v_sin_f32 v69, v69
    v_sin_f32 v70, v70
    v_sin_f32 v71, v71
    v_bfe_u32 v4, v2, 2, 2
    v_lshl_add_u32 v4, v14, 2, v4
    v_lshlrev_b32 v4, 6, v4
    v_bfe_u32 v5, v2, 4, 1
    v_lshl_add_u32 v4, v5, 5, v4
    v_and_b32 v5, 3, v2
    v_lshl_add_u32 v4, v5, 3, v4
    v_add_u32 v4, s39, v4
    v_mul_u32_u24 v8, 144, v14
    v_lshl_add_u32 v8, v13, 2, v8
    v_add_u32 v8, s39, v8
    v_cmp_eq_u32 vcc, 0, v13
    s_nop 1
    v_cndmask_b32 v12, 0, 1.0, vcc
    s_mov_b32 s43, 0x3f803f80
    s_mov_b32 s44, 0x3a800000
    s_mov_b32 s45, 0x3fb8aa3b
    s_waitcnt vmcnt(0)
    ds_read_b64_tr_b16 v[104:105], v4 offset:0
    ds_read_b64_tr_b16 v[106:107], v4 offset:512
    ds_read_b64_tr_b16 v[108:109], v4 offset:1024
    ds_read_b64_tr_b16 v[110:111], v4 offset:1536
    ds_read_b64_tr_b16 v[112:113], v4 offset:2048
    ds_read_b64_tr_b16 v[114:115], v4 offset:2560
    ds_read_b64_tr_b16 v[116:117], v4 offset:3072
    ds_read_b64_tr_b16 v[118:119], v4 offset:3584
    s_waitcnt lgkmcnt(0)
    v_mfma_f32_32x32x16_bf16 v[168:183], v[104:107], v[16:19], 0
    v_mfma_f32_32x32x16_bf16 v[168:183], v[108:111], v[20:23], v[168:183]
    v_mfma_f32_32x32x16_bf16 v[184:199], v[104:107], v[32:35], 0
    v_mfma_f32_32x32x16_bf16 v[184:199], v[108:111], v[36:39], v[184:199]
    v_mfma_f32_32x32x16_bf16 v[200:215], v[112:115], v[16:19], 0
    v_mfma_f32_32x32x16_bf16 v[200:215], v[116:119], v[20:23], v[200:215]
    v_mfma_f32_32x32x16_bf16 v[216:231], v[112:115], v[32:35], 0
    v_mfma_f32_32x32x16_bf16 v[216:231], v[116:119], v[36:39], v[216:231]
    v_dot2_f32_bf16 v240, v104, s43, 0
    v_dot2_f32_bf16 v242, v104, v104, 0
    v_dot2_f32_bf16 v241, v112, s43, 0
    v_dot2_f32_bf16 v243, v112, v112, 0
    v_dot2_f32_bf16 v240, v105, s43, v240
    v_dot2_f32_bf16 v242, v105, v105, v242
    v_dot2_f32_bf16 v241, v113, s43, v241
    v_dot2_f32_bf16 v243, v113, v113, v243
    v_dot2_f32_bf16 v240, v106, s43, v240
    v_dot2_f32_bf16 v242, v106, v106, v242
    v_dot2_f32_bf16 v241, v114, s43, v241
    v_dot2_f32_bf16 v243, v114, v114, v243
    v_dot2_f32_bf16 v240, v107, s43, v240
    v_dot2_f32_bf16 v242, v107, v107, v242
    v_dot2_f32_bf16 v241, v115, s43, v241
    v_dot2_f32_bf16 v243, v115, v115, v243
    v_dot2_f32_bf16 v240, v108, s43, v240
    v_dot2_f32_bf16 v242, v108, v108, v242
    v_dot2_f32_bf16 v241, v116, s43, v241
    v_dot2_f32_bf16 v243, v116, v116, v243
    v_dot2_f32_bf16 v240, v109, s43, v240
    v_dot2_f32_bf16 v242, v109, v109, v242
    v_dot2_f32_bf16 v241, v117, s43, v241
    v_dot2_f32_bf16 v243, v117, v117, v243
    v_dot2_f32_bf16 v240, v110, s43, v240
    v_dot2_f32_bf16 v242, v110, v110, v242
    v_dot2_f32_bf16 v241, v118, s43, v241
    v_dot2_f32_bf16 v243, v118, v118, v243
    v_dot2_f32_bf16 v240, v111, s43, v240
    v_dot2_f32_bf16 v242, v111, v111, v242
    v_dot2_f32_bf16 v241, v119, s43, v241
    v_dot2_f32_bf16 v243, v119, v119, v243
    s_nop 1
    v_permlane32_swap_b32 v240, v241
    v_permlane32_swap_b32 v242, v243
    v_add_f32 v240, v240, v241
    v_add_f32 v242, v242, v243
    v_mov_b32 v241, v240
    v_mov_b32 v243, v242
    s_nop 0
    v_permlane16_swap_b32 v240, v241
    v_permlane16_swap_b32 v242, v243
    v_add_f32 v240, v240, v241
    v_add_f32 v242, v242, v243
    s_nop 0
    v_add_f32_dpp v240, v240, v240 row_ror:8 row_mask:0xf bank_mask:0xf
    v_add_f32_dpp v242, v242, v242 row_ror:8 row_mask:0xf bank_mask:0xf
    s_nop 0
    v_add_f32_dpp v240, v240, v240 row_ror:4 row_mask:0xf bank_mask:0xf
    v_add_f32_dpp v242, v242, v242 row_ror:4 row_mask:0xf bank_mask:0xf
    s_nop 0
    v_add_f32_dpp v240, v240, v240 row_ror:2 row_mask:0xf bank_mask:0xf
    v_add_f32_dpp v242, v242, v242 row_ror:2 row_mask:0xf bank_mask:0xf
    s_nop 0
    v_subrev_f32_dpp v241, v240, v240 quad_perm:[1,0,3,2] row_mask:0xf bank_mask:0xf
    v_add_f32_dpp v240, v240, v240 quad_perm:[1,0,3,2] row_mask:0xf bank_mask:0xf
    v_add_f32_dpp v242, v242, v242 quad_perm:[1,0,3,2] row_mask:0xf bank_mask:0xf
    s_add_u32 s74, s74, 1
    v_mul_f32 v240, s44, v240
    v_mul_f32 v243, v240, v240
    v_fma_f32 v242, v242, s44, -v243
    v_mul_f32 v243, 0xc2000000, v240
    v_max_f32 v242, 0, v242
    v_readlane_b32 s56, v243, 0
    v_readlane_b32 s57, v243, 32
    v_cvt_pk_bf16_f32 v242, v242, v242
    v_and_b32 v242, 0xffff0000, v242
    v_add_f32 v242, 0x3727c5ac, v242
    v_cvt_pk_bf16_f32 v242, v242, v242
    v_and_b32 v242, 0xffff0000, v242
    v_sqrt_f32 v242, v242
    s_nop 0
    v_cvt_pk_bf16_f32 v242, v242, v242
    v_and_b32 v242, 0xffff0000, v242
    v_rcp_f32 v242, v242
    v_cvt_pk_bf16_f32 v240, v240, v240
    v_and_b32 v240, 0xffff0000, v240
    v_sub_f32 v244, 0, v240
    v_mul_f32 v245, s45, v242
    v_mov_b32 v246, s74
    v_mov_b32 v247, s74
    v_readlane_b32 s58, v242, 0
    v_readlane_b32 s60, v241, 0
    v_readlane_b32 s59, v242, 32
    v_readlane_b32 s61, v241, 32
    s_lshl_b32 s46, s16, 5
    s_add_u32 s46, s46, s40
    s_add_u32 s46, s46, 18432
    v_lshl_add_u32 v6, v14, 4, s46
    s_mov_b32 exec_lo, 1
    s_mov_b32 exec_hi, 1
    ds_write_b128 v6, v[244:247]
    s_mov_b64 exec, -1
    v_mul_f32 v10, s56, v12
    v_pk_fma_f32 v[232:233], v[184:185], v[56:57], v[10:11] op_sel_hi:[1,1,0]
    v_pk_mul_f32 v[234:235], v[168:169], v[56:57]
    v_pk_fma_f32 v[232:233], v[168:169], v[40:41], v[232:233]
    v_pk_fma_f32 v[234:235], v[184:185], v[40:41], v[234:235] neg_lo:[0,0,1] neg_hi:[0,0,1]
    v_cvt_pk_bf16_f32 v120, v232, v233
    v_cvt_pk_bf16_f32 v128, v234, v235
    v_pk_fma_f32 v[236:237], v[186:187], v[58:59], v[10:11] op_sel_hi:[1,1,0]
    v_pk_mul_f32 v[238:239], v[170:171], v[58:59]
    v_pk_fma_f32 v[236:237], v[170:171], v[42:43], v[236:237]
    v_pk_fma_f32 v[238:239], v[186:187], v[42:43], v[238:239] neg_lo:[0,0,1] neg_hi:[0,0,1]
    v_cvt_pk_bf16_f32 v121, v236, v237
    v_cvt_pk_bf16_f32 v129, v238, v239
    v_pk_fma_f32 v[232:233], v[188:189], v[60:61], v[10:11] op_sel_hi:[1,1,0]
    v_pk_mul_f32 v[234:235], v[172:173], v[60:61]
    v_pk_fma_f32 v[232:233], v[172:173], v[44:45], v[232:233]
    v_pk_fma_f32 v[234:235], v[188:189], v[44:45], v[234:235] neg_lo:[0,0,1] neg_hi:[0,0,1]
    v_cvt_pk_bf16_f32 v122, v232, v233
    v_cvt_pk_bf16_f32 v130, v234, v235
    v_pk_fma_f32 v[236:237], v[190:191], v[62:63], v[10:11] op_sel_hi:[1,1,0]
    v_pk_mul_f32 v[238:239], v[174:175], v[62:63]
    v_pk_fma_f32 v[236:237], v[174:175], v[46:47], v[236:237]
    v_pk_fma_f32 v[238:239], v[190:191], v[46:47], v[238:239] neg_lo:[0,0,1] neg_hi:[0,0,1]
    v_cvt_pk_bf16_f32 v123, v236, v237
    v_cvt_pk_bf16_f32 v131, v238, v239
    v_pk_fma_f32 v[232:233], v[192:193], v[64:65], v[10:11] op_sel_hi:[1,1,0]
    v_pk_mul_f32 v[234:235], v[176:177], v[64:65]
    v_pk_fma_f32 v[232:233], v[176:177], v[48:49], v[232:233]
    v_pk_fma_f32 v[234:235], v[192:193], v[48:49], v[234:235] neg_lo:[0,0,1] neg_hi:[0,0,1]
    v_cvt_pk_bf16_f32 v124, v232, v233
    v_cvt_pk_bf16_f32 v132, v234, v235
    v_pk_fma_f32 v[236:237], v[194:195], v[66:67], v[10:11] op_sel_hi:[1,1,0]
    v_pk_mul_f32 v[238:239], v[178:179], v[66:67]
    v_pk_fma_f32 v[236:237], v[178:179], v[50:51], v[236:237]
    v_pk_fma_f32 v[238:239], v[194:195], v[50:51], v[238:239] neg_lo:[0,0,1] neg_hi:[0,0,1]
    v_cvt_pk_bf16_f32 v125, v236, v237
    v_cvt_pk_bf16_f32 v133, v238, v239
    v_pk_fma_f32 v[232:233], v[196:197], v[68:69], v[10:11] op_sel_hi:[1,1,0]
    v_pk_mul_f32 v[234:235], v[180:181], v[68:69]
    v_pk_fma_f32 v[232:233], v[180:181], v[52:53], v[232:233]
    v_pk_fma_f32 v[234:235], v[196:197], v[52:53], v[234:235] neg_lo:[0,0,1] neg_hi:[0,0,1]
    v_cvt_pk_bf16_f32 v126, v232, v233
    v_cvt_pk_bf16_f32 v134, v234, v235
    v_pk_fma_f32 v[236:237], v[198:199], v[70:71], v[10:11] op_sel_hi:[1,1,0]
    v_pk_mul_f32 v[238:239], v[182:183], v[70:71]
    v_pk_fma_f32 v[236:237], v[182:183], v[54:55], v[236:237]
    v_pk_fma_f32 v[238:239], v[198:199], v[54:55], v[238:239] neg_lo:[0,0,1] neg_hi:[0,0,1]
    v_cvt_pk_bf16_f32 v127, v236, v237
    v_cvt_pk_bf16_f32 v135, v238, v239
    v_mfma_f32_32x32x16_bf16 v[168:183], v[72:75], v[120:123], 0
    v_mfma_f32_32x32x16_bf16 v[168:183], v[76:79], v[124:127], v[168:183]
    v_mfma_f32_32x32x16_bf16 v[168:183], v[80:83], v[128:131], v[168:183]
    v_mfma_f32_32x32x16_bf16 v[168:183], v[84:87], v[132:135], v[168:183]
    v_mul_f32 v10, s57, v12
    v_pk_fma_f32 v[232:233], v[216:217], v[56:57], v[10:11] op_sel_hi:[1,1,0]
    v_pk_mul_f32 v[234:235], v[200:201], v[56:57]
    v_pk_fma_f32 v[232:233], v[200:201], v[40:41], v[232:233]
    v_pk_fma_f32 v[234:235], v[216:217], v[40:41], v[234:235] neg_lo:[0,0,1] neg_hi:[0,0,1]
    v_cvt_pk_bf16_f32 v120, v232, v233
    v_cvt_pk_bf16_f32 v128, v234, v235
    v_pk_fma_f32 v[236:237], v[218:219], v[58:59], v[10:11] op_sel_hi:[1,1,0]
    v_pk_mul_f32 v[238:239], v[202:203], v[58:59]
    v_pk_fma_f32 v[236:237], v[202:203], v[42:43], v[236:237]
    v_pk_fma_f32 v[238:239], v[218:219], v[42:43], v[238:239] neg_lo:[0,0,1] neg_hi:[0,0,1]
    v_cvt_pk_bf16_f32 v121, v236, v237
    v_cvt_pk_bf16_f32 v129, v238, v239
    v_pk_fma_f32 v[232:233], v[220:221], v[60:61], v[10:11] op_sel_hi:[1,1,0]
    v_pk_mul_f32 v[234:235], v[204:205], v[60:61]
    v_pk_fma_f32 v[232:233], v[204:205], v[44:45], v[232:233]
    v_pk_fma_f32 v[234:235], v[220:221], v[44:45], v[234:235] neg_lo:[0,0,1] neg_hi:[0,0,1]
    v_cvt_pk_bf16_f32 v122, v232, v233
    v_cvt_pk_bf16_f32 v130, v234, v235
    v_pk_fma_f32 v[236:237], v[222:223], v[62:63], v[10:11] op_sel_hi:[1,1,0]
    v_pk_mul_f32 v[238:239], v[206:207], v[62:63]
    v_pk_fma_f32 v[236:237], v[206:207], v[46:47], v[236:237]
    v_pk_fma_f32 v[238:239], v[222:223], v[46:47], v[238:239] neg_lo:[0,0,1] neg_hi:[0,0,1]
    v_cvt_pk_bf16_f32 v123, v236, v237
    v_cvt_pk_bf16_f32 v131, v238, v239
    v_pk_fma_f32 v[232:233], v[224:225], v[64:65], v[10:11] op_sel_hi:[1,1,0]
    v_pk_mul_f32 v[234:235], v[208:209], v[64:65]
    v_pk_fma_f32 v[232:233], v[208:209], v[48:49], v[232:233]
    v_pk_fma_f32 v[234:235], v[224:225], v[48:49], v[234:235] neg_lo:[0,0,1] neg_hi:[0,0,1]
    v_cvt_pk_bf16_f32 v124, v232, v233
    v_cvt_pk_bf16_f32 v132, v234, v235
    v_pk_fma_f32 v[236:237], v[226:227], v[66:67], v[10:11] op_sel_hi:[1,1,0]
    v_pk_mul_f32 v[238:239], v[210:211], v[66:67]
    v_pk_fma_f32 v[236:237], v[210:211], v[50:51], v[236:237]
    v_pk_fma_f32 v[238:239], v[226:227], v[50:51], v[238:239] neg_lo:[0,0,1] neg_hi:[0,0,1]
    v_cvt_pk_bf16_f32 v125, v236, v237
    v_cvt_pk_bf16_f32 v133, v238, v239
    v_pk_fma_f32 v[232:233], v[228:229], v[68:69], v[10:11] op_sel_hi:[1,1,0]
    v_pk_mul_f32 v[234:235], v[212:213], v[68:69]
    v_pk_fma_f32 v[232:233], v[212:213], v[52:53], v[232:233]
    v_pk_fma_f32 v[234:235], v[228:229], v[52:53], v[234:235] neg_lo:[0,0,1] neg_hi:[0,0,1]
    v_cvt_pk_bf16_f32 v126, v232, v233
    v_cvt_pk_bf16_f32 v134, v234, v235
    v_pk_fma_f32 v[236:237], v[230:231], v[70:71], v[10:11] op_sel_hi:[1,1,0]
    v_pk_mul_f32 v[238:239], v[214:215], v[70:71]
    v_pk_fma_f32 v[236:237], v[214:215], v[54:55], v[236:237]
    v_pk_fma_f32 v[238:239], v[230:231], v[54:55], v[238:239] neg_lo:[0,0,1] neg_hi:[0,0,1]
    v_cvt_pk_bf16_f32 v127, v236, v237
    v_cvt_pk_bf16_f32 v135, v238, v239
    v_mfma_f32_32x32x16_bf16 v[200:215], v[72:75], v[120:123], 0
    v_mfma_f32_32x32x16_bf16 v[200:215], v[76:79], v[124:127], v[200:215]
    v_mfma_f32_32x32x16_bf16 v[200:215], v[80:83], v[128:131], v[200:215]
    v_mfma_f32_32x32x16_bf16 v[200:215], v[84:87], v[132:135], v[200:215]
    v_writelane_b32 v168, s60, 0
    v_writelane_b32 v176, 0, 0
    s_nop 9
    v_writelane_b32 v200, s61, 0
    v_writelane_b32 v208, 0, 0
    v_mul_f32 v168, s58, v168
    v_mul_f32 v200, s59, v200
    v_cvt_pk_bf16_f32 v184, v168, v200
    ds_write_b32 v8, v184 offset:0
    v_mul_f32 v169, s58, v169
    v_mul_f32 v201, s59, v201
    v_cvt_pk_bf16_f32 v185, v169, v201
    ds_write_b32 v8, v185 offset:288
    v_mul_f32 v170, s58, v170
    v_mul_f32 v202, s59, v202
    v_cvt_pk_bf16_f32 v186, v170, v202
    ds_write_b32 v8, v186 offset:576
    v_mul_f32 v171, s58, v171
    v_mul_f32 v203, s59, v203
    v_cvt_pk_bf16_f32 v187, v171, v203
    ds_write_b32 v8, v187 offset:864
    v_mul_f32 v172, s58, v172
    v_mul_f32 v204, s59, v204
    v_cvt_pk_bf16_f32 v188, v172, v204
    ds_write_b32 v8, v188 offset:1152
    v_mul_f32 v173, s58, v173
    v_mul_f32 v205, s59, v205
    v_cvt_pk_bf16_f32 v189, v173, v205
    ds_write_b32 v8, v189 offset:1440
    v_mul_f32 v174, s58, v174
    v_mul_f32 v206, s59, v206
    v_cvt_pk_bf16_f32 v190, v174, v206
    ds_write_b32 v8, v190 offset:1728
    v_mul_f32 v175, s58, v175
    v_mul_f32 v207, s59, v207
    v_cvt_pk_bf16_f32 v191, v175, v207
    ds_write_b32 v8, v191 offset:2016
    v_mul_f32 v176, s58, v176
    v_mul_f32 v208, s59, v208
    v_cvt_pk_bf16_f32 v192, v176, v208
    ds_write_b32 v8, v192 offset:2304
    v_mul_f32 v177, s58, v177
    v_mul_f32 v209, s59, v209
    v_cvt_pk_bf16_f32 v193, v177, v209
    ds_write_b32 v8, v193 offset:2592
    v_mul_f32 v178, s58, v178
    v_mul_f32 v210, s59, v210
    v_cvt_pk_bf16_f32 v194, v178, v210
    ds_write_b32 v8, v194 offset:2880
    v_mul_f32 v179, s58, v179
    v_mul_f32 v211, s59, v211
    v_cvt_pk_bf16_f32 v195, v179, v211
    ds_write_b32 v8, v195 offset:3168
    v_mul_f32 v180, s58, v180
    v_mul_f32 v212, s59, v212
    v_cvt_pk_bf16_f32 v196, v180, v212
    ds_write_b32 v8, v196 offset:3456
    v_mul_f32 v181, s58, v181
    v_mul_f32 v213, s59, v213
    v_cvt_pk_bf16_f32 v197, v181, v213
    ds_write_b32 v8, v197 offset:3744
    v_mul_f32 v182, s58, v182
    v_mul_f32 v214, s59, v214
    v_cvt_pk_bf16_f32 v198, v182, v214
    ds_write_b32 v8, v198 offset:4032
    v_mul_f32 v183, s58, v183
    v_mul_f32 v215, s59, v215
    v_cvt_pk_bf16_f32 v199, v183, v215
    ds_write_b32 v8, v199 offset:4320
    s_waitcnt lgkmcnt(0)
    s_cmp_lt_u32 s2, 32
    s_cbranch_scc1 L_fa_t0
    v_lshlrev_b32 v5, 2, v1
    v_add_u32 v5, 163776, v5
    v_mov_b32 v6, 1
    ds_write_b32 v5, v6
    v_lshrrev_b32 v5, 4, v2
    v_bfe_u32 v6, v2, 2, 2
    v_and_b32 v7, 3, v2
    v_and_b32 v8, 1, v5
    v_lshl_or_b32 v8, v8, 2, v6
    v_lshl_add_u32 v9, v5, 3, v6
    v_lshlrev_b32 v9, 9, v9
    v_lshl_add_u32 v9, v7, 3, v9
    s_lshl_b32 s36, s18, 8
    v_add_u32 v9, s36, v9
    v_xor_b32 v10, 0, v8
    v_lshl_add_u32 v12, v10, 5, v9
    v_xor_b32 v10, 1, v8
    v_lshl_add_u32 v13, v10, 5, v9
    v_xor_b32 v10, 2, v8
    v_lshl_add_u32 v14, v10, 5, v9
    v_xor_b32 v10, 3, v8
    v_lshl_add_u32 v15, v10, 5, v9
    v_xor_b32 v10, 4, v8
    v_lshl_add_u32 v16, v10, 5, v9
    v_xor_b32 v10, 5, v8
    v_lshl_add_u32 v17, v10, 5, v9
    v_xor_b32 v10, 6, v8
    v_lshl_add_u32 v18, v10, 5, v9
    v_xor_b32 v10, 7, v8
    v_lshl_add_u32 v19, v10, 5, v9
    v_and_b32 v6, 15, v2
    v_lshrrev_b32 v7, 1, v6
    s_lshl_b32 s36, s19, 13
    s_add_u32 s36, s36, 32768
    v_lshl_add_u32 v9, v6, 7, s36
    v_xor_b32 v10, v5, v7
    v_lshl_add_u32 v20, v10, 4, v9
    v_xor_b32 v21, 64, v20
    s_lshl_b32 s36, s18, 9
    s_add_u32 s36, s36, 147456
    v_lshl_add_u32 v3, v5, 4, s36
    s_lshl_b32 s36, s19, 9
    s_add_u32 s36, s36, 149504
    v_lshl_add_u32 v4, v6, 3, s36
    v_lshlrev_b32 v11, 4, v2
    s_lshl_b32 s52, s15, 8
    s_lshl_b32 s36, s18, 7
    s_add_u32 s52, s52, s36
    s_lshl_b32 s53, s14, 7
    s_lshl_b32 s36, s19, 6
    s_add_u32 s53, s53, s36
    s_lshl_b32 s57, s15, 20
    s_lshl_b32 s36, s53, 7
    s_add_u32 s57, s57, s36
    s_lshl_b32 s36, s18, 10
    s_add_u32 s57, s57, s36
    s_mul_i32 s75, s14, 14
    s_add_u32 s75, s75, s15
    s_lshl_b32 s75, s75, 2
    s_add_u32 s75, s75, s16
    s_lshl_b32 s75, s75, 7
    s_add_u32 s75, s75, 15335424
    s_lshl_b32 s36, s19, 13
    s_lshl_b32 s37, s18, 10
    s_add_u32 s36, s36, s37
    s_add_u32 s36, s36, 32768
    v_add_u32 v7, s36, v11
    v_add_u32 v8, 98304, v7
    s_cmp_eq_u32 s13, 4
    s_cselect_b32 s36, s51, 0
    v_add_u32 v7, s36, v7
    s_lshl_b32 s76, s18, 8
    s_add_u32 s76, s76, 49152
    s_lshl_b32 s77, s19, 13
    s_add_u32 s77, s77, 81920
    s_barrier
    ds_read_b64_tr_b16 v[216:217], v12 offset:0
    ds_read_b64_tr_b16 v[218:219], v12 offset:2048
    ds_read_b64_tr_b16 v[220:221], v12 offset:16384
    ds_read_b64_tr_b16 v[222:223], v12 offset:18432
    ds_read_b128 v[152:155], v20 offset:0
    ds_read_b128 v[168:171], v21 offset:0
    ds_read_b128 v[172:175], v21 offset:2048
    ds_read_b128 v[156:159], v20 offset:2048
    ds_read_b128 v[160:163], v20 offset:4096
    ds_read_b128 v[176:179], v21 offset:4096
    ds_read_b128 v[180:183], v21 offset:6144
    ds_read_b128 v[164:167], v20 offset:6144
    ds_read_b64_tr_b16 v[224:225], v13 offset:0
    ds_read_b64_tr_b16 v[226:227], v13 offset:2048
    ds_read_b64_tr_b16 v[228:229], v13 offset:16384
    ds_read_b64_tr_b16 v[230:231], v13 offset:18432
    ds_read_b64_tr_b16 v[232:233], v14 offset:0
    ds_read_b64_tr_b16 v[234:235], v14 offset:2048
    ds_read_b64_tr_b16 v[236:237], v14 offset:16384
    ds_read_b64_tr_b16 v[238:239], v14 offset:18432
    s_waitcnt lgkmcnt(8)
    v_mfma_f32_16x16x32_bf16 v[24:27], v[216:219], v[152:155], 0
    ds_read_b64_tr_b16 v[240:241], v15 offset:0
    s_add_u32 s48, s48, 1
    s_cmp_eq_u32 s48, 3
    s_cselect_b32 s49, s50, s51
    s_cselect_b32 s48, 0, s48
    v_mfma_f32_16x16x32_bf16 v[24:27], v[220:223], v[168:171], v[24:27]
    ds_read_b64_tr_b16 v[242:243], v15 offset:2048
    v_mfma_f32_16x16x32_bf16 v[28:31], v[220:223], v[172:175], 0
    ds_read_b64_tr_b16 v[244:245], v15 offset:16384
    v_mfma_f32_16x16x32_bf16 v[28:31], v[216:219], v[156:159], v[28:31]
    ds_read_b64_tr_b16 v[246:247], v15 offset:18432
    v_mfma_f32_16x16x32_bf16 v[32:35], v[216:219], v[160:163], 0
    v_add_u32 v15, s49, v15
    v_mfma_f32_16x16x32_bf16 v[32:35], v[220:223], v[176:179], v[32:35]
    v_add_u32 v12, s49, v12
    v_mfma_f32_16x16x32_bf16 v[36:39], v[220:223], v[180:183], 0
    v_add_u32 v13, s49, v13
    v_mfma_f32_16x16x32_bf16 v[36:39], v[216:219], v[164:167], v[36:39]
    s_waitcnt lgkmcnt(8)
    v_mfma_f32_16x16x32_bf16 v[52:55], v[224:227], v[164:167], 0
    ds_read_b64_tr_b16 v[216:217], v16 offset:0
    v_mfma_f32_16x16x32_bf16 v[52:55], v[228:231], v[180:183], v[52:55]
    ds_read_b64_tr_b16 v[218:219], v16 offset:2048
    v_mfma_f32_16x16x32_bf16 v[48:51], v[228:231], v[176:179], 0
    ds_read_b64_tr_b16 v[220:221], v16 offset:16384
    v_mfma_f32_16x16x32_bf16 v[48:51], v[224:227], v[160:163], v[48:51]
    ds_read_b64_tr_b16 v[222:223], v16 offset:18432
    v_mfma_f32_16x16x32_bf16 v[44:47], v[224:227], v[156:159], 0
    v_add_u32 v16, s49, v16
    v_mfma_f32_16x16x32_bf16 v[44:47], v[228:231], v[172:175], v[44:47]
    v_add_u32 v20, s49, v20
    v_mfma_f32_16x16x32_bf16 v[40:43], v[228:231], v[168:171], 0
    v_add_u32 v21, s49, v21
    v_mfma_f32_16x16x32_bf16 v[40:43], v[224:227], v[152:155], v[40:43]
    s_waitcnt lgkmcnt(8)
    v_mfma_f32_16x16x32_bf16 v[56:59], v[232:235], v[152:155], 0
    ds_read_b64_tr_b16 v[224:225], v17 offset:0
    v_mfma_f32_16x16x32_bf16 v[56:59], v[236:239], v[168:171], v[56:59]
    ds_read_b64_tr_b16 v[226:227], v17 offset:2048
    v_mfma_f32_16x16x32_bf16 v[60:63], v[236:239], v[172:175], 0
    ds_read_b64_tr_b16 v[228:229], v17 offset:16384
    v_mfma_f32_16x16x32_bf16 v[60:63], v[232:235], v[156:159], v[60:63]
    ds_read_b64_tr_b16 v[230:231], v17 offset:18432
    v_mfma_f32_16x16x32_bf16 v[64:67], v[232:235], v[160:163], 0
    v_add_u32 v17, s49, v17
    v_mfma_f32_16x16x32_bf16 v[64:67], v[236:239], v[176:179], v[64:67]
    v_add_u32 v14, s49, v14
    v_mfma_f32_16x16x32_bf16 v[68:71], v[236:239], v[180:183], 0
    v_mfma_f32_16x16x32_bf16 v[68:71], v[232:235], v[164:167], v[68:71]
    s_waitcnt lgkmcnt(8)
    v_mfma_f32_16x16x32_bf16 v[84:87], v[240:243], v[164:167], 0
    ds_read_b64_tr_b16 v[232:233], v18 offset:0
    v_mfma_f32_16x16x32_bf16 v[84:87], v[244:247], v[180:183], v[84:87]
    ds_read_b64_tr_b16 v[234:235], v18 offset:2048
    v_mfma_f32_16x16x32_bf16 v[80:83], v[244:247], v[176:179], 0
    ds_read_b64_tr_b16 v[236:237], v18 offset:16384
    v_mfma_f32_16x16x32_bf16 v[80:83], v[240:243], v[160:163], v[80:83]
    ds_read_b64_tr_b16 v[238:239], v18 offset:18432
    v_mfma_f32_16x16x32_bf16 v[76:79], v[240:243], v[156:159], 0
    v_add_u32 v18, s49, v18
    v_mfma_f32_16x16x32_bf16 v[76:79], v[244:247], v[172:175], v[76:79]
    v_mfma_f32_16x16x32_bf16 v[72:75], v[244:247], v[168:171], 0
    v_mfma_f32_16x16x32_bf16 v[72:75], v[240:243], v[152:155], v[72:75]
    s_waitcnt lgkmcnt(8)
    v_mfma_f32_16x16x32_bf16 v[88:91], v[216:219], v[152:155], 0
    ds_read_b64_tr_b16 v[240:241], v19 offset:0
    v_mfma_f32_16x16x32_bf16 v[88:91], v[220:223], v[168:171], v[88:91]
    ds_read_b64_tr_b16 v[242:243], v19 offset:2048
    v_mfma_f32_16x16x32_bf16 v[92:95], v[220:223], v[172:175], 0
    ds_read_b64_tr_b16 v[244:245], v19 offset:16384
    v_mfma_f32_16x16x32_bf16 v[92:95], v[216:219], v[156:159], v[92:95]
    ds_read_b64_tr_b16 v[246:247], v19 offset:18432
    v_mfma_f32_16x16x32_bf16 v[96:99], v[216:219], v[160:163], 0
    v_add_u32 v19, s49, v19
    v_mfma_f32_16x16x32_bf16 v[96:99], v[220:223], v[176:179], v[96:99]
    v_mfma_f32_16x16x32_bf16 v[100:103], v[220:223], v[180:183], 0
    v_mfma_f32_16x16x32_bf16 v[100:103], v[216:219], v[164:167], v[100:103]
    s_waitcnt lgkmcnt(0)
    s_barrier
    v_mfma_f32_16x16x32_bf16 v[116:119], v[224:227], v[164:167], 0
    ds_read_b64_tr_b16 v[216:217], v12 offset:0
    v_mfma_f32_16x16x32_bf16 v[116:119], v[228:231], v[180:183], v[116:119]
    ds_read_b64_tr_b16 v[218:219], v12 offset:2048
    v_mfma_f32_16x16x32_bf16 v[112:115], v[228:231], v[176:179], 0
    ds_read_b64_tr_b16 v[220:221], v12 offset:16384
    v_mfma_f32_16x16x32_bf16 v[112:115], v[224:227], v[160:163], v[112:115]
    ds_read_b64_tr_b16 v[222:223], v12 offset:18432
    v_mfma_f32_16x16x32_bf16 v[108:111], v[224:227], v[156:159], 0
    ds_read_b128 v[184:187], v20 offset:0
    v_mfma_f32_16x16x32_bf16 v[108:111], v[228:231], v[172:175], v[108:111]
    ds_read_b128 v[200:203], v21 offset:0
    v_mfma_f32_16x16x32_bf16 v[104:107], v[228:231], v[168:171], 0
    ds_read_b128 v[204:207], v21 offset:2048
    v_mfma_f32_16x16x32_bf16 v[104:107], v[224:227], v[152:155], v[104:107]
    ds_read_b128 v[188:191], v20 offset:2048
    v_mfma_f32_16x16x32_bf16 v[120:123], v[232:235], v[152:155], 0
    ds_read_b128 v[192:195], v20 offset:4096
    v_mfma_f32_16x16x32_bf16 v[120:123], v[236:239], v[168:171], v[120:123]
    ds_read_b128 v[208:211], v21 offset:4096
    v_mfma_f32_16x16x32_bf16 v[124:127], v[236:239], v[172:175], 0
    ds_read_b128 v[212:215], v21 offset:6144
    v_mfma_f32_16x16x32_bf16 v[124:127], v[232:235], v[156:159], v[124:127]
    ds_read_b128 v[196:199], v20 offset:6144
    v_mfma_f32_16x16x32_bf16 v[128:131], v[232:235], v[160:163], 0
    ds_read_b64_tr_b16 v[224:225], v13 offset:0
    v_mfma_f32_16x16x32_bf16 v[128:131], v[236:239], v[176:179], v[128:131]
    ds_read_b64_tr_b16 v[226:227], v13 offset:2048
    v_mfma_f32_16x16x32_bf16 v[132:135], v[236:239], v[180:183], 0
    ds_read_b64_tr_b16 v[228:229], v13 offset:16384
    v_mfma_f32_16x16x32_bf16 v[132:135], v[232:235], v[164:167], v[132:135]
    ds_read_b64_tr_b16 v[230:231], v13 offset:18432
    v_mfma_f32_16x16x32_bf16 v[148:151], v[240:243], v[164:167], 0
    ds_read_b64_tr_b16 v[232:233], v14 offset:0
    v_mfma_f32_16x16x32_bf16 v[148:151], v[244:247], v[180:183], v[148:151]
    ds_read_b64_tr_b16 v[234:235], v14 offset:2048
    v_mfma_f32_16x16x32_bf16 v[144:147], v[244:247], v[176:179], 0
    ds_read_b64_tr_b16 v[236:237], v14 offset:16384
    v_mfma_f32_16x16x32_bf16 v[144:147], v[240:243], v[160:163], v[144:147]
    ds_read_b64_tr_b16 v[238:239], v14 offset:18432
    v_mfma_f32_16x16x32_bf16 v[140:143], v[240:243], v[156:159], 0
    v_mfma_f32_16x16x32_bf16 v[140:143], v[244:247], v[172:175], v[140:143]
    v_mfma_f32_16x16x32_bf16 v[136:139], v[244:247], v[168:171], 0
    v_mfma_f32_16x16x32_bf16 v[136:139], v[240:243], v[152:155], v[136:139]
    s_mov_b32 s47, 14
.p2alignl 6, 0xbf800000
L_g1_loop:
    s_waitcnt lgkmcnt(8)
    v_mfma_f32_16x16x32_bf16 v[24:27], v[216:219], v[184:187], v[24:27]
    ds_read_b64_tr_b16 v[240:241], v15 offset:0
    s_add_u32 s48, s48, 1
    s_cmp_eq_u32 s48, 3
    s_cselect_b32 s49, s50, s51
    s_cselect_b32 s48, 0, s48
    v_mfma_f32_16x16x32_bf16 v[24:27], v[220:223], v[200:203], v[24:27]
    ds_read_b64_tr_b16 v[242:243], v15 offset:2048
    v_mfma_f32_16x16x32_bf16 v[28:31], v[220:223], v[204:207], v[28:31]
    ds_read_b64_tr_b16 v[244:245], v15 offset:16384
    v_mfma_f32_16x16x32_bf16 v[28:31], v[216:219], v[188:191], v[28:31]
    ds_read_b64_tr_b16 v[246:247], v15 offset:18432
    v_mfma_f32_16x16x32_bf16 v[32:35], v[216:219], v[192:195], v[32:35]
    v_add_u32 v15, s49, v15
    v_mfma_f32_16x16x32_bf16 v[32:35], v[220:223], v[208:211], v[32:35]
    v_add_u32 v12, s49, v12
    v_mfma_f32_16x16x32_bf16 v[36:39], v[220:223], v[212:215], v[36:39]
    v_add_u32 v13, s49, v13
    v_mfma_f32_16x16x32_bf16 v[36:39], v[216:219], v[196:199], v[36:39]
    s_waitcnt lgkmcnt(8)
    v_mfma_f32_16x16x32_bf16 v[52:55], v[224:227], v[196:199], v[52:55]
    ds_read_b64_tr_b16 v[216:217], v16 offset:0
    v_mfma_f32_16x16x32_bf16 v[52:55], v[228:231], v[212:215], v[52:55]
    ds_read_b64_tr_b16 v[218:219], v16 offset:2048
    v_mfma_f32_16x16x32_bf16 v[48:51], v[228:231], v[208:211], v[48:51]
    ds_read_b64_tr_b16 v[220:221], v16 offset:16384
    v_mfma_f32_16x16x32_bf16 v[48:51], v[224:227], v[192:195], v[48:51]
    ds_read_b64_tr_b16 v[222:223], v16 offset:18432
    v_mfma_f32_16x16x32_bf16 v[44:47], v[224:227], v[188:191], v[44:47]
    v_add_u32 v16, s49, v16
    v_mfma_f32_16x16x32_bf16 v[44:47], v[228:231], v[204:207], v[44:47]
    v_add_u32 v20, s49, v20
    v_mfma_f32_16x16x32_bf16 v[40:43], v[228:231], v[200:203], v[40:43]
    v_add_u32 v21, s49, v21
    v_mfma_f32_16x16x32_bf16 v[40:43], v[224:227], v[184:187], v[40:43]
    s_waitcnt lgkmcnt(8)
    v_mfma_f32_16x16x32_bf16 v[56:59], v[232:235], v[184:187], v[56:59]
    ds_read_b64_tr_b16 v[224:225], v17 offset:0
    v_mfma_f32_16x16x32_bf16 v[56:59], v[236:239], v[200:203], v[56:59]
    ds_read_b64_tr_b16 v[226:227], v17 offset:2048
    v_mfma_f32_16x16x32_bf16 v[60:63], v[236:239], v[204:207], v[60:63]
    ds_read_b64_tr_b16 v[228:229], v17 offset:16384
    v_mfma_f32_16x16x32_bf16 v[60:63], v[232:235], v[188:191], v[60:63]
    ds_read_b64_tr_b16 v[230:231], v17 offset:18432
    v_mfma_f32_16x16x32_bf16 v[64:67], v[232:235], v[192:195], v[64:67]
    v_add_u32 v17, s49, v17
    v_mfma_f32_16x16x32_bf16 v[64:67], v[236:239], v[208:211], v[64:67]
    v_add_u32 v14, s49, v14
    v_mfma_f32_16x16x32_bf16 v[68:71], v[236:239], v[212:215], v[68:71]
    v_mfma_f32_16x16x32_bf16 v[68:71], v[232:235], v[196:199], v[68:71]
    s_waitcnt lgkmcnt(8)
    v_mfma_f32_16x16x32_bf16 v[84:87], v[240:243], v[196:199], v[84:87]
    ds_read_b64_tr_b16 v[232:233], v18 offset:0
    v_mfma_f32_16x16x32_bf16 v[84:87], v[244:247], v[212:215], v[84:87]
    ds_read_b64_tr_b16 v[234:235], v18 offset:2048
    v_mfma_f32_16x16x32_bf16 v[80:83], v[244:247], v[208:211], v[80:83]
    ds_read_b64_tr_b16 v[236:237], v18 offset:16384
    v_mfma_f32_16x16x32_bf16 v[80:83], v[240:243], v[192:195], v[80:83]
    ds_read_b64_tr_b16 v[238:239], v18 offset:18432
    v_mfma_f32_16x16x32_bf16 v[76:79], v[240:243], v[188:191], v[76:79]
    v_add_u32 v18, s49, v18
    v_mfma_f32_16x16x32_bf16 v[76:79], v[244:247], v[204:207], v[76:79]
    v_mfma_f32_16x16x32_bf16 v[72:75], v[244:247], v[200:203], v[72:75]
    v_mfma_f32_16x16x32_bf16 v[72:75], v[240:243], v[184:187], v[72:75]
    s_waitcnt lgkmcnt(8)
    v_mfma_f32_16x16x32_bf16 v[88:91], v[216:219], v[184:187], v[88:91]
    ds_read_b64_tr_b16 v[240:241], v19 offset:0
    v_mfma_f32_16x16x32_bf16 v[88:91], v[220:223], v[200:203], v[88:91]
    ds_read_b64_tr_b16 v[242:243], v19 offset:2048
    v_mfma_f32_16x16x32_bf16 v[92:95], v[220:223], v[204:207], v[92:95]
    ds_read_b64_tr_b16 v[244:245], v19 offset:16384
    v_mfma_f32_16x16x32_bf16 v[92:95], v[216:219], v[188:191], v[92:95]
    ds_read_b64_tr_b16 v[246:247], v19 offset:18432
    v_mfma_f32_16x16x32_bf16 v[96:99], v[216:219], v[192:195], v[96:99]
    v_add_u32 v19, s49, v19
    v_mfma_f32_16x16x32_bf16 v[96:99], v[220:223], v[208:211], v[96:99]
    v_mfma_f32_16x16x32_bf16 v[100:103], v[220:223], v[212:215], v[100:103]
    v_mfma_f32_16x16x32_bf16 v[100:103], v[216:219], v[196:199], v[100:103]
    s_waitcnt lgkmcnt(0)
    s_barrier
    v_mfma_f32_16x16x32_bf16 v[116:119], v[224:227], v[196:199], v[116:119]
    ds_read_b64_tr_b16 v[216:217], v12 offset:0
    v_mfma_f32_16x16x32_bf16 v[116:119], v[228:231], v[212:215], v[116:119]
    ds_read_b64_tr_b16 v[218:219], v12 offset:2048
    v_mfma_f32_16x16x32_bf16 v[112:115], v[228:231], v[208:211], v[112:115]
    ds_read_b64_tr_b16 v[220:221], v12 offset:16384
    v_mfma_f32_16x16x32_bf16 v[112:115], v[224:227], v[192:195], v[112:115]
    ds_read_b64_tr_b16 v[222:223], v12 offset:18432
    v_mfma_f32_16x16x32_bf16 v[108:111], v[224:227], v[188:191], v[108:111]
    ds_read_b128 v[152:155], v20 offset:0
    v_mfma_f32_16x16x32_bf16 v[108:111], v[228:231], v[204:207], v[108:111]
    ds_read_b128 v[168:171], v21 offset:0
    v_mfma_f32_16x16x32_bf16 v[104:107], v[228:231], v[200:203], v[104:107]
    ds_read_b128 v[172:175], v21 offset:2048
    v_mfma_f32_16x16x32_bf16 v[104:107], v[224:227], v[184:187], v[104:107]
    ds_read_b128 v[156:159], v20 offset:2048
    v_mfma_f32_16x16x32_bf16 v[120:123], v[232:235], v[184:187], v[120:123]
    ds_read_b128 v[160:163], v20 offset:4096
    v_mfma_f32_16x16x32_bf16 v[120:123], v[236:239], v[200:203], v[120:123]
    ds_read_b128 v[176:179], v21 offset:4096
    v_mfma_f32_16x16x32_bf16 v[124:127], v[236:239], v[204:207], v[124:127]
    ds_read_b128 v[180:183], v21 offset:6144
    v_mfma_f32_16x16x32_bf16 v[124:127], v[232:235], v[188:191], v[124:127]
    ds_read_b128 v[164:167], v20 offset:6144
    v_mfma_f32_16x16x32_bf16 v[128:131], v[232:235], v[192:195], v[128:131]
    ds_read_b64_tr_b16 v[224:225], v13 offset:0
    v_mfma_f32_16x16x32_bf16 v[128:131], v[236:239], v[208:211], v[128:131]
    ds_read_b64_tr_b16 v[226:227], v13 offset:2048
    v_mfma_f32_16x16x32_bf16 v[132:135], v[236:239], v[212:215], v[132:135]
    ds_read_b64_tr_b16 v[228:229], v13 offset:16384
    v_mfma_f32_16x16x32_bf16 v[132:135], v[232:235], v[196:199], v[132:135]
    ds_read_b64_tr_b16 v[230:231], v13 offset:18432
    v_mfma_f32_16x16x32_bf16 v[148:151], v[240:243], v[196:199], v[148:151]
    ds_read_b64_tr_b16 v[232:233], v14 offset:0
    v_mfma_f32_16x16x32_bf16 v[148:151], v[244:247], v[212:215], v[148:151]
    ds_read_b64_tr_b16 v[234:235], v14 offset:2048
    v_mfma_f32_16x16x32_bf16 v[144:147], v[244:247], v[208:211], v[144:147]
    ds_read_b64_tr_b16 v[236:237], v14 offset:16384
    v_mfma_f32_16x16x32_bf16 v[144:147], v[240:243], v[192:195], v[144:147]
    ds_read_b64_tr_b16 v[238:239], v14 offset:18432
    v_mfma_f32_16x16x32_bf16 v[140:143], v[240:243], v[188:191], v[140:143]
    v_mfma_f32_16x16x32_bf16 v[140:143], v[244:247], v[204:207], v[140:143]
    s_sub_u32 s47, s47, 1
    s_cmp_lg_u32 s47, 0
    v_mfma_f32_16x16x32_bf16 v[136:139], v[244:247], v[200:203], v[136:139]
    v_mfma_f32_16x16x32_bf16 v[136:139], v[240:243], v[184:187], v[136:139]
    s_waitcnt lgkmcnt(8)
    v_mfma_f32_16x16x32_bf16 v[24:27], v[216:219], v[152:155], v[24:27]
    ds_read_b64_tr_b16 v[240:241], v15 offset:0
    s_add_u32 s48, s48, 1
    s_cmp_eq_u32 s48, 3
    s_cselect_b32 s49, s50, s51
    s_cselect_b32 s48, 0, s48
    v_mfma_f32_16x16x32_bf16 v[24:27], v[220:223], v[168:171], v[24:27]
    ds_read_b64_tr_b16 v[242:243], v15 offset:2048
    v_mfma_f32_16x16x32_bf16 v[28:31], v[220:223], v[172:175], v[28:31]
    ds_read_b64_tr_b16 v[244:245], v15 offset:16384
    v_mfma_f32_16x16x32_bf16 v[28:31], v[216:219], v[156:159], v[28:31]
    ds_read_b64_tr_b16 v[246:247], v15 offset:18432
    v_mfma_f32_16x16x32_bf16 v[32:35], v[216:219], v[160:163], v[32:35]
    v_add_u32 v15, s49, v15
    v_mfma_f32_16x16x32_bf16 v[32:35], v[220:223], v[176:179], v[32:35]
    v_add_u32 v12, s49, v12
    v_mfma_f32_16x16x32_bf16 v[36:39], v[220:223], v[180:183], v[36:39]
    v_add_u32 v13, s49, v13
    v_mfma_f32_16x16x32_bf16 v[36:39], v[216:219], v[164:167], v[36:39]
    s_waitcnt lgkmcnt(8)
    v_mfma_f32_16x16x32_bf16 v[52:55], v[224:227], v[164:167], v[52:55]
    ds_read_b64_tr_b16 v[216:217], v16 offset:0
    v_mfma_f32_16x16x32_bf16 v[52:55], v[228:231], v[180:183], v[52:55]
    ds_read_b64_tr_b16 v[218:219], v16 offset:2048
    v_mfma_f32_16x16x32_bf16 v[48:51], v[228:231], v[176:179], v[48:51]
    ds_read_b64_tr_b16 v[220:221], v16 offset:16384
    v_mfma_f32_16x16x32_bf16 v[48:51], v[224:227], v[160:163], v[48:51]
    ds_read_b64_tr_b16 v[222:223], v16 offset:18432
    v_mfma_f32_16x16x32_bf16 v[44:47], v[224:227], v[156:159], v[44:47]
    v_add_u32 v16, s49, v16
    v_mfma_f32_16x16x32_bf16 v[44:47], v[228:231], v[172:175], v[44:47]
    v_add_u32 v20, s49, v20
    v_mfma_f32_16x16x32_bf16 v[40:43], v[228:231], v[168:171], v[40:43]
    v_add_u32 v21, s49, v21
    v_mfma_f32_16x16x32_bf16 v[40:43], v[224:227], v[152:155], v[40:43]
    s_waitcnt lgkmcnt(8)
    v_mfma_f32_16x16x32_bf16 v[56:59], v[232:235], v[152:155], v[56:59]
    ds_read_b64_tr_b16 v[224:225], v17 offset:0
    v_mfma_f32_16x16x32_bf16 v[56:59], v[236:239], v[168:171], v[56:59]
    ds_read_b64_tr_b16 v[226:227], v17 offset:2048
    v_mfma_f32_16x16x32_bf16 v[60:63], v[236:239], v[172:175], v[60:63]
    ds_read_b64_tr_b16 v[228:229], v17 offset:16384
    v_mfma_f32_16x16x32_bf16 v[60:63], v[232:235], v[156:159], v[60:63]
    ds_read_b64_tr_b16 v[230:231], v17 offset:18432
    v_mfma_f32_16x16x32_bf16 v[64:67], v[232:235], v[160:163], v[64:67]
    v_add_u32 v17, s49, v17
    v_mfma_f32_16x16x32_bf16 v[64:67], v[236:239], v[176:179], v[64:67]
    v_add_u32 v14, s49, v14
    v_mfma_f32_16x16x32_bf16 v[68:71], v[236:239], v[180:183], v[68:71]
    v_mfma_f32_16x16x32_bf16 v[68:71], v[232:235], v[164:167], v[68:71]
    s_waitcnt lgkmcnt(8)
    v_mfma_f32_16x16x32_bf16 v[84:87], v[240:243], v[164:167], v[84:87]
    ds_read_b64_tr_b16 v[232:233], v18 offset:0
    v_mfma_f32_16x16x32_bf16 v[84:87], v[244:247], v[180:183], v[84:87]
    ds_read_b64_tr_b16 v[234:235], v18 offset:2048
    v_mfma_f32_16x16x32_bf16 v[80:83], v[244:247], v[176:179], v[80:83]
    ds_read_b64_tr_b16 v[236:237], v18 offset:16384
    v_mfma_f32_16x16x32_bf16 v[80:83], v[240:243], v[160:163], v[80:83]
    ds_read_b64_tr_b16 v[238:239], v18 offset:18432
    v_mfma_f32_16x16x32_bf16 v[76:79], v[240:243], v[156:159], v[76:79]
    v_add_u32 v18, s49, v18
    v_mfma_f32_16x16x32_bf16 v[76:79], v[244:247], v[172:175], v[76:79]
    v_mfma_f32_16x16x32_bf16 v[72:75], v[244:247], v[168:171], v[72:75]
    v_mfma_f32_16x16x32_bf16 v[72:75], v[240:243], v[152:155], v[72:75]
    s_waitcnt lgkmcnt(8)
    v_mfma_f32_16x16x32_bf16 v[88:91], v[216:219], v[152:155], v[88:91]
    ds_read_b64_tr_b16 v[240:241], v19 offset:0
    v_mfma_f32_16x16x32_bf16 v[88:91], v[220:223], v[168:171], v[88:91]
    ds_read_b64_tr_b16 v[242:243], v19 offset:2048
    v_mfma_f32_16x16x32_bf16 v[92:95], v[220:223], v[172:175], v[92:95]
    ds_read_b64_tr_b16 v[244:245], v19 offset:16384
    v_mfma_f32_16x16x32_bf16 v[92:95], v[216:219], v[156:159], v[92:95]
    ds_read_b64_tr_b16 v[246:247], v19 offset:18432
    v_mfma_f32_16x16x32_bf16 v[96:99], v[216:219], v[160:163], v[96:99]
    v_add_u32 v19, s49, v19
    v_mfma_f32_16x16x32_bf16 v[96:99], v[220:223], v[176:179], v[96:99]
    v_mfma_f32_16x16x32_bf16 v[100:103], v[220:223], v[180:183], v[100:103]
    v_mfma_f32_16x16x32_bf16 v[100:103], v[216:219], v[164:167], v[100:103]
    s_waitcnt lgkmcnt(0)
    s_barrier
    v_mfma_f32_16x16x32_bf16 v[116:119], v[224:227], v[164:167], v[116:119]
    ds_read_b64_tr_b16 v[216:217], v12 offset:0
    v_mfma_f32_16x16x32_bf16 v[116:119], v[228:231], v[180:183], v[116:119]
    ds_read_b64_tr_b16 v[218:219], v12 offset:2048
    v_mfma_f32_16x16x32_bf16 v[112:115], v[228:231], v[176:179], v[112:115]
    ds_read_b64_tr_b16 v[220:221], v12 offset:16384
    v_mfma_f32_16x16x32_bf16 v[112:115], v[224:227], v[160:163], v[112:115]
    ds_read_b64_tr_b16 v[222:223], v12 offset:18432
    v_mfma_f32_16x16x32_bf16 v[108:111], v[224:227], v[156:159], v[108:111]
    ds_read_b128 v[184:187], v20 offset:0
    v_mfma_f32_16x16x32_bf16 v[108:111], v[228:231], v[172:175], v[108:111]
    ds_read_b128 v[200:203], v21 offset:0
    v_mfma_f32_16x16x32_bf16 v[104:107], v[228:231], v[168:171], v[104:107]
    ds_read_b128 v[204:207], v21 offset:2048
    v_mfma_f32_16x16x32_bf16 v[104:107], v[224:227], v[152:155], v[104:107]
    ds_read_b128 v[188:191], v20 offset:2048
    v_mfma_f32_16x16x32_bf16 v[120:123], v[232:235], v[152:155], v[120:123]
    ds_read_b128 v[192:195], v20 offset:4096
    v_mfma_f32_16x16x32_bf16 v[120:123], v[236:239], v[168:171], v[120:123]
    ds_read_b128 v[208:211], v21 offset:4096
    v_mfma_f32_16x16x32_bf16 v[124:127], v[236:239], v[172:175], v[124:127]
    ds_read_b128 v[212:215], v21 offset:6144
    v_mfma_f32_16x16x32_bf16 v[124:127], v[232:235], v[156:159], v[124:127]
    ds_read_b128 v[196:199], v20 offset:6144
    v_mfma_f32_16x16x32_bf16 v[128:131], v[232:235], v[160:163], v[128:131]
    ds_read_b64_tr_b16 v[224:225], v13 offset:0
    v_mfma_f32_16x16x32_bf16 v[128:131], v[236:239], v[176:179], v[128:131]
    ds_read_b64_tr_b16 v[226:227], v13 offset:2048
    v_mfma_f32_16x16x32_bf16 v[132:135], v[236:239], v[180:183], v[132:135]
    ds_read_b64_tr_b16 v[228:229], v13 offset:16384
    v_mfma_f32_16x16x32_bf16 v[132:135], v[232:235], v[164:167], v[132:135]
    ds_read_b64_tr_b16 v[230:231], v13 offset:18432
    v_mfma_f32_16x16x32_bf16 v[148:151], v[240:243], v[164:167], v[148:151]
    ds_read_b64_tr_b16 v[232:233], v14 offset:0
    v_mfma_f32_16x16x32_bf16 v[148:151], v[244:247], v[180:183], v[148:151]
    ds_read_b64_tr_b16 v[234:235], v14 offset:2048
    v_mfma_f32_16x16x32_bf16 v[144:147], v[244:247], v[176:179], v[144:147]
    ds_read_b64_tr_b16 v[236:237], v14 offset:16384
    v_mfma_f32_16x16x32_bf16 v[144:147], v[240:243], v[160:163], v[144:147]
    ds_read_b64_tr_b16 v[238:239], v14 offset:18432
    v_mfma_f32_16x16x32_bf16 v[140:143], v[240:243], v[156:159], v[140:143]
    v_mfma_f32_16x16x32_bf16 v[140:143], v[244:247], v[172:175], v[140:143]
    s_sub_u32 s47, s47, 1
    s_cmp_lg_u32 s47, 0
    v_mfma_f32_16x16x32_bf16 v[136:139], v[244:247], v[168:171], v[136:139]
    v_mfma_f32_16x16x32_bf16 v[136:139], v[240:243], v[152:155], v[136:139]
    s_cbranch_scc1 L_g1_loop
    s_waitcnt lgkmcnt(8)
    v_mfma_f32_16x16x32_bf16 v[24:27], v[216:219], v[184:187], v[24:27]
    ds_read_b64_tr_b16 v[240:241], v15 offset:0
    v_mfma_f32_16x16x32_bf16 v[24:27], v[220:223], v[200:203], v[24:27]
    ds_read_b64_tr_b16 v[242:243], v15 offset:2048
    v_mfma_f32_16x16x32_bf16 v[28:31], v[220:223], v[204:207], v[28:31]
    ds_read_b64_tr_b16 v[244:245], v15 offset:16384
    v_mfma_f32_16x16x32_bf16 v[28:31], v[216:219], v[188:191], v[28:31]
    ds_read_b64_tr_b16 v[246:247], v15 offset:18432
    v_mfma_f32_16x16x32_bf16 v[32:35], v[216:219], v[192:195], v[32:35]
    v_mfma_f32_16x16x32_bf16 v[32:35], v[220:223], v[208:211], v[32:35]
    v_mfma_f32_16x16x32_bf16 v[36:39], v[220:223], v[212:215], v[36:39]
    v_mfma_f32_16x16x32_bf16 v[36:39], v[216:219], v[196:199], v[36:39]
    s_waitcnt lgkmcnt(8)
    v_mfma_f32_16x16x32_bf16 v[52:55], v[224:227], v[196:199], v[52:55]
    ds_read_b64_tr_b16 v[216:217], v16 offset:0
    v_mfma_f32_16x16x32_bf16 v[52:55], v[228:231], v[212:215], v[52:55]
    ds_read_b64_tr_b16 v[218:219], v16 offset:2048
    v_mfma_f32_16x16x32_bf16 v[48:51], v[228:231], v[208:211], v[48:51]
    ds_read_b64_tr_b16 v[220:221], v16 offset:16384
    v_mfma_f32_16x16x32_bf16 v[48:51], v[224:227], v[192:195], v[48:51]
    ds_read_b64_tr_b16 v[222:223], v16 offset:18432
    v_mfma_f32_16x16x32_bf16 v[44:47], v[224:227], v[188:191], v[44:47]
    v_mfma_f32_16x16x32_bf16 v[44:47], v[228:231], v[204:207], v[44:47]
    v_mfma_f32_16x16x32_bf16 v[40:43], v[228:231], v[200:203], v[40:43]
    v_mfma_f32_16x16x32_bf16 v[40:43], v[224:227], v[184:187], v[40:43]
    s_waitcnt lgkmcnt(8)
    v_mfma_f32_16x16x32_bf16 v[56:59], v[232:235], v[184:187], v[56:59]
    ds_read_b64_tr_b16 v[224:225], v17 offset:0
    v_mfma_f32_16x16x32_bf16 v[56:59], v[236:239], v[200:203], v[56:59]
    ds_read_b64_tr_b16 v[226:227], v17 offset:2048
    v_mfma_f32_16x16x32_bf16 v[60:63], v[236:239], v[204:207], v[60:63]
    ds_read_b64_tr_b16 v[228:229], v17 offset:16384
    v_mfma_f32_16x16x32_bf16 v[60:63], v[232:235], v[188:191], v[60:63]
    ds_read_b64_tr_b16 v[230:231], v17 offset:18432
    v_mfma_f32_16x16x32_bf16 v[64:67], v[232:235], v[192:195], v[64:67]
    v_mfma_f32_16x16x32_bf16 v[64:67], v[236:239], v[208:211], v[64:67]
    v_mfma_f32_16x16x32_bf16 v[68:71], v[236:239], v[212:215], v[68:71]
    v_mfma_f32_16x16x32_bf16 v[68:71], v[232:235], v[196:199], v[68:71]
    s_waitcnt lgkmcnt(8)
    v_mfma_f32_16x16x32_bf16 v[84:87], v[240:243], v[196:199], v[84:87]
    ds_read_b64_tr_b16 v[232:233], v18 offset:0
    v_mfma_f32_16x16x32_bf16 v[84:87], v[244:247], v[212:215], v[84:87]
    ds_read_b64_tr_b16 v[234:235], v18 offset:2048
    v_mfma_f32_16x16x32_bf16 v[80:83], v[244:247], v[208:211], v[80:83]
    ds_read_b64_tr_b16 v[236:237], v18 offset:16384
    v_mfma_f32_16x16x32_bf16 v[80:83], v[240:243], v[192:195], v[80:83]
    ds_read_b64_tr_b16 v[238:239], v18 offset:18432
    v_mfma_f32_16x16x32_bf16 v[76:79], v[240:243], v[188:191], v[76:79]
    v_mfma_f32_16x16x32_bf16 v[76:79], v[244:247], v[204:207], v[76:79]
    v_mfma_f32_16x16x32_bf16 v[72:75], v[244:247], v[200:203], v[72:75]
    v_mfma_f32_16x16x32_bf16 v[72:75], v[240:243], v[184:187], v[72:75]
    s_waitcnt lgkmcnt(8)
    v_mfma_f32_16x16x32_bf16 v[88:91], v[216:219], v[184:187], v[88:91]
    ds_read_b64_tr_b16 v[240:241], v19 offset:0
    v_mfma_f32_16x16x32_bf16 v[88:91], v[220:223], v[200:203], v[88:91]
    ds_read_b64_tr_b16 v[242:243], v19 offset:2048
    v_mfma_f32_16x16x32_bf16 v[92:95], v[220:223], v[204:207], v[92:95]
    ds_read_b64_tr_b16 v[244:245], v19 offset:16384
    v_mfma_f32_16x16x32_bf16 v[92:95], v[216:219], v[188:191], v[92:95]
    ds_read_b64_tr_b16 v[246:247], v19 offset:18432
    v_mfma_f32_16x16x32_bf16 v[96:99], v[216:219], v[192:195], v[96:99]
    v_mfma_f32_16x16x32_bf16 v[96:99], v[220:223], v[208:211], v[96:99]
    v_lshrrev_b32 v6, 2, v2
    v_mfma_f32_16x16x32_bf16 v[100:103], v[220:223], v[212:215], v[100:103]
    v_and_b32 v22, 7, v6
    v_mfma_f32_16x16x32_bf16 v[100:103], v[216:219], v[196:199], v[100:103]
    v_and_b32 v10, 3, v2
    s_waitcnt lgkmcnt(0)
    v_mfma_f32_16x16x32_bf16 v[116:119], v[224:227], v[196:199], v[116:119]
    v_lshlrev_b32 v9, 9, v6
    v_mfma_f32_16x16x32_bf16 v[116:119], v[228:231], v[212:215], v[116:119]
    v_lshl_add_u32 v9, v10, 3, v9
    v_mfma_f32_16x16x32_bf16 v[112:115], v[228:231], v[208:211], v[112:115]
    v_add_u32 v9, s76, v9
    v_mfma_f32_16x16x32_bf16 v[112:115], v[224:227], v[192:195], v[112:115]
    v_xor_b32 v10, 0, v22
    v_mfma_f32_16x16x32_bf16 v[108:111], v[224:227], v[188:191], v[108:111]
    v_lshl_add_u32 v12, v10, 5, v9
    v_mfma_f32_16x16x32_bf16 v[108:111], v[228:231], v[204:207], v[108:111]
    v_xor_b32 v10, 1, v22
    v_mfma_f32_16x16x32_bf16 v[104:107], v[228:231], v[200:203], v[104:107]
    v_lshl_add_u32 v13, v10, 5, v9
    v_mfma_f32_16x16x32_bf16 v[104:107], v[224:227], v[184:187], v[104:107]
    v_xor_b32 v10, 2, v22
    v_mfma_f32_16x16x32_bf16 v[120:123], v[232:235], v[184:187], v[120:123]
    ds_read_b64 v[216:217], v4 offset:0
    v_lshl_add_u32 v14, v10, 5, v9
    v_mfma_f32_16x16x32_bf16 v[120:123], v[236:239], v[200:203], v[120:123]
    ds_read_b64 v[218:219], v4 offset:128
    v_xor_b32 v10, 3, v22
    v_mfma_f32_16x16x32_bf16 v[124:127], v[236:239], v[204:207], v[124:127]
    ds_read_b64 v[220:221], v4 offset:256
    v_lshl_add_u32 v15, v10, 5, v9
    v_mfma_f32_16x16x32_bf16 v[124:127], v[232:235], v[188:191], v[124:127]
    ds_read_b64 v[222:223], v4 offset:384
    v_xor_b32 v10, 4, v22
    v_mfma_f32_16x16x32_bf16 v[128:131], v[232:235], v[192:195], v[128:131]
    ds_read_b128 v[152:155], v3 offset:0
    v_lshl_add_u32 v16, v10, 5, v9
    v_mfma_f32_16x16x32_bf16 v[128:131], v[236:239], v[208:211], v[128:131]
    ds_read_b128 v[156:159], v3 offset:64
    v_xor_b32 v10, 5, v22
    v_mfma_f32_16x16x32_bf16 v[132:135], v[236:239], v[212:215], v[132:135]
    ds_read_b128 v[160:163], v3 offset:128
    v_lshl_add_u32 v17, v10, 5, v9
    v_mfma_f32_16x16x32_bf16 v[132:135], v[232:235], v[196:199], v[132:135]
    ds_read_b128 v[164:167], v3 offset:192
    v_xor_b32 v10, 6, v22
    v_mfma_f32_16x16x32_bf16 v[148:151], v[240:243], v[196:199], v[148:151]
    ds_read_b128 v[168:171], v3 offset:256
    v_lshl_add_u32 v18, v10, 5, v9
    v_mfma_f32_16x16x32_bf16 v[148:151], v[244:247], v[212:215], v[148:151]
    ds_read_b128 v[172:175], v3 offset:320
    v_xor_b32 v10, 7, v22
    v_mfma_f32_16x16x32_bf16 v[144:147], v[244:247], v[208:211], v[144:147]
    ds_read_b128 v[176:179], v3 offset:384
    v_lshl_add_u32 v19, v10, 5, v9
    v_mfma_f32_16x16x32_bf16 v[144:147], v[240:243], v[192:195], v[144:147]
    ds_read_b128 v[180:183], v3 offset:448
    v_add_u32 v20, s77, v11
    v_mfma_f32_16x16x32_bf16 v[140:143], v[240:243], v[188:191], v[140:143]
    v_add_u32 v21, 1024, v20
    v_mfma_f32_16x16x32_bf16 v[140:143], v[244:247], v[204:207], v[140:143]
    v_mfma_f32_16x16x32_bf16 v[136:139], v[244:247], v[200:203], v[136:139]
    v_mfma_f32_16x16x32_bf16 v[136:139], v[240:243], v[184:187], v[136:139]
    ds_read_b128 v[184:187], v3 offset:1024
    ds_read_b128 v[188:191], v3 offset:1088
    ds_read_b128 v[192:195], v3 offset:1152
    ds_read_b128 v[196:199], v3 offset:1216
    ds_read_b128 v[200:203], v3 offset:1280
    ds_read_b128 v[204:207], v3 offset:1344
    ds_read_b128 v[208:211], v3 offset:1408
    ds_read_b128 v[212:215], v3 offset:1472
    s_barrier
    v_mov_b32 v9, s74
    v_mov_b32 v5, 0
    s_waitcnt lgkmcnt(8)
    v_mov_b32 v4, v217
    v_mov_b32 v6, v219
    v_mov_b32 v10, v221
    v_mov_b32 v22, v223
    v_pk_fma_f32 v[24:25], v[152:153], v[216:217], v[24:25] op_sel_hi:[1,0,1]
    v_pk_fma_f32 v[26:27], v[154:155], v[216:217], v[26:27] op_sel_hi:[1,0,1]
    v_pk_fma_f32 v[40:41], v[156:157], v[216:217], v[40:41] op_sel_hi:[1,0,1]
    v_pk_fma_f32 v[42:43], v[158:159], v[216:217], v[42:43] op_sel_hi:[1,0,1]
    s_waitcnt lgkmcnt(6)
    v_pk_fma_f32 v[24:25], v[24:25], v[4:5], v[184:185] op_sel_hi:[1,0,1]
    v_pk_fma_f32 v[26:27], v[26:27], v[4:5], v[186:187] op_sel_hi:[1,0,1]
    v_pk_fma_f32 v[40:41], v[40:41], v[4:5], v[188:189] op_sel_hi:[1,0,1]
    v_pk_fma_f32 v[42:43], v[42:43], v[4:5], v[190:191] op_sel_hi:[1,0,1]
    v_exp_f32 v224, v24
    v_exp_f32 v225, v25
    v_exp_f32 v226, v26
    v_exp_f32 v227, v27
    v_exp_f32 v228, v40
    v_exp_f32 v229, v41
    v_exp_f32 v230, v42
    v_exp_f32 v231, v43
    v_pk_fma_f32 v[248:249], v[224:225], 0.5, 1.0 op_sel_hi:[1,0,0]
    v_pk_fma_f32 v[250:251], v[226:227], 0.5, 1.0 op_sel_hi:[1,0,0]
    v_pk_fma_f32 v[252:253], v[228:229], 0.5, 1.0 op_sel_hi:[1,0,0]
    v_pk_fma_f32 v[254:255], v[230:231], 0.5, 1.0 op_sel_hi:[1,0,0]
    v_pk_fma_f32 v[224:225], v[224:225], v[248:249], 1.0 op_sel_hi:[1,1,0]
    v_pk_fma_f32 v[226:227], v[226:227], v[250:251], 1.0 op_sel_hi:[1,1,0]
    v_pk_fma_f32 v[228:229], v[228:229], v[252:253], 1.0 op_sel_hi:[1,1,0]
    v_pk_fma_f32 v[230:231], v[230:231], v[254:255], 1.0 op_sel_hi:[1,1,0]
    v_rcp_f32 v224, v224
    v_rcp_f32 v225, v225
    v_rcp_f32 v226, v226
    v_rcp_f32 v227, v227
    v_rcp_f32 v228, v228
    v_rcp_f32 v229, v229
    v_rcp_f32 v230, v230
    v_rcp_f32 v231, v231
    v_pk_fma_f32 v[224:225], v[24:25], v[224:225], v[24:25] neg_lo:[1,0,0] neg_hi:[1,0,0]
    v_pk_fma_f32 v[226:227], v[26:27], v[226:227], v[26:27] neg_lo:[1,0,0] neg_hi:[1,0,0]
    v_pk_fma_f32 v[228:229], v[40:41], v[228:229], v[40:41] neg_lo:[1,0,0] neg_hi:[1,0,0]
    v_pk_fma_f32 v[230:231], v[42:43], v[230:231], v[42:43] neg_lo:[1,0,0] neg_hi:[1,0,0]
    v_cvt_pk_bf16_f32 v232, v224, v225
    v_cvt_pk_bf16_f32 v233, v226, v227
    v_cvt_pk_bf16_f32 v234, v228, v229
    v_cvt_pk_bf16_f32 v235, v230, v231
    s_add_u32 s37, s57, 0
    buffer_store_dwordx4 v[232:235], v11, s[28:31], s37 offen sc1
    ds_write_b128 v7, v[232:235] offset:49152
    v_pk_fma_f32 v[28:29], v[152:153], v[218:219], v[28:29] op_sel_hi:[1,0,1]
    v_pk_fma_f32 v[30:31], v[154:155], v[218:219], v[30:31] op_sel_hi:[1,0,1]
    v_pk_fma_f32 v[44:45], v[156:157], v[218:219], v[44:45] op_sel_hi:[1,0,1]
    v_pk_fma_f32 v[46:47], v[158:159], v[218:219], v[46:47] op_sel_hi:[1,0,1]
    v_pk_fma_f32 v[28:29], v[28:29], v[6:7], v[184:185] op_sel_hi:[1,0,1]
    v_pk_fma_f32 v[30:31], v[30:31], v[6:7], v[186:187] op_sel_hi:[1,0,1]
    v_pk_fma_f32 v[44:45], v[44:45], v[6:7], v[188:189] op_sel_hi:[1,0,1]
    v_pk_fma_f32 v[46:47], v[46:47], v[6:7], v[190:191] op_sel_hi:[1,0,1]
    v_exp_f32 v236, v28
    v_exp_f32 v237, v29
    v_exp_f32 v238, v30
    v_exp_f32 v239, v31
    v_exp_f32 v240, v44
    v_exp_f32 v241, v45
    v_exp_f32 v242, v46
    v_exp_f32 v243, v47
    v_pk_fma_f32 v[248:249], v[236:237], 0.5, 1.0 op_sel_hi:[1,0,0]
    v_pk_fma_f32 v[250:251], v[238:239], 0.5, 1.0 op_sel_hi:[1,0,0]
    v_pk_fma_f32 v[252:253], v[240:241], 0.5, 1.0 op_sel_hi:[1,0,0]
    v_pk_fma_f32 v[254:255], v[242:243], 0.5, 1.0 op_sel_hi:[1,0,0]
    v_pk_fma_f32 v[236:237], v[236:237], v[248:249], 1.0 op_sel_hi:[1,1,0]
    v_pk_fma_f32 v[238:239], v[238:239], v[250:251], 1.0 op_sel_hi:[1,1,0]
    v_pk_fma_f32 v[240:241], v[240:241], v[252:253], 1.0 op_sel_hi:[1,1,0]
    v_pk_fma_f32 v[242:243], v[242:243], v[254:255], 1.0 op_sel_hi:[1,1,0]
    v_rcp_f32 v236, v236
    v_rcp_f32 v237, v237
    v_rcp_f32 v238, v238
    v_rcp_f32 v239, v239
    v_rcp_f32 v240, v240
    v_rcp_f32 v241, v241
    v_rcp_f32 v242, v242
    v_rcp_f32 v243, v243
    v_pk_fma_f32 v[236:237], v[28:29], v[236:237], v[28:29] neg_lo:[1,0,0] neg_hi:[1,0,0]
    v_pk_fma_f32 v[238:239], v[30:31], v[238:239], v[30:31] neg_lo:[1,0,0] neg_hi:[1,0,0]
    v_pk_fma_f32 v[240:241], v[44:45], v[240:241], v[44:45] neg_lo:[1,0,0] neg_hi:[1,0,0]
    v_pk_fma_f32 v[242:243], v[46:47], v[242:243], v[46:47] neg_lo:[1,0,0] neg_hi:[1,0,0]
    v_cvt_pk_bf16_f32 v244, v236, v237
    v_cvt_pk_bf16_f32 v245, v238, v239
    v_cvt_pk_bf16_f32 v246, v240, v241
    v_cvt_pk_bf16_f32 v247, v242, v243
    s_add_u32 s37, s57, 2048
    buffer_store_dwordx4 v[244:247], v11, s[28:31], s37 offen sc1
    ds_write_b128 v7, v[244:247] offset:51200
    v_pk_fma_f32 v[32:33], v[152:153], v[220:221], v[32:33] op_sel_hi:[1,0,1]
    v_pk_fma_f32 v[34:35], v[154:155], v[220:221], v[34:35] op_sel_hi:[1,0,1]
    v_pk_fma_f32 v[48:49], v[156:157], v[220:221], v[48:49] op_sel_hi:[1,0,1]
    v_pk_fma_f32 v[50:51], v[158:159], v[220:221], v[50:51] op_sel_hi:[1,0,1]
    v_pk_fma_f32 v[32:33], v[32:33], v[10:11], v[184:185] op_sel_hi:[1,0,1]
    v_pk_fma_f32 v[34:35], v[34:35], v[10:11], v[186:187] op_sel_hi:[1,0,1]
    v_pk_fma_f32 v[48:49], v[48:49], v[10:11], v[188:189] op_sel_hi:[1,0,1]
    v_pk_fma_f32 v[50:51], v[50:51], v[10:11], v[190:191] op_sel_hi:[1,0,1]
    v_exp_f32 v224, v32
    v_exp_f32 v225, v33
    v_exp_f32 v226, v34
    v_exp_f32 v227, v35
    v_exp_f32 v228, v48
    v_exp_f32 v229, v49
    v_exp_f32 v230, v50
    v_exp_f32 v231, v51
    v_pk_fma_f32 v[248:249], v[224:225], 0.5, 1.0 op_sel_hi:[1,0,0]
    v_pk_fma_f32 v[250:251], v[226:227], 0.5, 1.0 op_sel_hi:[1,0,0]
    v_pk_fma_f32 v[252:253], v[228:229], 0.5, 1.0 op_sel_hi:[1,0,0]
    v_pk_fma_f32 v[254:255], v[230:231], 0.5, 1.0 op_sel_hi:[1,0,0]
    v_pk_fma_f32 v[224:225], v[224:225], v[248:249], 1.0 op_sel_hi:[1,1,0]
    v_pk_fma_f32 v[226:227], v[226:227], v[250:251], 1.0 op_sel_hi:[1,1,0]
    v_pk_fma_f32 v[228:229], v[228:229], v[252:253], 1.0 op_sel_hi:[1,1,0]
    v_pk_fma_f32 v[230:231], v[230:231], v[254:255], 1.0 op_sel_hi:[1,1,0]
    v_rcp_f32 v224, v224
    v_rcp_f32 v225, v225
    v_rcp_f32 v226, v226
    v_rcp_f32 v227, v227
    v_rcp_f32 v228, v228
    v_rcp_f32 v229, v229
    v_rcp_f32 v230, v230
    v_rcp_f32 v231, v231
    v_pk_fma_f32 v[224:225], v[32:33], v[224:225], v[32:33] neg_lo:[1,0,0] neg_hi:[1,0,0]
    v_pk_fma_f32 v[226:227], v[34:35], v[226:227], v[34:35] neg_lo:[1,0,0] neg_hi:[1,0,0]
    v_pk_fma_f32 v[228:229], v[48:49], v[228:229], v[48:49] neg_lo:[1,0,0] neg_hi:[1,0,0]
    v_pk_fma_f32 v[230:231], v[50:51], v[230:231], v[50:51] neg_lo:[1,0,0] neg_hi:[1,0,0]
    v_cvt_pk_bf16_f32 v232, v224, v225
    v_cvt_pk_bf16_f32 v233, v226, v227
    v_cvt_pk_bf16_f32 v234, v228, v229
    v_cvt_pk_bf16_f32 v235, v230, v231
    s_add_u32 s37, s57, 4096
    buffer_store_dwordx4 v[232:235], v11, s[28:31], s37 offen sc1
    ds_write_b128 v7, v[232:235] offset:53248
    v_pk_fma_f32 v[36:37], v[152:153], v[222:223], v[36:37] op_sel_hi:[1,0,1]
    v_pk_fma_f32 v[38:39], v[154:155], v[222:223], v[38:39] op_sel_hi:[1,0,1]
    v_pk_fma_f32 v[52:53], v[156:157], v[222:223], v[52:53] op_sel_hi:[1,0,1]
    v_pk_fma_f32 v[54:55], v[158:159], v[222:223], v[54:55] op_sel_hi:[1,0,1]
    v_pk_fma_f32 v[36:37], v[36:37], v[22:23], v[184:185] op_sel_hi:[1,0,1]
    v_pk_fma_f32 v[38:39], v[38:39], v[22:23], v[186:187] op_sel_hi:[1,0,1]
    v_pk_fma_f32 v[52:53], v[52:53], v[22:23], v[188:189] op_sel_hi:[1,0,1]
    v_pk_fma_f32 v[54:55], v[54:55], v[22:23], v[190:191] op_sel_hi:[1,0,1]
    v_exp_f32 v236, v36
    v_exp_f32 v237, v37
    v_exp_f32 v238, v38
    v_exp_f32 v239, v39
    v_exp_f32 v240, v52
    v_exp_f32 v241, v53
    v_exp_f32 v242, v54
    v_exp_f32 v243, v55
    v_pk_fma_f32 v[248:249], v[236:237], 0.5, 1.0 op_sel_hi:[1,0,0]
    v_pk_fma_f32 v[250:251], v[238:239], 0.5, 1.0 op_sel_hi:[1,0,0]
    v_pk_fma_f32 v[252:253], v[240:241], 0.5, 1.0 op_sel_hi:[1,0,0]
    v_pk_fma_f32 v[254:255], v[242:243], 0.5, 1.0 op_sel_hi:[1,0,0]
    v_pk_fma_f32 v[236:237], v[236:237], v[248:249], 1.0 op_sel_hi:[1,1,0]
    v_pk_fma_f32 v[238:239], v[238:239], v[250:251], 1.0 op_sel_hi:[1,1,0]
    v_pk_fma_f32 v[240:241], v[240:241], v[252:253], 1.0 op_sel_hi:[1,1,0]
    v_pk_fma_f32 v[242:243], v[242:243], v[254:255], 1.0 op_sel_hi:[1,1,0]
    v_rcp_f32 v236, v236
    v_rcp_f32 v237, v237
    v_rcp_f32 v238, v238
    v_rcp_f32 v239, v239
    v_rcp_f32 v240, v240
    v_rcp_f32 v241, v241
    v_rcp_f32 v242, v242
    v_rcp_f32 v243, v243
    v_pk_fma_f32 v[236:237], v[36:37], v[236:237], v[36:37] neg_lo:[1,0,0] neg_hi:[1,0,0]
    v_pk_fma_f32 v[238:239], v[38:39], v[238:239], v[38:39] neg_lo:[1,0,0] neg_hi:[1,0,0]
    v_pk_fma_f32 v[240:241], v[52:53], v[240:241], v[52:53] neg_lo:[1,0,0] neg_hi:[1,0,0]
    v_pk_fma_f32 v[242:243], v[54:55], v[242:243], v[54:55] neg_lo:[1,0,0] neg_hi:[1,0,0]
    v_cvt_pk_bf16_f32 v244, v236, v237
    v_cvt_pk_bf16_f32 v245, v238, v239
    v_cvt_pk_bf16_f32 v246, v240, v241
    v_cvt_pk_bf16_f32 v247, v242, v243
    s_add_u32 s37, s57, 6144
    buffer_store_dwordx4 v[244:247], v11, s[28:31], s37 offen sc1
    ds_write_b128 v7, v[244:247] offset:55296
    v_pk_fma_f32 v[56:57], v[160:161], v[216:217], v[56:57] op_sel_hi:[1,0,1]
    v_pk_fma_f32 v[58:59], v[162:163], v[216:217], v[58:59] op_sel_hi:[1,0,1]
    v_pk_fma_f32 v[72:73], v[164:165], v[216:217], v[72:73] op_sel_hi:[1,0,1]
    v_pk_fma_f32 v[74:75], v[166:167], v[216:217], v[74:75] op_sel_hi:[1,0,1]
    s_waitcnt lgkmcnt(0)
    v_pk_fma_f32 v[56:57], v[56:57], v[4:5], v[192:193] op_sel_hi:[1,0,1]
    v_pk_fma_f32 v[58:59], v[58:59], v[4:5], v[194:195] op_sel_hi:[1,0,1]
    v_pk_fma_f32 v[72:73], v[72:73], v[4:5], v[196:197] op_sel_hi:[1,0,1]
    v_pk_fma_f32 v[74:75], v[74:75], v[4:5], v[198:199] op_sel_hi:[1,0,1]
    v_exp_f32 v224, v56
    v_exp_f32 v225, v57
    v_exp_f32 v226, v58
    v_exp_f32 v227, v59
    v_exp_f32 v228, v72
    v_exp_f32 v229, v73
    v_exp_f32 v230, v74
    v_exp_f32 v231, v75
    v_pk_fma_f32 v[248:249], v[224:225], 0.5, 1.0 op_sel_hi:[1,0,0]
    v_pk_fma_f32 v[250:251], v[226:227], 0.5, 1.0 op_sel_hi:[1,0,0]
    v_pk_fma_f32 v[252:253], v[228:229], 0.5, 1.0 op_sel_hi:[1,0,0]
    v_pk_fma_f32 v[254:255], v[230:231], 0.5, 1.0 op_sel_hi:[1,0,0]
    v_pk_fma_f32 v[224:225], v[224:225], v[248:249], 1.0 op_sel_hi:[1,1,0]
    v_pk_fma_f32 v[226:227], v[226:227], v[250:251], 1.0 op_sel_hi:[1,1,0]
    v_pk_fma_f32 v[228:229], v[228:229], v[252:253], 1.0 op_sel_hi:[1,1,0]
    v_pk_fma_f32 v[230:231], v[230:231], v[254:255], 1.0 op_sel_hi:[1,1,0]
    v_rcp_f32 v224, v224
    v_rcp_f32 v225, v225
    v_rcp_f32 v226, v226
    v_rcp_f32 v227, v227
    v_rcp_f32 v228, v228
    v_rcp_f32 v229, v229
    v_rcp_f32 v230, v230
    v_rcp_f32 v231, v231
    v_pk_fma_f32 v[224:225], v[56:57], v[224:225], v[56:57] neg_lo:[1,0,0] neg_hi:[1,0,0]
    v_pk_fma_f32 v[226:227], v[58:59], v[226:227], v[58:59] neg_lo:[1,0,0] neg_hi:[1,0,0]
    v_pk_fma_f32 v[228:229], v[72:73], v[228:229], v[72:73] neg_lo:[1,0,0] neg_hi:[1,0,0]
    v_pk_fma_f32 v[230:231], v[74:75], v[230:231], v[74:75] neg_lo:[1,0,0] neg_hi:[1,0,0]
    v_cvt_pk_bf16_f32 v232, v224, v225
    v_cvt_pk_bf16_f32 v233, v226, v227
    v_cvt_pk_bf16_f32 v234, v228, v229
    v_cvt_pk_bf16_f32 v235, v230, v231
    s_add_u32 s37, s57, 262144
    buffer_store_dwordx4 v[232:235], v11, s[28:31], s37 offen sc1
    ds_write_b128 v8, v[232:235] offset:0
    v_pk_fma_f32 v[60:61], v[160:161], v[218:219], v[60:61] op_sel_hi:[1,0,1]
    v_pk_fma_f32 v[62:63], v[162:163], v[218:219], v[62:63] op_sel_hi:[1,0,1]
    v_pk_fma_f32 v[76:77], v[164:165], v[218:219], v[76:77] op_sel_hi:[1,0,1]
    v_pk_fma_f32 v[78:79], v[166:167], v[218:219], v[78:79] op_sel_hi:[1,0,1]
    v_pk_fma_f32 v[60:61], v[60:61], v[6:7], v[192:193] op_sel_hi:[1,0,1]
    v_pk_fma_f32 v[62:63], v[62:63], v[6:7], v[194:195] op_sel_hi:[1,0,1]
    v_pk_fma_f32 v[76:77], v[76:77], v[6:7], v[196:197] op_sel_hi:[1,0,1]
    v_pk_fma_f32 v[78:79], v[78:79], v[6:7], v[198:199] op_sel_hi:[1,0,1]
    v_exp_f32 v236, v60
    v_exp_f32 v237, v61
    v_exp_f32 v238, v62
    v_exp_f32 v239, v63
    v_exp_f32 v240, v76
    v_exp_f32 v241, v77
    v_exp_f32 v242, v78
    v_exp_f32 v243, v79
    v_pk_fma_f32 v[248:249], v[236:237], 0.5, 1.0 op_sel_hi:[1,0,0]
    v_pk_fma_f32 v[250:251], v[238:239], 0.5, 1.0 op_sel_hi:[1,0,0]
    v_pk_fma_f32 v[252:253], v[240:241], 0.5, 1.0 op_sel_hi:[1,0,0]
    v_pk_fma_f32 v[254:255], v[242:243], 0.5, 1.0 op_sel_hi:[1,0,0]
    v_pk_fma_f32 v[236:237], v[236:237], v[248:249], 1.0 op_sel_hi:[1,1,0]
    v_pk_fma_f32 v[238:239], v[238:239], v[250:251], 1.0 op_sel_hi:[1,1,0]
    v_pk_fma_f32 v[240:241], v[240:241], v[252:253], 1.0 op_sel_hi:[1,1,0]
    v_pk_fma_f32 v[242:243], v[242:243], v[254:255], 1.0 op_sel_hi:[1,1,0]
    v_rcp_f32 v236, v236
    v_rcp_f32 v237, v237
    v_rcp_f32 v238, v238
    v_rcp_f32 v239, v239
    v_rcp_f32 v240, v240
    v_rcp_f32 v241, v241
    v_rcp_f32 v242, v242
    v_rcp_f32 v243, v243
    v_pk_fma_f32 v[236:237], v[60:61], v[236:237], v[60:61] neg_lo:[1,0,0] neg_hi:[1,0,0]
    v_pk_fma_f32 v[238:239], v[62:63], v[238:239], v[62:63] neg_lo:[1,0,0] neg_hi:[1,0,0]
    v_pk_fma_f32 v[240:241], v[76:77], v[240:241], v[76:77] neg_lo:[1,0,0] neg_hi:[1,0,0]
    v_pk_fma_f32 v[242:243], v[78:79], v[242:243], v[78:79] neg_lo:[1,0,0] neg_hi:[1,0,0]
    v_cvt_pk_bf16_f32 v244, v236, v237
    v_cvt_pk_bf16_f32 v245, v238, v239
    v_cvt_pk_bf16_f32 v246, v240, v241
    v_cvt_pk_bf16_f32 v247, v242, v243
    s_add_u32 s37, s57, 264192
    buffer_store_dwordx4 v[244:247], v11, s[28:31], s37 offen sc1
    ds_write_b128 v8, v[244:247] offset:2048
    v_pk_fma_f32 v[64:65], v[160:161], v[220:221], v[64:65] op_sel_hi:[1,0,1]
    v_pk_fma_f32 v[66:67], v[162:163], v[220:221], v[66:67] op_sel_hi:[1,0,1]
    v_pk_fma_f32 v[80:81], v[164:165], v[220:221], v[80:81] op_sel_hi:[1,0,1]
    v_pk_fma_f32 v[82:83], v[166:167], v[220:221], v[82:83] op_sel_hi:[1,0,1]
    v_pk_fma_f32 v[64:65], v[64:65], v[10:11], v[192:193] op_sel_hi:[1,0,1]
    v_pk_fma_f32 v[66:67], v[66:67], v[10:11], v[194:195] op_sel_hi:[1,0,1]
    v_pk_fma_f32 v[80:81], v[80:81], v[10:11], v[196:197] op_sel_hi:[1,0,1]
    v_pk_fma_f32 v[82:83], v[82:83], v[10:11], v[198:199] op_sel_hi:[1,0,1]
    v_exp_f32 v224, v64
    v_exp_f32 v225, v65
    v_exp_f32 v226, v66
    v_exp_f32 v227, v67
    v_exp_f32 v228, v80
    v_exp_f32 v229, v81
    v_exp_f32 v230, v82
    v_exp_f32 v231, v83
    v_pk_fma_f32 v[248:249], v[224:225], 0.5, 1.0 op_sel_hi:[1,0,0]
    v_pk_fma_f32 v[250:251], v[226:227], 0.5, 1.0 op_sel_hi:[1,0,0]
    v_pk_fma_f32 v[252:253], v[228:229], 0.5, 1.0 op_sel_hi:[1,0,0]
    v_pk_fma_f32 v[254:255], v[230:231], 0.5, 1.0 op_sel_hi:[1,0,0]
    v_pk_fma_f32 v[224:225], v[224:225], v[248:249], 1.0 op_sel_hi:[1,1,0]
    v_pk_fma_f32 v[226:227], v[226:227], v[250:251], 1.0 op_sel_hi:[1,1,0]
    v_pk_fma_f32 v[228:229], v[228:229], v[252:253], 1.0 op_sel_hi:[1,1,0]
    v_pk_fma_f32 v[230:231], v[230:231], v[254:255], 1.0 op_sel_hi:[1,1,0]
    v_rcp_f32 v224, v224
    v_rcp_f32 v225, v225
    v_rcp_f32 v226, v226
    v_rcp_f32 v227, v227
    v_rcp_f32 v228, v228
    v_rcp_f32 v229, v229
    v_rcp_f32 v230, v230
    v_rcp_f32 v231, v231
    v_pk_fma_f32 v[224:225], v[64:65], v[224:225], v[64:65] neg_lo:[1,0,0] neg_hi:[1,0,0]
    v_pk_fma_f32 v[226:227], v[66:67], v[226:227], v[66:67] neg_lo:[1,0,0] neg_hi:[1,0,0]
    v_pk_fma_f32 v[228:229], v[80:81], v[228:229], v[80:81] neg_lo:[1,0,0] neg_hi:[1,0,0]
    v_pk_fma_f32 v[230:231], v[82:83], v[230:231], v[82:83] neg_lo:[1,0,0] neg_hi:[1,0,0]
    v_cvt_pk_bf16_f32 v232, v224, v225
    v_cvt_pk_bf16_f32 v233, v226, v227
    v_cvt_pk_bf16_f32 v234, v228, v229
    v_cvt_pk_bf16_f32 v235, v230, v231
    s_add_u32 s37, s57, 266240
    buffer_store_dwordx4 v[232:235], v11, s[28:31], s37 offen sc1
    ds_write_b128 v8, v[232:235] offset:4096
    v_pk_fma_f32 v[68:69], v[160:161], v[222:223], v[68:69] op_sel_hi:[1,0,1]
    v_pk_fma_f32 v[70:71], v[162:163], v[222:223], v[70:71] op_sel_hi:[1,0,1]
    v_pk_fma_f32 v[84:85], v[164:165], v[222:223], v[84:85] op_sel_hi:[1,0,1]
    v_pk_fma_f32 v[86:87], v[166:167], v[222:223], v[86:87] op_sel_hi:[1,0,1]
    v_pk_fma_f32 v[68:69], v[68:69], v[22:23], v[192:193] op_sel_hi:[1,0,1]
    v_pk_fma_f32 v[70:71], v[70:71], v[22:23], v[194:195] op_sel_hi:[1,0,1]
    v_pk_fma_f32 v[84:85], v[84:85], v[22:23], v[196:197] op_sel_hi:[1,0,1]
    v_pk_fma_f32 v[86:87], v[86:87], v[22:23], v[198:199] op_sel_hi:[1,0,1]
    v_exp_f32 v236, v68
    v_exp_f32 v237, v69
    v_exp_f32 v238, v70
    v_exp_f32 v239, v71
    v_exp_f32 v240, v84
    v_exp_f32 v241, v85
    v_exp_f32 v242, v86
    v_exp_f32 v243, v87
    v_pk_fma_f32 v[248:249], v[236:237], 0.5, 1.0 op_sel_hi:[1,0,0]
    v_pk_fma_f32 v[250:251], v[238:239], 0.5, 1.0 op_sel_hi:[1,0,0]
    v_pk_fma_f32 v[252:253], v[240:241], 0.5, 1.0 op_sel_hi:[1,0,0]
    v_pk_fma_f32 v[254:255], v[242:243], 0.5, 1.0 op_sel_hi:[1,0,0]
    v_pk_fma_f32 v[236:237], v[236:237], v[248:249], 1.0 op_sel_hi:[1,1,0]
    v_pk_fma_f32 v[238:239], v[238:239], v[250:251], 1.0 op_sel_hi:[1,1,0]
    v_pk_fma_f32 v[240:241], v[240:241], v[252:253], 1.0 op_sel_hi:[1,1,0]
    v_pk_fma_f32 v[242:243], v[242:243], v[254:255], 1.0 op_sel_hi:[1,1,0]
    v_rcp_f32 v236, v236
    v_rcp_f32 v237, v237
    v_rcp_f32 v238, v238
    v_rcp_f32 v239, v239
    v_rcp_f32 v240, v240
    v_rcp_f32 v241, v241
    v_rcp_f32 v242, v242
    v_rcp_f32 v243, v243
    v_pk_fma_f32 v[236:237], v[68:69], v[236:237], v[68:69] neg_lo:[1,0,0] neg_hi:[1,0,0]
    v_pk_fma_f32 v[238:239], v[70:71], v[238:239], v[70:71] neg_lo:[1,0,0] neg_hi:[1,0,0]
    v_pk_fma_f32 v[240:241], v[84:85], v[240:241], v[84:85] neg_lo:[1,0,0] neg_hi:[1,0,0]
    v_pk_fma_f32 v[242:243], v[86:87], v[242:243], v[86:87] neg_lo:[1,0,0] neg_hi:[1,0,0]
    v_cvt_pk_bf16_f32 v244, v236, v237
    v_cvt_pk_bf16_f32 v245, v238, v239
    v_cvt_pk_bf16_f32 v246, v240, v241
    v_cvt_pk_bf16_f32 v247, v242, v243
    s_add_u32 s37, s57, 268288
    buffer_store_dwordx4 v[244:247], v11, s[28:31], s37 offen sc1
    ds_write_b128 v8, v[244:247] offset:6144
    s_waitcnt vmcnt(4)
    s_mov_b64 exec, 1
    buffer_store_dword v9, v5, s[28:31], s75 offen sc1
    s_mov_b64 exec, -1
    v_pk_fma_f32 v[88:89], v[168:169], v[216:217], v[88:89] op_sel_hi:[1,0,1]
    v_pk_fma_f32 v[90:91], v[170:171], v[216:217], v[90:91] op_sel_hi:[1,0,1]
    v_pk_fma_f32 v[104:105], v[172:173], v[216:217], v[104:105] op_sel_hi:[1,0,1]
    v_pk_fma_f32 v[106:107], v[174:175], v[216:217], v[106:107] op_sel_hi:[1,0,1]
    v_pk_fma_f32 v[88:89], v[88:89], v[4:5], v[200:201] op_sel_hi:[1,0,1]
    v_pk_fma_f32 v[90:91], v[90:91], v[4:5], v[202:203] op_sel_hi:[1,0,1]
    v_pk_fma_f32 v[104:105], v[104:105], v[4:5], v[204:205] op_sel_hi:[1,0,1]
    v_pk_fma_f32 v[106:107], v[106:107], v[4:5], v[206:207] op_sel_hi:[1,0,1]
    v_exp_f32 v224, v88
    v_exp_f32 v225, v89
    v_exp_f32 v226, v90
    v_exp_f32 v227, v91
    v_exp_f32 v228, v104
    v_exp_f32 v229, v105
    v_exp_f32 v230, v106
    v_exp_f32 v231, v107
    v_pk_fma_f32 v[248:249], v[224:225], 0.5, 1.0 op_sel_hi:[1,0,0]
    v_pk_fma_f32 v[250:251], v[226:227], 0.5, 1.0 op_sel_hi:[1,0,0]
    v_pk_fma_f32 v[252:253], v[228:229], 0.5, 1.0 op_sel_hi:[1,0,0]
    v_pk_fma_f32 v[254:255], v[230:231], 0.5, 1.0 op_sel_hi:[1,0,0]
    v_pk_fma_f32 v[224:225], v[224:225], v[248:249], 1.0 op_sel_hi:[1,1,0]
    v_pk_fma_f32 v[226:227], v[226:227], v[250:251], 1.0 op_sel_hi:[1,1,0]
    v_pk_fma_f32 v[228:229], v[228:229], v[252:253], 1.0 op_sel_hi:[1,1,0]
    v_pk_fma_f32 v[230:231], v[230:231], v[254:255], 1.0 op_sel_hi:[1,1,0]
    v_rcp_f32 v224, v224
    v_rcp_f32 v225, v225
    v_rcp_f32 v226, v226
    v_rcp_f32 v227, v227
    v_rcp_f32 v228, v228
    v_rcp_f32 v229, v229
    v_rcp_f32 v230, v230
    v_rcp_f32 v231, v231
    v_pk_fma_f32 v[224:225], v[88:89], v[224:225], v[88:89] neg_lo:[1,0,0] neg_hi:[1,0,0]
    v_pk_fma_f32 v[226:227], v[90:91], v[226:227], v[90:91] neg_lo:[1,0,0] neg_hi:[1,0,0]
    v_pk_fma_f32 v[228:229], v[104:105], v[228:229], v[104:105] neg_lo:[1,0,0] neg_hi:[1,0,0]
    v_pk_fma_f32 v[230:231], v[106:107], v[230:231], v[106:107] neg_lo:[1,0,0] neg_hi:[1,0,0]
    v_cvt_pk_bf16_f32 v232, v224, v225
    v_cvt_pk_bf16_f32 v233, v226, v227
    v_cvt_pk_bf16_f32 v234, v228, v229
    v_cvt_pk_bf16_f32 v235, v230, v231
    s_add_u32 s37, s57, 524288
    buffer_store_dwordx4 v[232:235], v11, s[28:31], s37 offen sc1
    ds_write_b128 v7, v[232:235] offset:0
    v_pk_fma_f32 v[92:93], v[168:169], v[218:219], v[92:93] op_sel_hi:[1,0,1]
    v_pk_fma_f32 v[94:95], v[170:171], v[218:219], v[94:95] op_sel_hi:[1,0,1]
    v_pk_fma_f32 v[108:109], v[172:173], v[218:219], v[108:109] op_sel_hi:[1,0,1]
    v_pk_fma_f32 v[110:111], v[174:175], v[218:219], v[110:111] op_sel_hi:[1,0,1]
    v_pk_fma_f32 v[92:93], v[92:93], v[6:7], v[200:201] op_sel_hi:[1,0,1]
    v_pk_fma_f32 v[94:95], v[94:95], v[6:7], v[202:203] op_sel_hi:[1,0,1]
    v_pk_fma_f32 v[108:109], v[108:109], v[6:7], v[204:205] op_sel_hi:[1,0,1]
    v_pk_fma_f32 v[110:111], v[110:111], v[6:7], v[206:207] op_sel_hi:[1,0,1]
    v_exp_f32 v236, v92
    v_exp_f32 v237, v93
    v_exp_f32 v238, v94
    v_exp_f32 v239, v95
    v_exp_f32 v240, v108
    v_exp_f32 v241, v109
    v_exp_f32 v242, v110
    v_exp_f32 v243, v111
    v_pk_fma_f32 v[248:249], v[236:237], 0.5, 1.0 op_sel_hi:[1,0,0]
    v_pk_fma_f32 v[250:251], v[238:239], 0.5, 1.0 op_sel_hi:[1,0,0]
    v_pk_fma_f32 v[252:253], v[240:241], 0.5, 1.0 op_sel_hi:[1,0,0]
    v_pk_fma_f32 v[254:255], v[242:243], 0.5, 1.0 op_sel_hi:[1,0,0]
    v_pk_fma_f32 v[236:237], v[236:237], v[248:249], 1.0 op_sel_hi:[1,1,0]
    v_pk_fma_f32 v[238:239], v[238:239], v[250:251], 1.0 op_sel_hi:[1,1,0]
    v_pk_fma_f32 v[240:241], v[240:241], v[252:253], 1.0 op_sel_hi:[1,1,0]
    v_pk_fma_f32 v[242:243], v[242:243], v[254:255], 1.0 op_sel_hi:[1,1,0]
    v_rcp_f32 v236, v236
    v_rcp_f32 v237, v237
    v_rcp_f32 v238, v238
    v_rcp_f32 v239, v239
    v_rcp_f32 v240, v240
    v_rcp_f32 v241, v241
    v_rcp_f32 v242, v242
    v_rcp_f32 v243, v243
    v_pk_fma_f32 v[236:237], v[92:93], v[236:237], v[92:93] neg_lo:[1,0,0] neg_hi:[1,0,0]
    v_pk_fma_f32 v[238:239], v[94:95], v[238:239], v[94:95] neg_lo:[1,0,0] neg_hi:[1,0,0]
    v_pk_fma_f32 v[240:241], v[108:109], v[240:241], v[108:109] neg_lo:[1,0,0] neg_hi:[1,0,0]
    v_pk_fma_f32 v[242:243], v[110:111], v[242:243], v[110:111] neg_lo:[1,0,0] neg_hi:[1,0,0]
    v_cvt_pk_bf16_f32 v244, v236, v237
    v_cvt_pk_bf16_f32 v245, v238, v239
    v_cvt_pk_bf16_f32 v246, v240, v241
    v_cvt_pk_bf16_f32 v247, v242, v243
    s_add_u32 s37, s57, 526336
    buffer_store_dwordx4 v[244:247], v11, s[28:31], s37 offen sc1
    ds_write_b128 v7, v[244:247] offset:2048
    v_pk_fma_f32 v[96:97], v[168:169], v[220:221], v[96:97] op_sel_hi:[1,0,1]
    v_pk_fma_f32 v[98:99], v[170:171], v[220:221], v[98:99] op_sel_hi:[1,0,1]
    v_pk_fma_f32 v[112:113], v[172:173], v[220:221], v[112:113] op_sel_hi:[1,0,1]
    v_pk_fma_f32 v[114:115], v[174:175], v[220:221], v[114:115] op_sel_hi:[1,0,1]
    v_pk_fma_f32 v[96:97], v[96:97], v[10:11], v[200:201] op_sel_hi:[1,0,1]
    v_pk_fma_f32 v[98:99], v[98:99], v[10:11], v[202:203] op_sel_hi:[1,0,1]
    v_pk_fma_f32 v[112:113], v[112:113], v[10:11], v[204:205] op_sel_hi:[1,0,1]
    v_pk_fma_f32 v[114:115], v[114:115], v[10:11], v[206:207] op_sel_hi:[1,0,1]
    v_exp_f32 v224, v96
    v_exp_f32 v225, v97
    v_exp_f32 v226, v98
    v_exp_f32 v227, v99
    v_exp_f32 v228, v112
    v_exp_f32 v229, v113
    v_exp_f32 v230, v114
    v_exp_f32 v231, v115
    v_pk_fma_f32 v[248:249], v[224:225], 0.5, 1.0 op_sel_hi:[1,0,0]
    v_pk_fma_f32 v[250:251], v[226:227], 0.5, 1.0 op_sel_hi:[1,0,0]
    v_pk_fma_f32 v[252:253], v[228:229], 0.5, 1.0 op_sel_hi:[1,0,0]
    v_pk_fma_f32 v[254:255], v[230:231], 0.5, 1.0 op_sel_hi:[1,0,0]
    v_pk_fma_f32 v[224:225], v[224:225], v[248:249], 1.0 op_sel_hi:[1,1,0]
    v_pk_fma_f32 v[226:227], v[226:227], v[250:251], 1.0 op_sel_hi:[1,1,0]
    v_pk_fma_f32 v[228:229], v[228:229], v[252:253], 1.0 op_sel_hi:[1,1,0]
    v_pk_fma_f32 v[230:231], v[230:231], v[254:255], 1.0 op_sel_hi:[1,1,0]
    v_rcp_f32 v224, v224
    v_rcp_f32 v225, v225
    v_rcp_f32 v226, v226
    v_rcp_f32 v227, v227
    v_rcp_f32 v228, v228
    v_rcp_f32 v229, v229
    v_rcp_f32 v230, v230
    v_rcp_f32 v231, v231
    v_pk_fma_f32 v[224:225], v[96:97], v[224:225], v[96:97] neg_lo:[1,0,0] neg_hi:[1,0,0]
    v_pk_fma_f32 v[226:227], v[98:99], v[226:227], v[98:99] neg_lo:[1,0,0] neg_hi:[1,0,0]
    v_pk_fma_f32 v[228:229], v[112:113], v[228:229], v[112:113] neg_lo:[1,0,0] neg_hi:[1,0,0]
    v_pk_fma_f32 v[230:231], v[114:115], v[230:231], v[114:115] neg_lo:[1,0,0] neg_hi:[1,0,0]
    v_cvt_pk_bf16_f32 v232, v224, v225
    v_cvt_pk_bf16_f32 v233, v226, v227
    v_cvt_pk_bf16_f32 v234, v228, v229
    v_cvt_pk_bf16_f32 v235, v230, v231
    s_add_u32 s37, s57, 528384
    buffer_store_dwordx4 v[232:235], v11, s[28:31], s37 offen sc1
    ds_write_b128 v7, v[232:235] offset:4096
    v_pk_fma_f32 v[100:101], v[168:169], v[222:223], v[100:101] op_sel_hi:[1,0,1]
    v_pk_fma_f32 v[102:103], v[170:171], v[222:223], v[102:103] op_sel_hi:[1,0,1]
    v_pk_fma_f32 v[116:117], v[172:173], v[222:223], v[116:117] op_sel_hi:[1,0,1]
    v_pk_fma_f32 v[118:119], v[174:175], v[222:223], v[118:119] op_sel_hi:[1,0,1]
    v_pk_fma_f32 v[100:101], v[100:101], v[22:23], v[200:201] op_sel_hi:[1,0,1]
    v_pk_fma_f32 v[102:103], v[102:103], v[22:23], v[202:203] op_sel_hi:[1,0,1]
    v_pk_fma_f32 v[116:117], v[116:117], v[22:23], v[204:205] op_sel_hi:[1,0,1]
    v_pk_fma_f32 v[118:119], v[118:119], v[22:23], v[206:207] op_sel_hi:[1,0,1]
    v_exp_f32 v236, v100
    v_exp_f32 v237, v101
    v_exp_f32 v238, v102
    v_exp_f32 v239, v103
    v_exp_f32 v240, v116
    v_exp_f32 v241, v117
    v_exp_f32 v242, v118
    v_exp_f32 v243, v119
    v_pk_fma_f32 v[248:249], v[236:237], 0.5, 1.0 op_sel_hi:[1,0,0]
    v_pk_fma_f32 v[250:251], v[238:239], 0.5, 1.0 op_sel_hi:[1,0,0]
    v_pk_fma_f32 v[252:253], v[240:241], 0.5, 1.0 op_sel_hi:[1,0,0]
    v_pk_fma_f32 v[254:255], v[242:243], 0.5, 1.0 op_sel_hi:[1,0,0]
    v_pk_fma_f32 v[236:237], v[236:237], v[248:249], 1.0 op_sel_hi:[1,1,0]
    v_pk_fma_f32 v[238:239], v[238:239], v[250:251], 1.0 op_sel_hi:[1,1,0]
    v_pk_fma_f32 v[240:241], v[240:241], v[252:253], 1.0 op_sel_hi:[1,1,0]
    v_pk_fma_f32 v[242:243], v[242:243], v[254:255], 1.0 op_sel_hi:[1,1,0]
    v_rcp_f32 v236, v236
    v_rcp_f32 v237, v237
    v_rcp_f32 v238, v238
    v_rcp_f32 v239, v239
    v_rcp_f32 v240, v240
    v_rcp_f32 v241, v241
    v_rcp_f32 v242, v242
    v_rcp_f32 v243, v243
    v_pk_fma_f32 v[236:237], v[100:101], v[236:237], v[100:101] neg_lo:[1,0,0] neg_hi:[1,0,0]
    v_pk_fma_f32 v[238:239], v[102:103], v[238:239], v[102:103] neg_lo:[1,0,0] neg_hi:[1,0,0]
    v_pk_fma_f32 v[240:241], v[116:117], v[240:241], v[116:117] neg_lo:[1,0,0] neg_hi:[1,0,0]
    v_pk_fma_f32 v[242:243], v[118:119], v[242:243], v[118:119] neg_lo:[1,0,0] neg_hi:[1,0,0]
    v_cvt_pk_bf16_f32 v244, v236, v237
    v_cvt_pk_bf16_f32 v245, v238, v239
    v_cvt_pk_bf16_f32 v246, v240, v241
    v_cvt_pk_bf16_f32 v247, v242, v243
    s_add_u32 s37, s57, 530432
    buffer_store_dwordx4 v[244:247], v11, s[28:31], s37 offen sc1
    ds_write_b128 v7, v[244:247] offset:6144
    v_pk_fma_f32 v[120:121], v[176:177], v[216:217], v[120:121] op_sel_hi:[1,0,1]
    v_pk_fma_f32 v[122:123], v[178:179], v[216:217], v[122:123] op_sel_hi:[1,0,1]
    v_pk_fma_f32 v[136:137], v[180:181], v[216:217], v[136:137] op_sel_hi:[1,0,1]
    v_pk_fma_f32 v[138:139], v[182:183], v[216:217], v[138:139] op_sel_hi:[1,0,1]
    v_pk_fma_f32 v[120:121], v[120:121], v[4:5], v[208:209] op_sel_hi:[1,0,1]
    v_pk_fma_f32 v[122:123], v[122:123], v[4:5], v[210:211] op_sel_hi:[1,0,1]
    v_pk_fma_f32 v[136:137], v[136:137], v[4:5], v[212:213] op_sel_hi:[1,0,1]
    v_pk_fma_f32 v[138:139], v[138:139], v[4:5], v[214:215] op_sel_hi:[1,0,1]
    v_exp_f32 v224, v120
    v_exp_f32 v225, v121
    v_exp_f32 v226, v122
    v_exp_f32 v227, v123
    v_exp_f32 v228, v136
    v_exp_f32 v229, v137
    v_exp_f32 v230, v138
    v_exp_f32 v231, v139
    v_pk_fma_f32 v[248:249], v[224:225], 0.5, 1.0 op_sel_hi:[1,0,0]
    v_pk_fma_f32 v[250:251], v[226:227], 0.5, 1.0 op_sel_hi:[1,0,0]
    v_pk_fma_f32 v[252:253], v[228:229], 0.5, 1.0 op_sel_hi:[1,0,0]
    v_pk_fma_f32 v[254:255], v[230:231], 0.5, 1.0 op_sel_hi:[1,0,0]
    v_pk_fma_f32 v[224:225], v[224:225], v[248:249], 1.0 op_sel_hi:[1,1,0]
    v_pk_fma_f32 v[226:227], v[226:227], v[250:251], 1.0 op_sel_hi:[1,1,0]
    v_pk_fma_f32 v[228:229], v[228:229], v[252:253], 1.0 op_sel_hi:[1,1,0]
    v_pk_fma_f32 v[230:231], v[230:231], v[254:255], 1.0 op_sel_hi:[1,1,0]
    v_rcp_f32 v224, v224
    v_rcp_f32 v225, v225
    v_rcp_f32 v226, v226
    v_rcp_f32 v227, v227
    v_rcp_f32 v228, v228
    v_rcp_f32 v229, v229
    v_rcp_f32 v230, v230
    v_rcp_f32 v231, v231
    v_pk_fma_f32 v[224:225], v[120:121], v[224:225], v[120:121] neg_lo:[1,0,0] neg_hi:[1,0,0]
    v_pk_fma_f32 v[226:227], v[122:123], v[226:227], v[122:123] neg_lo:[1,0,0] neg_hi:[1,0,0]
    v_pk_fma_f32 v[228:229], v[136:137], v[228:229], v[136:137] neg_lo:[1,0,0] neg_hi:[1,0,0]
    v_pk_fma_f32 v[230:231], v[138:139], v[230:231], v[138:139] neg_lo:[1,0,0] neg_hi:[1,0,0]
    v_cvt_pk_bf16_f32 v232, v224, v225
    v_cvt_pk_bf16_f32 v233, v226, v227
    v_cvt_pk_bf16_f32 v234, v228, v229
    v_cvt_pk_bf16_f32 v235, v230, v231
    s_add_u32 s37, s57, 786432
    buffer_store_dwordx4 v[232:235], v11, s[28:31], s37 offen sc1
    v_pk_fma_f32 v[124:125], v[176:177], v[218:219], v[124:125] op_sel_hi:[1,0,1]
    v_pk_fma_f32 v[126:127], v[178:179], v[218:219], v[126:127] op_sel_hi:[1,0,1]
    v_pk_fma_f32 v[140:141], v[180:181], v[218:219], v[140:141] op_sel_hi:[1,0,1]
    v_pk_fma_f32 v[142:143], v[182:183], v[218:219], v[142:143] op_sel_hi:[1,0,1]
    v_pk_fma_f32 v[124:125], v[124:125], v[6:7], v[208:209] op_sel_hi:[1,0,1]
    v_pk_fma_f32 v[126:127], v[126:127], v[6:7], v[210:211] op_sel_hi:[1,0,1]
    v_pk_fma_f32 v[140:141], v[140:141], v[6:7], v[212:213] op_sel_hi:[1,0,1]
    v_pk_fma_f32 v[142:143], v[142:143], v[6:7], v[214:215] op_sel_hi:[1,0,1]
    v_exp_f32 v236, v124
    v_exp_f32 v237, v125
    v_exp_f32 v238, v126
    v_exp_f32 v239, v127
    v_exp_f32 v240, v140
    v_exp_f32 v241, v141
    v_exp_f32 v242, v142
    v_exp_f32 v243, v143
    v_pk_fma_f32 v[248:249], v[236:237], 0.5, 1.0 op_sel_hi:[1,0,0]
    v_pk_fma_f32 v[250:251], v[238:239], 0.5, 1.0 op_sel_hi:[1,0,0]
    v_pk_fma_f32 v[252:253], v[240:241], 0.5, 1.0 op_sel_hi:[1,0,0]
    v_pk_fma_f32 v[254:255], v[242:243], 0.5, 1.0 op_sel_hi:[1,0,0]
    v_pk_fma_f32 v[236:237], v[236:237], v[248:249], 1.0 op_sel_hi:[1,1,0]
    v_pk_fma_f32 v[238:239], v[238:239], v[250:251], 1.0 op_sel_hi:[1,1,0]
    v_pk_fma_f32 v[240:241], v[240:241], v[252:253], 1.0 op_sel_hi:[1,1,0]
    v_pk_fma_f32 v[242:243], v[242:243], v[254:255], 1.0 op_sel_hi:[1,1,0]
    v_rcp_f32 v236, v236
    v_rcp_f32 v237, v237
    v_rcp_f32 v238, v238
    v_rcp_f32 v239, v239
    v_rcp_f32 v240, v240
    v_rcp_f32 v241, v241
    v_rcp_f32 v242, v242
    v_rcp_f32 v243, v243
    v_pk_fma_f32 v[236:237], v[124:125], v[236:237], v[124:125] neg_lo:[1,0,0] neg_hi:[1,0,0]
    v_pk_fma_f32 v[238:239], v[126:127], v[238:239], v[126:127] neg_lo:[1,0,0] neg_hi:[1,0,0]
    v_pk_fma_f32 v[240:241], v[140:141], v[240:241], v[140:141] neg_lo:[1,0,0] neg_hi:[1,0,0]
    v_pk_fma_f32 v[242:243], v[142:143], v[242:243], v[142:143] neg_lo:[1,0,0] neg_hi:[1,0,0]
    v_cvt_pk_bf16_f32 v244, v236, v237
    v_cvt_pk_bf16_f32 v245, v238, v239
    v_cvt_pk_bf16_f32 v246, v240, v241
    v_cvt_pk_bf16_f32 v247, v242, v243
    s_add_u32 s37, s57, 788480
    buffer_store_dwordx4 v[244:247], v11, s[28:31], s37 offen sc1
    v_pk_fma_f32 v[128:129], v[176:177], v[220:221], v[128:129] op_sel_hi:[1,0,1]
    v_pk_fma_f32 v[130:131], v[178:179], v[220:221], v[130:131] op_sel_hi:[1,0,1]
    v_pk_fma_f32 v[144:145], v[180:181], v[220:221], v[144:145] op_sel_hi:[1,0,1]
    v_pk_fma_f32 v[146:147], v[182:183], v[220:221], v[146:147] op_sel_hi:[1,0,1]
    v_pk_fma_f32 v[128:129], v[128:129], v[10:11], v[208:209] op_sel_hi:[1,0,1]
    v_pk_fma_f32 v[130:131], v[130:131], v[10:11], v[210:211] op_sel_hi:[1,0,1]
    v_pk_fma_f32 v[144:145], v[144:145], v[10:11], v[212:213] op_sel_hi:[1,0,1]
    v_pk_fma_f32 v[146:147], v[146:147], v[10:11], v[214:215] op_sel_hi:[1,0,1]
    v_exp_f32 v224, v128
    v_exp_f32 v225, v129
    v_exp_f32 v226, v130
    v_exp_f32 v227, v131
    v_exp_f32 v228, v144
    v_exp_f32 v229, v145
    v_exp_f32 v230, v146
    v_exp_f32 v231, v147
    v_pk_fma_f32 v[248:249], v[224:225], 0.5, 1.0 op_sel_hi:[1,0,0]
    v_pk_fma_f32 v[250:251], v[226:227], 0.5, 1.0 op_sel_hi:[1,0,0]
    v_pk_fma_f32 v[252:253], v[228:229], 0.5, 1.0 op_sel_hi:[1,0,0]
    v_pk_fma_f32 v[254:255], v[230:231], 0.5, 1.0 op_sel_hi:[1,0,0]
    v_pk_fma_f32 v[224:225], v[224:225], v[248:249], 1.0 op_sel_hi:[1,1,0]
    v_pk_fma_f32 v[226:227], v[226:227], v[250:251], 1.0 op_sel_hi:[1,1,0]
    v_pk_fma_f32 v[228:229], v[228:229], v[252:253], 1.0 op_sel_hi:[1,1,0]
    v_pk_fma_f32 v[230:231], v[230:231], v[254:255], 1.0 op_sel_hi:[1,1,0]
    v_rcp_f32 v224, v224
    v_rcp_f32 v225, v225
    v_rcp_f32 v226, v226
    v_rcp_f32 v227, v227
    v_rcp_f32 v228, v228
    v_rcp_f32 v229, v229
    v_rcp_f32 v230, v230
    v_rcp_f32 v231, v231
    v_pk_fma_f32 v[224:225], v[128:129], v[224:225], v[128:129] neg_lo:[1,0,0] neg_hi:[1,0,0]
    v_pk_fma_f32 v[226:227], v[130:131], v[226:227], v[130:131] neg_lo:[1,0,0] neg_hi:[1,0,0]
    v_pk_fma_f32 v[228:229], v[144:145], v[228:229], v[144:145] neg_lo:[1,0,0] neg_hi:[1,0,0]
    v_pk_fma_f32 v[230:231], v[146:147], v[230:231], v[146:147] neg_lo:[1,0,0] neg_hi:[1,0,0]
    v_cvt_pk_bf16_f32 v232, v224, v225
    v_cvt_pk_bf16_f32 v233, v226, v227
    v_cvt_pk_bf16_f32 v234, v228, v229
    v_cvt_pk_bf16_f32 v235, v230, v231
    s_add_u32 s37, s57, 790528
    buffer_store_dwordx4 v[232:235], v11, s[28:31], s37 offen sc1
    v_pk_fma_f32 v[132:133], v[176:177], v[222:223], v[132:133] op_sel_hi:[1,0,1]
    v_pk_fma_f32 v[134:135], v[178:179], v[222:223], v[134:135] op_sel_hi:[1,0,1]
    v_pk_fma_f32 v[148:149], v[180:181], v[222:223], v[148:149] op_sel_hi:[1,0,1]
    v_pk_fma_f32 v[150:151], v[182:183], v[222:223], v[150:151] op_sel_hi:[1,0,1]
    v_pk_fma_f32 v[132:133], v[132:133], v[22:23], v[208:209] op_sel_hi:[1,0,1]
    v_pk_fma_f32 v[134:135], v[134:135], v[22:23], v[210:211] op_sel_hi:[1,0,1]
    v_pk_fma_f32 v[148:149], v[148:149], v[22:23], v[212:213] op_sel_hi:[1,0,1]
    v_pk_fma_f32 v[150:151], v[150:151], v[22:23], v[214:215] op_sel_hi:[1,0,1]
    v_exp_f32 v236, v132
    v_exp_f32 v237, v133
    v_exp_f32 v238, v134
    v_exp_f32 v239, v135
    v_exp_f32 v240, v148
    v_exp_f32 v241, v149
    v_exp_f32 v242, v150
    v_exp_f32 v243, v151
    v_pk_fma_f32 v[248:249], v[236:237], 0.5, 1.0 op_sel_hi:[1,0,0]
    v_pk_fma_f32 v[250:251], v[238:239], 0.5, 1.0 op_sel_hi:[1,0,0]
    v_pk_fma_f32 v[252:253], v[240:241], 0.5, 1.0 op_sel_hi:[1,0,0]
    v_pk_fma_f32 v[254:255], v[242:243], 0.5, 1.0 op_sel_hi:[1,0,0]
    v_pk_fma_f32 v[236:237], v[236:237], v[248:249], 1.0 op_sel_hi:[1,1,0]
    v_pk_fma_f32 v[238:239], v[238:239], v[250:251], 1.0 op_sel_hi:[1,1,0]
    v_pk_fma_f32 v[240:241], v[240:241], v[252:253], 1.0 op_sel_hi:[1,1,0]
    v_pk_fma_f32 v[242:243], v[242:243], v[254:255], 1.0 op_sel_hi:[1,1,0]
    v_rcp_f32 v236, v236
    v_rcp_f32 v237, v237
    v_rcp_f32 v238, v238
    v_rcp_f32 v239, v239
    v_rcp_f32 v240, v240
    v_rcp_f32 v241, v241
    v_rcp_f32 v242, v242
    v_rcp_f32 v243, v243
    v_pk_fma_f32 v[236:237], v[132:133], v[236:237], v[132:133] neg_lo:[1,0,0] neg_hi:[1,0,0]
    v_pk_fma_f32 v[238:239], v[134:135], v[238:239], v[134:135] neg_lo:[1,0,0] neg_hi:[1,0,0]
    v_pk_fma_f32 v[240:241], v[148:149], v[240:241], v[148:149] neg_lo:[1,0,0] neg_hi:[1,0,0]
    v_pk_fma_f32 v[242:243], v[150:151], v[242:243], v[150:151] neg_lo:[1,0,0] neg_hi:[1,0,0]
    v_cvt_pk_bf16_f32 v244, v236, v237
    v_cvt_pk_bf16_f32 v245, v238, v239
    v_cvt_pk_bf16_f32 v246, v240, v241
    v_cvt_pk_bf16_f32 v247, v242, v243
    s_add_u32 s37, s57, 792576
    buffer_store_dwordx4 v[244:247], v11, s[28:31], s37 offen sc1
    s_cmp_eq_u32 s13, 4
    s_cbranch_scc1 L_g1_pb16
    s_barrier
L_g1_pb16:
    s_add_u32 s75, s75, 131072
    v_mov_b32 v4, s74
    s_cmp_lg_u32 s13, 4
    s_cbranch_scc1 L_g2_c
    s_branch L_f3_x2
L_fa_t0:
    s_barrier
    s_branch L_fa
L_fa_hi:
    v_lshlrev_b32 v3, 4, v2
    s_and_b32 s36, s16, 3
    s_lshl_b32 s37, s36, 1
    s_lshr_b32 s38, s2, 1
    s_lshl_b32 s38, s38, 3
    s_add_u32 s37, s37, s38
    s_and_b32 s38, s2, 1
    s_add_u32 s37, s37, s38
    s_mul_i32 s37, s37, 16416
    s_mul_i32 s38, s36, 17472
    s_mov_b32 s34, 2101248
    s_mov_b32 s35, 0x20000
    s_waitcnt lgkmcnt(0)
    s_add_u32 s72, s10, 15040512
    s_addc_u32 s73, s11, 0
    s_load_dword s74, s[72:73], 0
    v_and_b32 v13, 31, v2
    v_lshrrev_b32 v14, 5, v2
    s_mov_b32 s32, s4
    s_mov_b32 s33, s5
    s_add_u32 m0, s38, 0
    s_add_u32 s44, s37, 0
    buffer_load_dwordx4 v3, s[32:35], s44 offen offset:0 lds
    buffer_load_dwordx4 v3, s[32:35], s44 offen offset:1024 lds
    buffer_load_dwordx4 v3, s[32:35], s44 offen offset:2048 lds
    buffer_load_dwordx4 v3, s[32:35], s44 offen offset:3072 lds
    s_add_u32 m0, s38, 4096
    s_add_u32 s44, s37, 4096
    buffer_load_dwordx4 v3, s[32:35], s44 offen offset:0 lds
    buffer_load_dwordx4 v3, s[32:35], s44 offen offset:1024 lds
    buffer_load_dwordx4 v3, s[32:35], s44 offen offset:2048 lds
    buffer_load_dwordx4 v3, s[32:35], s44 offen offset:3072 lds
    s_add_u32 m0, s38, 8192
    s_add_u32 s44, s37, 8192
    buffer_load_dwordx4 v3, s[32:35], s44 offen offset:0 lds
    buffer_load_dwordx4 v3, s[32:35], s44 offen offset:1024 lds
    buffer_load_dwordx4 v3, s[32:35], s44 offen offset:2048 lds
    buffer_load_dwordx4 v3, s[32:35], s44 offen offset:3072 lds
    s_add_u32 m0, s38, 12288
    s_add_u32 s44, s37, 12288
    buffer_load_dwordx4 v3, s[32:35], s44 offen offset:0 lds
    buffer_load_dwordx4 v3, s[32:35], s44 offen offset:1024 lds
    buffer_load_dwordx4 v3, s[32:35], s44 offen offset:2048 lds
    buffer_load_dwordx4 v3, s[32:35], s44 offen offset:3072 lds
    s_add_u32 m0, s38, 16384
    s_add_u32 s44, s37, 16384
    buffer_load_dwordx4 v3, s[32:35], s44 offen offset:0 lds
    s_mov_b32 s32, s6
    s_mov_b32 s33, s7
    s_add_u32 m0, s38, 69888
    s_add_u32 s44, s37, 0
    buffer_load_dwordx4 v3, s[32:35], s44 offen offset:0 lds
    buffer_load_dwordx4 v3, s[32:35], s44 offen offset:1024 lds
    buffer_load_dwordx4 v3, s[32:35], s44 offen offset:2048 lds
    buffer_load_dwordx4 v3, s[32:35], s44 offen offset:3072 lds
    s_add_u32 m0, s38, 73984
    s_add_u32 s44, s37, 4096
    buffer_load_dwordx4 v3, s[32:35], s44 offen offset:0 lds
    buffer_load_dwordx4 v3, s[32:35], s44 offen offset:1024 lds
    buffer_load_dwordx4 v3, s[32:35], s44 offen offset:2048 lds
    buffer_load_dwordx4 v3, s[32:35], s44 offen offset:3072 lds
    s_add_u32 m0, s38, 78080
    s_add_u32 s44, s37, 8192
    buffer_load_dwordx4 v3, s[32:35], s44 offen offset:0 lds
    buffer_load_dwordx4 v3, s[32:35], s44 offen offset:1024 lds
    buffer_load_dwordx4 v3, s[32:35], s44 offen offset:2048 lds
    buffer_load_dwordx4 v3, s[32:35], s44 offen offset:3072 lds
    s_add_u32 m0, s38, 82176
    s_add_u32 s44, s37, 12288
    buffer_load_dwordx4 v3, s[32:35], s44 offen offset:0 lds
    buffer_load_dwordx4 v3, s[32:35], s44 offen offset:1024 lds
    buffer_load_dwordx4 v3, s[32:35], s44 offen offset:2048 lds
    buffer_load_dwordx4 v3, s[32:35], s44 offen offset:3072 lds
    s_add_u32 m0, s38, 86272
    s_add_u32 s44, s37, 16384
    buffer_load_dwordx4 v3, s[32:35], s44 offen offset:0 lds
    s_waitcnt lgkmcnt(0)
    s_add_u32 s74, s74, 1
    s_barrier
    s_mov_b32 s28, s10
    s_mov_b32 s29, s11
    s_mov_b32 s30, 268435456
    s_mov_b32 s31, 0x20000
    v_cvt_f32_u32 v10, v13
    v_mul_u32_u24 v11, v13, v14
    v_cvt_f32_u32 v11, v11
    v_mul_f32 v11, 0x3e000000, v11
    v_mov_b32 v168, v11
    v_fmamk_f32 v169, v10, 0x3d000000, v11
    v_fmamk_f32 v170, v10, 0x3d800000, v11
    v_fmamk_f32 v171, v10, 0x3dc00000, v11
    v_fmamk_f32 v172, v10, 0x3e800000, v11
    v_fmamk_f32 v173, v10, 0x3e900000, v11
    v_fmamk_f32 v174, v10, 0x3ea00000, v11
    v_fmamk_f32 v175, v10, 0x3eb00000, v11
    v_fmamk_f32 v176, v10, 0x3f000000, v11
    v_fmamk_f32 v177, v10, 0x3f080000, v11
    v_fmamk_f32 v178, v10, 0x3f100000, v11
    v_fmamk_f32 v179, v10, 0x3f180000, v11
    v_fmamk_f32 v180, v10, 0x3f400000, v11
    v_fmamk_f32 v181, v10, 0x3f480000, v11
    v_fmamk_f32 v182, v10, 0x3f500000, v11
    v_fmamk_f32 v183, v10, 0x3f580000, v11
    v_fract_f32 v168, v168
    v_fract_f32 v169, v169
    v_fract_f32 v170, v170
    v_fract_f32 v171, v171
    v_fract_f32 v172, v172
    v_fract_f32 v173, v173
    v_fract_f32 v174, v174
    v_fract_f32 v175, v175
    v_fract_f32 v176, v176
    v_fract_f32 v177, v177
    v_fract_f32 v178, v178
    v_fract_f32 v179, v179
    v_fract_f32 v180, v180
    v_fract_f32 v181, v181
    v_fract_f32 v182, v182
    v_fract_f32 v183, v183
    v_cos_f32 v184, v168
    v_cos_f32 v185, v169
    v_cos_f32 v186, v170
    v_cos_f32 v187, v171
    v_cos_f32 v188, v172
    v_cos_f32 v189, v173
    v_cos_f32 v190, v174
    v_cos_f32 v191, v175
    v_cos_f32 v192, v176
    v_cos_f32 v193, v177
    v_cos_f32 v194, v178
    v_cos_f32 v195, v179
    v_cos_f32 v196, v180
    v_cos_f32 v197, v181
    v_cos_f32 v198, v182
    v_cos_f32 v199, v183
    v_sin_f32 v200, v168
    v_sin_f32 v201, v169
    v_sin_f32 v202, v170
    v_sin_f32 v203, v171
    v_sin_f32 v204, v172
    v_sin_f32 v205, v173
    v_sin_f32 v206, v174
    v_sin_f32 v207, v175
    v_sin_f32 v208, v176
    v_sin_f32 v209, v177
    v_sin_f32 v210, v178
    v_sin_f32 v211, v179
    v_sin_f32 v212, v180
    v_sin_f32 v213, v181
    v_sin_f32 v214, v182
    v_sin_f32 v215, v183
    v_cvt_pk_bf16_f32 v16, v184, v185
    v_cvt_pk_bf16_f32 v24, v200, v201
    v_cvt_pk_bf16_f32 v32, -v200, -v201
    v_cvt_pk_bf16_f32 v17, v186, v187
    v_cvt_pk_bf16_f32 v25, v202, v203
    v_cvt_pk_bf16_f32 v33, -v202, -v203
    v_cvt_pk_bf16_f32 v18, v188, v189
    v_cvt_pk_bf16_f32 v26, v204, v205
    v_cvt_pk_bf16_f32 v34, -v204, -v205
    v_cvt_pk_bf16_f32 v19, v190, v191
    v_cvt_pk_bf16_f32 v27, v206, v207
    v_cvt_pk_bf16_f32 v35, -v206, -v207
    v_cvt_pk_bf16_f32 v20, v192, v193
    v_cvt_pk_bf16_f32 v28, v208, v209
    v_cvt_pk_bf16_f32 v36, -v208, -v209
    v_cvt_pk_bf16_f32 v21, v194, v195
    v_cvt_pk_bf16_f32 v29, v210, v211
    v_cvt_pk_bf16_f32 v37, -v210, -v211
    v_cvt_pk_bf16_f32 v22, v196, v197
    v_cvt_pk_bf16_f32 v30, v212, v213
    v_cvt_pk_bf16_f32 v38, -v212, -v213
    v_cvt_pk_bf16_f32 v23, v198, v199
    v_cvt_pk_bf16_f32 v31, v214, v215
    v_cvt_pk_bf16_f32 v39, -v214, -v215
    v_cvt_f32_u32 v10, v13
    v_mul_u32_u24 v11, v13, v14
    v_cvt_f32_u32 v11, v11
    v_mul_f32 v11, 0x3b800000, v11
    v_mov_b32 v56, v11
    v_fmamk_f32 v57, v10, 0x3a800000, v11
    v_fmamk_f32 v58, v10, 0x3b000000, v11
    v_fmamk_f32 v59, v10, 0x3b400000, v11
    v_fmamk_f32 v60, v10, 0x3c000000, v11
    v_fmamk_f32 v61, v10, 0x3c100000, v11
    v_fmamk_f32 v62, v10, 0x3c200000, v11
    v_fmamk_f32 v63, v10, 0x3c300000, v11
    v_fmamk_f32 v64, v10, 0x3c800000, v11
    v_fmamk_f32 v65, v10, 0x3c880000, v11
    v_fmamk_f32 v66, v10, 0x3c900000, v11
    v_fmamk_f32 v67, v10, 0x3c980000, v11
    v_fmamk_f32 v68, v10, 0x3cc00000, v11
    v_fmamk_f32 v69, v10, 0x3cc80000, v11
    v_fmamk_f32 v70, v10, 0x3cd00000, v11
    v_fmamk_f32 v71, v10, 0x3cd80000, v11
    v_cos_f32 v40, v56
    v_cos_f32 v41, v57
    v_cos_f32 v42, v58
    v_cos_f32 v43, v59
    v_cos_f32 v44, v60
    v_cos_f32 v45, v61
    v_cos_f32 v46, v62
    v_cos_f32 v47, v63
    v_cos_f32 v48, v64
    v_cos_f32 v49, v65
    v_cos_f32 v50, v66
    v_cos_f32 v51, v67
    v_cos_f32 v52, v68
    v_cos_f32 v53, v69
    v_cos_f32 v54, v70
    v_cos_f32 v55, v71
    v_sin_f32 v56, v56
    v_sin_f32 v57, v57
    v_sin_f32 v58, v58
    v_sin_f32 v59, v59
    v_sin_f32 v60, v60
    v_sin_f32 v61, v61
    v_sin_f32 v62, v62
    v_sin_f32 v63, v63
    v_sin_f32 v64, v64
    v_sin_f32 v65, v65
    v_sin_f32 v66, v66
    v_sin_f32 v67, v67
    v_sin_f32 v68, v68
    v_sin_f32 v69, v69
    v_sin_f32 v70, v70
    v_sin_f32 v71, v71
L_fa:
    s_cmp_lg_u32 s16, 0
    s_cbranch_scc1 L_fa_zo
    s_bfe_u32 s37, s2, 0x30004
    v_and_b32 v5, 7, v2
    v_lshrrev_b32 v6, 3, v2
    v_lshlrev_b32 v9, 15, v6
    v_lshl_add_u32 v9, v5, 4, v9
    v_xor_b32 v5, s37, v5
    v_and_b32 v7, 1, v5
    v_lshlrev_b32 v7, 4, v7
    v_and_b32 v5, 6, v5
    v_add_u32 v7, v7, v5
    v_bfe_u32 v5, v2, 4, 1
    v_lshl_add_u32 v7, v5, 3, v7
    v_and_b32 v5, 1, v6
    v_add_u32 v7, v7, v5
    v_mul_u32_u24 v7, 144, v7
    v_lshrrev_b32 v5, 5, v2
    v_lshl_add_u32 v7, v5, 2, v7
    v_add_u32 v7, 139776, v7
    v_lshlrev_b32 v3, 4, v2
    v_add_u32 v6, 158208, v3
    s_lshl_b32 s46, s2, 7
    ds_read2st64_b32 v[104:105], v7 offset0:0 offset1:18
    ds_read2st64_b32 v[106:107], v7 offset0:36 offset1:54
    v_add_u32 v7, 8, v7
    ds_read2st64_b32 v[108:109], v7 offset0:0 offset1:18
    ds_read2st64_b32 v[110:111], v7 offset0:36 offset1:54
    v_add_u32 v7, 8, v7
    ds_read2st64_b32 v[112:113], v7 offset0:0 offset1:18
    ds_read2st64_b32 v[114:115], v7 offset0:36 offset1:54
    v_add_u32 v7, 8, v7
    ds_read2st64_b32 v[116:117], v7 offset0:0 offset1:18
    ds_read2st64_b32 v[118:119], v7 offset0:36 offset1:54
    v_add_u32 v7, 8, v7
    ds_read2st64_b32 v[120:121], v7 offset0:0 offset1:18
    ds_read2st64_b32 v[122:123], v7 offset0:36 offset1:54
    v_add_u32 v7, 8, v7
    ds_read2st64_b32 v[124:125], v7 offset0:0 offset1:18
    ds_read2st64_b32 v[126:127], v7 offset0:36 offset1:54
    v_add_u32 v7, 8, v7
    ds_read2st64_b32 v[128:129], v7 offset0:0 offset1:18
    ds_read2st64_b32 v[130:131], v7 offset0:36 offset1:54
    s_waitcnt lgkmcnt(12)
    s_add_u32 s47, s46, 16777216
    buffer_store_dwordx4 v[104:107], v9, s[28:31], s47 offen sc1
    v_add_u32 v7, 8, v7
    ds_read2st64_b32 v[132:133], v7 offset0:0 offset1:18
    ds_read2st64_b32 v[134:135], v7 offset0:36 offset1:54
    s_waitcnt lgkmcnt(12)
    s_add_u32 s47, s46, 17039360
    buffer_store_dwordx4 v[108:111], v9, s[28:31], s47 offen sc1
    v_add_u32 v7, 8, v7
    ds_read2st64_b32 v[136:137], v7 offset0:0 offset1:18
    ds_read2st64_b32 v[138:139], v7 offset0:36 offset1:54
    s_waitcnt lgkmcnt(12)
    s_add_u32 s47, s46, 17301504
    buffer_store_dwordx4 v[112:115], v9, s[28:31], s47 offen sc1
    v_add_u32 v7, 8, v7
    ds_read2st64_b32 v[140:141], v7 offset0:0 offset1:18
    ds_read2st64_b32 v[142:143], v7 offset0:36 offset1:54
    s_waitcnt lgkmcnt(12)
    s_add_u32 s47, s46, 17563648
    buffer_store_dwordx4 v[116:119], v9, s[28:31], s47 offen sc1
    v_add_u32 v7, 8, v7
    ds_read2st64_b32 v[144:145], v7 offset0:0 offset1:18
    ds_read2st64_b32 v[146:147], v7 offset0:36 offset1:54
    s_waitcnt lgkmcnt(12)
    s_add_u32 s47, s46, 17825792
    buffer_store_dwordx4 v[120:123], v9, s[28:31], s47 offen sc1
    v_add_u32 v7, 8, v7
    ds_read2st64_b32 v[148:149], v7 offset0:0 offset1:18
    ds_read2st64_b32 v[150:151], v7 offset0:36 offset1:54
    s_waitcnt lgkmcnt(12)
    s_add_u32 s47, s46, 18087936
    buffer_store_dwordx4 v[124:127], v9, s[28:31], s47 offen sc1
    v_add_u32 v7, 8, v7
    ds_read2st64_b32 v[152:153], v7 offset0:0 offset1:18
    ds_read2st64_b32 v[154:155], v7 offset0:36 offset1:54
    s_waitcnt lgkmcnt(12)
    s_add_u32 s47, s46, 18350080
    buffer_store_dwordx4 v[128:131], v9, s[28:31], s47 offen sc1
    v_add_u32 v7, 8, v7
    ds_read2st64_b32 v[156:157], v7 offset0:0 offset1:18
    ds_read2st64_b32 v[158:159], v7 offset0:36 offset1:54
    s_waitcnt lgkmcnt(12)
    s_add_u32 s47, s46, 18612224
    buffer_store_dwordx4 v[132:135], v9, s[28:31], s47 offen sc1
    v_add_u32 v7, 8, v7
    ds_read2st64_b32 v[160:161], v7 offset0:0 offset1:18
    ds_read2st64_b32 v[162:163], v7 offset0:36 offset1:54
    s_waitcnt lgkmcnt(12)
    s_add_u32 s47, s46, 18874368
    buffer_store_dwordx4 v[136:139], v9, s[28:31], s47 offen sc1
    v_add_u32 v7, 8, v7
    ds_read2st64_b32 v[164:165], v7 offset0:0 offset1:18
    ds_read2st64_b32 v[166:167], v7 offset0:36 offset1:54
    s_waitcnt lgkmcnt(12)
    s_add_u32 s47, s46, 19136512
    buffer_store_dwordx4 v[140:143], v9, s[28:31], s47 offen sc1
    ds_read_b128 v[168:171], v6
    s_waitcnt lgkmcnt(0)
    s_add_u32 s47, s46, 19398656
    buffer_store_dwordx4 v[144:147], v9, s[28:31], s47 offen sc1
    s_add_u32 s47, s46, 19660800
    buffer_store_dwordx4 v[148:151], v9, s[28:31], s47 offen sc1
    s_add_u32 s47, s46, 19922944
    buffer_store_dwordx4 v[152:155], v9, s[28:31], s47 offen sc1
    s_add_u32 s47, s46, 20185088
    buffer_store_dwordx4 v[156:159], v9, s[28:31], s47 offen sc1
    s_add_u32 s47, s46, 20447232
    buffer_store_dwordx4 v[160:163], v9, s[28:31], s47 offen sc1
    s_add_u32 s47, s46, 20709376
    buffer_store_dwordx4 v[164:167], v9, s[28:31], s47 offen sc1
    s_add_u32 s47, s46, 14680064
    s_mov_b64 exec, 0xff
    buffer_store_dwordx4 v[168:171], v3, s[28:31], s47 offen sc1
    s_mov_b64 exec, -1
L_fa_zo:
    v_lshl_add_u32 v10, v14, 7, v13
    v_cvt_f32_u32 v10, v10
    v_mul_f32 v10, 0x3a000000, v10
    v_add_f32 v88, 0x0, v10
    v_add_f32 v89, 0x3c800000, v10
    v_add_f32 v90, 0x3d000000, v10
    v_add_f32 v91, 0x3d400000, v10
    v_add_f32 v92, 0x3e000000, v10
    v_add_f32 v93, 0x3e100000, v10
    v_add_f32 v94, 0x3e200000, v10
    v_add_f32 v95, 0x3e300000, v10
    v_add_f32 v96, 0x3e800000, v10
    v_add_f32 v97, 0x3e880000, v10
    v_add_f32 v98, 0x3e900000, v10
    v_add_f32 v99, 0x3e980000, v10
    v_add_f32 v100, 0x3ec00000, v10
    v_add_f32 v101, 0x3ec80000, v10
    v_add_f32 v102, 0x3ed00000, v10
    v_add_f32 v103, 0x3ed80000, v10
    v_cos_f32 v72, v88
    v_cos_f32 v73, v89
    v_cos_f32 v74, v90
    v_cos_f32 v75, v91
    v_cos_f32 v76, v92
    v_cos_f32 v77, v93
    v_cos_f32 v78, v94
    v_cos_f32 v79, v95
    v_cos_f32 v80, v96
    v_cos_f32 v81, v97
    v_cos_f32 v82, v98
    v_cos_f32 v83, v99
    v_cos_f32 v84, v100
    v_cos_f32 v85, v101
    v_cos_f32 v86, v102
    v_cos_f32 v87, v103
    v_sin_f32 v88, v88
    v_sin_f32 v89, v89
    v_sin_f32 v90, v90
    v_sin_f32 v91, v91
    v_sin_f32 v92, v92
    v_sin_f32 v93, v93
    v_sin_f32 v94, v94
    v_sin_f32 v95, v95
    v_sin_f32 v96, v96
    v_sin_f32 v97, v97
    v_sin_f32 v98, v98
    v_sin_f32 v99, v99
    v_sin_f32 v100, v100
    v_sin_f32 v101, v101
    v_sin_f32 v102, v102
    v_sin_f32 v103, v103
    s_lshl_b32 s44, s16, 1
    v_add_u32 v4, s44, v14
    v_and_b32 v5, 3, v4
    v_bfe_u32 v6, v2, 2, 2
    v_mul_u32_u24 v6, 17472, v6
    v_mul_u32_u24 v7, 1026, v4
    v_add_u32 v6, v6, v7
    v_bfe_u32 v7, v2, 4, 1
    v_lshl_add_u32 v6, v7, 5, v6
    v_and_b32 v7, 3, v2
    v_lshl_add_u32 v6, v7, 3, v6
    v_lshlrev_b32 v7, 1, v5
    v_sub_u32 v6, v6, v7
    v_add_u32 v7, 69888, v6
    v_sub_u32 v8, v13, v5
    v_and_b32 v9, 31, v8
    v_and_b32 v10, 7, v8
    v_xor_b32 v10, v10, v4
    v_lshlrev_b32 v10, 4, v10
    v_lshl_add_u32 v9, v9, 11, v10
    v_cmp_gt_i32 vcc, 0, v8
    v_subrev_u32 v11, 256, v9
    s_nop 0
    v_cndmask_b32 v9, v9, v11, vcc
    v_add_u32 v15, 63488, v9
    v_cndmask_b32 v3, v15, v9, vcc
    v_add_u32 v11, 4096, v15
    v_cndmask_b32 v11, v10, v11, vcc
    v_cmp_ge_i32 vcc, 0, v8
    s_nop 0
    s_mov_b64 s[66:67], vcc
    s_waitcnt vmcnt(0)
    s_cmp_lg_u32 s16, 0
    s_cbranch_scc1 L_fa_nz
    s_lshl_b32 s44, s2, 7
    s_add_u32 s44, s44, 15106048
    v_mov_b32 v4, s74
    v_mov_b32 v5, 0
    s_mov_b64 exec, 1
    buffer_store_dword v4, v5, s[28:31], s44 offen sc1
    s_mov_b64 exec, -1
L_fa_nz:
    s_barrier
    s_lshl_b32 s62, s2, 3
    s_add_u32 s62, s62, s16
    s_lshr_b32 s63, s62, 6
    s_lshl_b32 s63, s63, 4
    s_add_u32 s63, s63, s62
    s_lshl_b32 s63, s63, 15
    s_bfe_u32 s62, s62, 0x20004
    s_lshl_b32 s62, s62, 9
    s_add_u32 s62, s62, s63
    s_mov_b32 s70, 7340032
    s_mov_b32 s71, 0x20000
    v_lshrrev_b32 v254, 2, v2
    v_lshlrev_b32 v254, 11, v254
    v_and_b32 v255, 3, v2
    v_lshl_add_u32 v253, v255, 7, v254
    v_lshlrev_b32 v255, 7, v2
    buffer_load_dword v254, v253, s[68:71], s62 offen
    ds_read_b64_tr_b16 v[104:105], v6 offset:0
    ds_read_b64_tr_b16 v[106:107], v7 offset:0
    ds_read_b64_tr_b16 v[108:109], v6 offset:64
    ds_read_b64_tr_b16 v[110:111], v7 offset:64
    ds_read_b64_tr_b16 v[112:113], v6 offset:128
    ds_read_b64_tr_b16 v[114:115], v7 offset:128
    ds_read_b64_tr_b16 v[116:117], v6 offset:192
    ds_read_b64_tr_b16 v[118:119], v7 offset:192
    ds_read_b64_tr_b16 v[120:121], v6 offset:256
    ds_read_b64_tr_b16 v[122:123], v7 offset:256
    ds_read_b64_tr_b16 v[124:125], v6 offset:320
    ds_read_b64_tr_b16 v[126:127], v7 offset:320
    ds_read_b64_tr_b16 v[128:129], v6 offset:384
    ds_read_b64_tr_b16 v[130:131], v7 offset:384
    ds_read_b64_tr_b16 v[132:133], v6 offset:448
    ds_read_b64_tr_b16 v[134:135], v7 offset:448
    ds_read_b64_tr_b16 v[136:137], v6 offset:512
    ds_read_b64_tr_b16 v[138:139], v7 offset:512
    ds_read_b64_tr_b16 v[140:141], v6 offset:576
    ds_read_b64_tr_b16 v[142:143], v7 offset:576
    ds_read_b64_tr_b16 v[144:145], v6 offset:640
    ds_read_b64_tr_b16 v[146:147], v7 offset:640
    ds_read_b64_tr_b16 v[148:149], v6 offset:704
    ds_read_b64_tr_b16 v[150:151], v7 offset:704
    ds_read_b64_tr_b16 v[152:153], v6 offset:768
    ds_read_b64_tr_b16 v[154:155], v7 offset:768
    ds_read_b64_tr_b16 v[156:157], v6 offset:832
    ds_read_b64_tr_b16 v[158:159], v7 offset:832
    ds_read_b64_tr_b16 v[160:161], v6 offset:896
    ds_read_b64_tr_b16 v[162:163], v7 offset:896
    ds_read_b64_tr_b16 v[164:165], v6 offset:960
    ds_read_b64_tr_b16 v[166:167], v7 offset:960
    ds_read_b64_tr_b16 v[168:169], v6 offset:1024
    ds_read_b64_tr_b16 v[170:171], v7 offset:1024
    s_waitcnt lgkmcnt(0)
    s_barrier
    ds_write_b128 v9, v[108:111] offset:256
    ds_write_b128 v9, v[112:115] offset:512
    ds_write_b128 v9, v[116:119] offset:768
    ds_write_b128 v9, v[120:123] offset:1024
    ds_write_b128 v9, v[124:127] offset:1280
    ds_write_b128 v9, v[128:131] offset:1536
    ds_write_b128 v9, v[132:135] offset:1792
    ds_write_b128 v3, v[136:139] offset:2048
    ds_write_b128 v15, v[140:143] offset:2304
    ds_write_b128 v15, v[144:147] offset:2560
    ds_write_b128 v15, v[148:151] offset:2816
    ds_write_b128 v15, v[152:155] offset:3072
    ds_write_b128 v15, v[156:159] offset:3328
    ds_write_b128 v15, v[160:163] offset:3584
    ds_write_b128 v15, v[164:167] offset:3840
    s_not_b64 exec, s[66:67]
    ds_write_b128 v9, v[104:107]
    s_mov_b64 exec, s[66:67]
    ds_write_b128 v11, v[168:171]
    s_mov_b64 exec, -1
    s_lshl_b32 s47, s2, 8
    s_add_u32 s47, s47, 20971520
    v_lshlrev_b32 v12, 4, v2
    s_cmp_lg_u32 s16, 0
    s_cbranch_scc1 L_fa_zq
    s_mov_b32 s44, 15106048
    buffer_load_dword v248, v255, s[28:31], s44 offen sc1
    s_mov_b32 s44, 15114240
    buffer_load_dword v249, v255, s[28:31], s44 offen sc1
    s_mov_b32 s44, 15122432
    buffer_load_dword v250, v255, s[28:31], s44 offen sc1
    s_mov_b32 s44, 15130624
    buffer_load_dword v251, v255, s[28:31], s44 offen sc1
L_fa_zq:
    s_lshl_b32 s37, s16, 13
    s_lshl_b32 s38, s2, 17
    s_add_u32 s38, s38, 16777216
    s_add_u32 s38, s38, s37
    s_waitcnt lgkmcnt(0)
    s_barrier
    v_lshrrev_b32 v4, 7, v0
    v_lshlrev_b32 v6, 17, v4
    v_bfe_u32 v5, v0, 4, 3
    v_lshl_add_u32 v6, v5, 13, v6
    v_and_b32 v5, 15, v0
    v_lshl_add_u32 v6, v5, 4, v6
    v_xor_b32 v7, v4, v0
    v_lshlrev_b32 v7, 4, v7
    v_xor_b32 v8, 64, v7
    ds_read_b128 v[168:171], v7 offset:0
    ds_read_b128 v[172:175], v8 offset:8192
    ds_read_b128 v[176:179], v7 offset:16384
    ds_read_b128 v[180:183], v8 offset:24576
    ds_read_b128 v[184:187], v7 offset:32768
    ds_read_b128 v[188:191], v8 offset:40960
    ds_read_b128 v[192:195], v7 offset:49152
    ds_read_b128 v[196:199], v8 offset:57344
    s_waitcnt lgkmcnt(7)
    s_add_u32 s80, s47, 0
    buffer_store_dwordx4 v[168:171], v6, s[28:31], s80 offen sc1
    s_waitcnt lgkmcnt(6)
    s_add_u32 s80, s47, 524288
    buffer_store_dwordx4 v[172:175], v6, s[28:31], s80 offen sc1
    s_waitcnt lgkmcnt(5)
    s_add_u32 s80, s47, 1048576
    buffer_store_dwordx4 v[176:179], v6, s[28:31], s80 offen sc1
    s_waitcnt lgkmcnt(4)
    s_add_u32 s80, s47, 1572864
    buffer_store_dwordx4 v[180:183], v6, s[28:31], s80 offen sc1
    s_waitcnt lgkmcnt(3)
    s_add_u32 s80, s47, 2097152
    buffer_store_dwordx4 v[184:187], v6, s[28:31], s80 offen sc1
    s_waitcnt lgkmcnt(2)
    s_add_u32 s80, s47, 2621440
    buffer_store_dwordx4 v[188:191], v6, s[28:31], s80 offen sc1
    s_waitcnt lgkmcnt(1)
    s_add_u32 s80, s47, 3145728
    buffer_store_dwordx4 v[192:195], v6, s[28:31], s80 offen sc1
    s_waitcnt lgkmcnt(0)
    s_add_u32 s80, s47, 3670016
    buffer_store_dwordx4 v[196:199], v6, s[28:31], s80 offen sc1
    s_cmp_lg_u32 s16, 0
    s_cbranch_scc1 L_fa_zw
    s_mov_b32 s83, 0x20000
    s_waitcnt vmcnt(8)
    s_branch L_fa_zp_w
L_fa_zp:
    s_mov_b32 s44, 15106048
    buffer_load_dword v248, v255, s[28:31], s44 offen sc1
    s_mov_b32 s44, 15114240
    buffer_load_dword v249, v255, s[28:31], s44 offen sc1
    s_mov_b32 s44, 15122432
    buffer_load_dword v250, v255, s[28:31], s44 offen sc1
    s_mov_b32 s44, 15130624
    buffer_load_dword v251, v255, s[28:31], s44 offen sc1
    s_waitcnt vmcnt(0)
L_fa_zp_w:
    v_cmp_ne_u32 vcc, s74, v248
    s_nop 0
    s_mov_b64 s[80:81], vcc
    v_cmp_ne_u32 vcc, s74, v249
    s_nop 0
    s_or_b64 s[80:81], s[80:81], vcc
    v_cmp_ne_u32 vcc, s74, v250
    s_nop 0
    s_or_b64 s[80:81], s[80:81], vcc
    v_cmp_ne_u32 vcc, s74, v251
    s_nop 0
    s_or_b64 s[80:81], s[80:81], vcc
    s_cmp_eq_u64 s[80:81], 0
    s_cbranch_scc1 L_fa_zp_ok
    s_sleep 8
    s_sub_u32 s83, s83, 1
    s_cmp_lg_u32 s83, 0
    s_cbranch_scc1 L_fa_zp
L_fa_zp_ok:
    s_cmp_lg_u32 s2, 0
    s_cbranch_scc1 L_fa_zw
    s_mov_b32 s44, 15040512
    v_mov_b32 v248, s74
    v_mov_b32 v249, 0
    s_mov_b64 exec, 1
    buffer_store_dword v248, v249, s[28:31], s44 offen sc1
    s_mov_b64 exec, -1
L_fa_zw:
    s_barrier
    s_add_u32 m0, s37, 0
    s_add_u32 s39, s38, 0
    buffer_load_dwordx4 v12, s[28:31], s39 offen offset:0 sc1 lds
    buffer_load_dwordx4 v12, s[28:31], s39 offen offset:1024 sc1 lds
    buffer_load_dwordx4 v12, s[28:31], s39 offen offset:2048 sc1 lds
    buffer_load_dwordx4 v12, s[28:31], s39 offen offset:3072 sc1 lds
    s_add_u32 m0, s37, 4096
    s_add_u32 s39, s38, 4096
    buffer_load_dwordx4 v12, s[28:31], s39 offen offset:0 sc1 lds
    buffer_load_dwordx4 v12, s[28:31], s39 offen offset:1024 sc1 lds
    buffer_load_dwordx4 v12, s[28:31], s39 offen offset:2048 sc1 lds
    buffer_load_dwordx4 v12, s[28:31], s39 offen offset:3072 sc1 lds
    v_add_u32 v7, 0x10000, v7
    v_add_u32 v8, 0x10000, v8
    ds_read_b128 v[200:203], v7 offset:0
    ds_read_b128 v[204:207], v8 offset:8192
    ds_read_b128 v[208:211], v7 offset:16384
    ds_read_b128 v[212:215], v8 offset:24576
    ds_read_b128 v[216:219], v7 offset:32768
    ds_read_b128 v[220:223], v8 offset:40960
    ds_read_b128 v[224:227], v7 offset:49152
    ds_read_b128 v[228:231], v8 offset:57344
    s_waitcnt lgkmcnt(7)
    s_add_u32 s80, s47, 65536
    buffer_store_dwordx4 v[200:203], v6, s[28:31], s80 offen sc1
    s_waitcnt lgkmcnt(6)
    s_add_u32 s80, s47, 589824
    buffer_store_dwordx4 v[204:207], v6, s[28:31], s80 offen sc1
    s_waitcnt lgkmcnt(5)
    s_add_u32 s80, s47, 1114112
    buffer_store_dwordx4 v[208:211], v6, s[28:31], s80 offen sc1
    s_waitcnt lgkmcnt(4)
    s_add_u32 s80, s47, 1638400
    buffer_store_dwordx4 v[212:215], v6, s[28:31], s80 offen sc1
    s_waitcnt lgkmcnt(3)
    s_add_u32 s80, s47, 2162688
    buffer_store_dwordx4 v[216:219], v6, s[28:31], s80 offen sc1
    s_waitcnt lgkmcnt(2)
    s_add_u32 s80, s47, 2686976
    buffer_store_dwordx4 v[220:223], v6, s[28:31], s80 offen sc1
    s_waitcnt lgkmcnt(1)
    s_add_u32 s80, s47, 3211264
    buffer_store_dwordx4 v[224:227], v6, s[28:31], s80 offen sc1
    s_waitcnt lgkmcnt(0)
    s_add_u32 s80, s47, 3735552
    buffer_store_dwordx4 v[228:231], v6, s[28:31], s80 offen sc1
    s_add_u32 s38, s38, 0x10000
    s_cmp_ge_u32 s16, 4
    s_cselect_b32 s38, 0x7f000000, s38
    s_lshl_b32 s36, s2, 4
    s_add_u32 s36, s36, s16
    s_mov_b32 s17, 0
    v_lshrrev_b32 v4, 1, v13
    v_and_b32 v5, 7, v4
    s_and_b32 s41, s16, 3
    s_lshl_b32 s42, s41, 1
    v_xor_b32 v5, s42, v5
    v_lshlrev_b32 v5, 4, v5
    v_lshl_add_u32 v5, v4, 11, v5
    v_lshl_add_u32 v5, v14, 8, v5
    v_and_b32 v4, 1, v2
    v_lshl_add_u32 v5, v4, 7, v5
    s_lshr_b32 s42, s16, 2
    s_lshl_b32 s42, s42, 15
    v_add_u32 v5, s42, v5
    v_xor_b32 v6, 16, v5
    s_mul_i32 s41, s16, 8192
    s_add_u32 s41, s41, 65536
    v_add_u32 v7, s41, v12
    v_xor_b32 v15, 64, v7
    s_bfe_u32 s41, s2, 0x30001
    v_and_b32 v4, 7, v0
    v_xor_b32 v8, s41, v4
    v_and_b32 v10, 1, v8
    v_mul_u32_u24 v10, 4160, v10
    v_lshrrev_b32 v9, 5, v0
    v_lshlrev_b32 v11, 6, v9
    v_xor_b32 v10, v10, v11
    v_lshrrev_b32 v8, 1, v8
    v_lshl_add_u32 v10, v8, 4, v10
    v_bfe_u32 v8, v0, 3, 2
    v_lshl_add_u32 v10, v8, 2, v10
    v_add_u32 v10, 65536, v10
    v_lshlrev_b32 v11, 17, v8
    v_and_b32 v8, 7, v9
    v_lshl_add_u32 v11, v8, 14, v11
    v_lshrrev_b32 v8, 3, v9
    v_lshl_add_u32 v11, v8, 19, v11
    v_lshl_add_u32 v11, v4, 4, v11
    v_add_u32 v8, 32768, v10
    s_lshl_b32 s45, s2, 7
    s_add_u32 s45, s45, 25165824
    v_lshlrev_b32 v4, 7, v13
    s_waitcnt vmcnt(8)
    s_barrier
    s_cmp_lg_u32 s16, 0
    s_cbranch_scc1 L_fa_nw
    s_lshl_b32 s44, s2, 7
    s_add_u32 s44, s44, 15048704
    v_mov_b32 v9, s74
    v_mov_b32 v3, 0
    s_mov_b64 exec, 1
    buffer_store_dword v9, v3, s[28:31], s44 offen sc1
    s_mov_b64 exec, -1
L_fa_nw:
L_f2_round:
    ds_read_b128 v[104:107], v5 offset:0
    ds_read_b128 v[108:111], v5 offset:512
    ds_read_b128 v[112:115], v6 offset:0
    ds_read_b128 v[116:119], v6 offset:512
    ds_read_b128 v[120:123], v5 offset:1024
    ds_read_b128 v[124:127], v5 offset:1536
    ds_read_b128 v[128:131], v6 offset:1024
    ds_read_b128 v[132:135], v6 offset:1536
    s_waitcnt lgkmcnt(4)
    v_mfma_f32_32x32x16_bf16 v[168:183], v[104:107], v[16:19], 0
    v_mfma_f32_32x32x16_bf16 v[168:183], v[108:111], v[20:23], v[168:183]
    v_mfma_f32_32x32x16_bf16 v[184:199], v[112:115], v[16:19], 0
    v_mfma_f32_32x32x16_bf16 v[184:199], v[116:119], v[20:23], v[184:199]
    v_mfma_f32_32x32x16_bf16 v[168:183], v[112:115], v[24:27], v[168:183]
    v_mfma_f32_32x32x16_bf16 v[168:183], v[116:119], v[28:31], v[168:183]
    v_mfma_f32_32x32x16_bf16 v[184:199], v[104:107], v[32:35], v[184:199]
    v_mfma_f32_32x32x16_bf16 v[184:199], v[108:111], v[36:39], v[184:199]
    s_waitcnt lgkmcnt(0)
    v_mfma_f32_32x32x16_bf16 v[200:215], v[120:123], v[16:19], 0
    v_mfma_f32_32x32x16_bf16 v[200:215], v[124:127], v[20:23], v[200:215]
    s_nop 8
    v_mul_f32 v232, v184, v56
    v_mul_f32 v233, v185, v57
    v_mul_f32 v234, v168, v56
    v_mul_f32 v235, v169, v57
    v_fmac_f32 v232, v168, v40
    v_fmac_f32 v233, v169, v41
    v_fma_f32 v234, v184, v40, -v234
    v_fma_f32 v235, v185, v41, -v235
    v_mfma_f32_32x32x16_bf16 v[216:231], v[128:131], v[16:19], 0
    v_cvt_pk_bf16_f32 v104, v232, v233
    v_cvt_pk_bf16_f32 v112, v234, v235
    v_mul_f32 v236, v186, v58
    v_mul_f32 v237, v187, v59
    v_mul_f32 v238, v170, v58
    v_mul_f32 v239, v171, v59
    v_fmac_f32 v236, v170, v42
    v_mfma_f32_32x32x16_bf16 v[216:231], v[132:135], v[20:23], v[216:231]
    v_fmac_f32 v237, v171, v43
    v_fma_f32 v238, v186, v42, -v238
    v_fma_f32 v239, v187, v43, -v239
    v_cvt_pk_bf16_f32 v105, v236, v237
    v_cvt_pk_bf16_f32 v113, v238, v239
    v_mul_f32 v232, v188, v60
    v_mul_f32 v233, v189, v61
    v_mfma_f32_32x32x16_bf16 v[200:215], v[128:131], v[24:27], v[200:215]
    v_mul_f32 v234, v172, v60
    v_mul_f32 v235, v173, v61
    v_fmac_f32 v232, v172, v44
    v_fmac_f32 v233, v173, v45
    v_fma_f32 v234, v188, v44, -v234
    v_fma_f32 v235, v189, v45, -v235
    v_cvt_pk_bf16_f32 v106, v232, v233
    v_mfma_f32_32x32x16_bf16 v[200:215], v[132:135], v[28:31], v[200:215]
    v_cvt_pk_bf16_f32 v114, v234, v235
    v_mul_f32 v236, v190, v62
    v_mul_f32 v237, v191, v63
    v_mul_f32 v238, v174, v62
    v_mul_f32 v239, v175, v63
    v_fmac_f32 v236, v174, v46
    v_fmac_f32 v237, v175, v47
    v_mfma_f32_32x32x16_bf16 v[216:231], v[120:123], v[32:35], v[216:231]
    v_fma_f32 v238, v190, v46, -v238
    v_fma_f32 v239, v191, v47, -v239
    v_cvt_pk_bf16_f32 v107, v236, v237
    v_cvt_pk_bf16_f32 v115, v238, v239
    v_mul_f32 v232, v192, v64
    v_mul_f32 v233, v193, v65
    v_mul_f32 v234, v176, v64
    v_mfma_f32_32x32x16_bf16 v[216:231], v[124:127], v[36:39], v[216:231]
    v_mul_f32 v235, v177, v65
    v_fmac_f32 v232, v176, v48
    v_fmac_f32 v233, v177, v49
    v_fma_f32 v234, v192, v48, -v234
    v_fma_f32 v235, v193, v49, -v235
    v_cvt_pk_bf16_f32 v108, v232, v233
    v_cvt_pk_bf16_f32 v116, v234, v235
    v_pk_mul_f32 v[236:237], v[194:195], v[66:67]
    v_pk_mul_f32 v[238:239], v[178:179], v[66:67]
    v_pk_fma_f32 v[236:237], v[178:179], v[50:51], v[236:237]
    v_pk_fma_f32 v[238:239], v[194:195], v[50:51], v[238:239] neg_lo:[0,0,1] neg_hi:[0,0,1]
    v_cvt_pk_bf16_f32 v109, v236, v237
    v_cvt_pk_bf16_f32 v117, v238, v239
    v_pk_mul_f32 v[232:233], v[196:197], v[68:69]
    v_pk_mul_f32 v[234:235], v[180:181], v[68:69]
    v_pk_fma_f32 v[232:233], v[180:181], v[52:53], v[232:233]
    v_pk_fma_f32 v[234:235], v[196:197], v[52:53], v[234:235] neg_lo:[0,0,1] neg_hi:[0,0,1]
    v_cvt_pk_bf16_f32 v110, v232, v233
    v_cvt_pk_bf16_f32 v118, v234, v235
    v_pk_mul_f32 v[236:237], v[198:199], v[70:71]
    v_pk_mul_f32 v[238:239], v[182:183], v[70:71]
    v_pk_fma_f32 v[236:237], v[182:183], v[54:55], v[236:237]
    v_pk_fma_f32 v[238:239], v[198:199], v[54:55], v[238:239] neg_lo:[0,0,1] neg_hi:[0,0,1]
    v_cvt_pk_bf16_f32 v111, v236, v237
    v_cvt_pk_bf16_f32 v119, v238, v239
    s_or_b32 s44, s16, s17
    s_cmp_lg_u32 s44, 0
    s_cbranch_scc1 L_f2a_wb
    s_mov_b32 s44, 15048704
    s_mov_b32 s83, 0x20000
L_f2a_wp:
    buffer_load_dword v9, v4, s[28:31], s44 offen sc1
    s_waitcnt vmcnt(0)
L_f2a_wp_w:
    v_cmp_ne_u32 vcc, s74, v9
    s_nop 0
    s_mov_b64 s[80:81], vcc
    s_cmp_eq_u64 s[80:81], 0
    s_cbranch_scc1 L_f2a_wp_ok
    s_sleep 8
    s_sub_u32 s83, s83, 1
    s_cmp_lg_u32 s83, 0
    s_cbranch_scc1 L_f2a_wp
L_f2a_wp_ok:
L_f2a_wb:
    s_cmp_lg_u32 s17, 0
    s_cbranch_scc1 L_f2a_w2
    s_waitcnt vmcnt(0)
L_f2a_w2:
    s_cmp_ge_u32 s2, 32
    s_cbranch_scc1 L_fs_ml
    s_waitcnt lgkmcnt(0)
    s_barrier
    s_branch L_fs_mx
L_fs_ml:
    v_lshlrev_b32 v248, 2, v1
    v_add_u32 v248, 163776, v248
    v_mov_b32 v249, 4
    s_waitcnt lgkmcnt(0)
    ds_write_b32 v248, v249
    v_and_b32 v250, 3, v2
    v_and_b32 v251, 4, v1
    v_or_b32 v250, v250, v251
    v_lshlrev_b32 v250, 2, v250
    v_add_u32 v250, 163776, v250
    s_mov_b32 s83, 0x400000
L_fs_m:
    ds_read_b32 v251, v250
    s_sub_u32 s83, s83, 1
    s_cmp_eq_u32 s83, 0
    s_cbranch_scc1 L_fs_mx
    s_waitcnt lgkmcnt(0)
    v_cmp_gt_u32 vcc, 4, v251
    s_nop 4
    s_cbranch_vccnz L_fs_m
L_fs_mx:
    s_cmp_lg_u32 s17, 0
    s_cbranch_scc1 L_f2_noz
    s_cmp_lg_u32 s16, 0
    s_cbranch_scc1 L_f2a_w3
    s_lshl_b32 s44, s2, 7
    s_add_u32 s44, s44, 15052800
    v_mov_b32 v9, s74
    v_mov_b32 v3, 0
    s_mov_b64 exec, 1
    buffer_store_dword v9, v3, s[28:31], s44 offen sc1
    s_mov_b64 exec, -1
L_f2a_w3:
    s_lshl_b32 s39, s36, 13
    s_add_u32 s39, s39, 20971520
    s_add_u32 s40, s39, 4096
    buffer_load_dwordx4 v[136:139], v12, s[28:31], s39 offen offset:0 sc1
    buffer_load_dwordx4 v[140:143], v12, s[28:31], s39 offen offset:1024 sc1
    buffer_load_dwordx4 v[144:147], v12, s[28:31], s39 offen offset:2048 sc1
    buffer_load_dwordx4 v[148:151], v12, s[28:31], s39 offen offset:3072 sc1
    buffer_load_dwordx4 v[152:155], v12, s[28:31], s40 offen offset:0 sc1
    buffer_load_dwordx4 v[156:159], v12, s[28:31], s40 offen offset:1024 sc1
    buffer_load_dwordx4 v[160:163], v12, s[28:31], s40 offen offset:2048 sc1
    buffer_load_dwordx4 v[164:167], v12, s[28:31], s40 offen offset:3072 sc1
    s_add_u32 m0, s37, 0
    s_add_u32 s39, s38, 0
    buffer_load_dwordx4 v12, s[28:31], s39 offen offset:0 sc1 lds
    buffer_load_dwordx4 v12, s[28:31], s39 offen offset:1024 sc1 lds
    buffer_load_dwordx4 v12, s[28:31], s39 offen offset:2048 sc1 lds
    buffer_load_dwordx4 v12, s[28:31], s39 offen offset:3072 sc1 lds
    s_add_u32 m0, s37, 4096
    s_add_u32 s39, s38, 4096
    buffer_load_dwordx4 v12, s[28:31], s39 offen offset:0 sc1 lds
    buffer_load_dwordx4 v12, s[28:31], s39 offen offset:1024 sc1 lds
    buffer_load_dwordx4 v12, s[28:31], s39 offen offset:2048 sc1 lds
    buffer_load_dwordx4 v12, s[28:31], s39 offen offset:3072 sc1 lds
L_f2_noz:
    v_mfma_f32_32x32x16_bf16 v[168:183], v[16:19], v[104:107], 0
    v_mul_f32 v232, v216, v56
    v_mul_f32 v233, v217, v57
    v_mul_f32 v234, v200, v56
    v_mul_f32 v235, v201, v57
    v_fmac_f32 v232, v200, v40
    v_fmac_f32 v233, v201, v41
    v_fma_f32 v234, v216, v40, -v234
    v_mfma_f32_32x32x16_bf16 v[168:183], v[20:23], v[108:111], v[168:183]
    v_fma_f32 v235, v217, v41, -v235
    v_cvt_pk_bf16_f32 v120, v232, v233
    v_cvt_pk_bf16_f32 v128, v234, v235
    v_mul_f32 v236, v218, v58
    v_mul_f32 v237, v219, v59
    v_mul_f32 v238, v202, v58
    v_mul_f32 v239, v203, v59
    v_mfma_f32_32x32x16_bf16 v[184:199], v[16:19], v[112:115], 0
    v_fmac_f32 v236, v202, v42
    v_fmac_f32 v237, v203, v43
    v_fma_f32 v238, v218, v42, -v238
    v_fma_f32 v239, v219, v43, -v239
    v_cvt_pk_bf16_f32 v121, v236, v237
    v_cvt_pk_bf16_f32 v129, v238, v239
    v_mfma_f32_32x32x16_bf16 v[184:199], v[20:23], v[116:119], v[184:199]
    v_mul_f32 v232, v220, v60
    v_mul_f32 v233, v221, v61
    v_mul_f32 v234, v204, v60
    v_mul_f32 v235, v205, v61
    v_fmac_f32 v232, v204, v44
    v_fmac_f32 v233, v205, v45
    v_mfma_f32_32x32x16_bf16 v[168:183], v[24:27], v[112:115], v[168:183]
    v_fma_f32 v234, v220, v44, -v234
    v_fma_f32 v235, v221, v45, -v235
    v_cvt_pk_bf16_f32 v122, v232, v233
    v_cvt_pk_bf16_f32 v130, v234, v235
    v_mul_f32 v236, v222, v62
    v_mul_f32 v237, v223, v63
    v_mfma_f32_32x32x16_bf16 v[168:183], v[28:31], v[116:119], v[168:183]
    v_mul_f32 v238, v206, v62
    v_mul_f32 v239, v207, v63
    v_fmac_f32 v236, v206, v46
    v_fmac_f32 v237, v207, v47
    v_fma_f32 v238, v222, v46, -v238
    v_fma_f32 v239, v223, v47, -v239
    v_mfma_f32_32x32x16_bf16 v[184:199], v[32:35], v[104:107], v[184:199]
    v_cvt_pk_bf16_f32 v123, v236, v237
    v_cvt_pk_bf16_f32 v131, v238, v239
    v_mul_f32 v232, v224, v64
    v_mul_f32 v233, v225, v65
    v_mul_f32 v234, v208, v64
    v_mul_f32 v235, v209, v65
    v_mfma_f32_32x32x16_bf16 v[184:199], v[36:39], v[108:111], v[184:199]
    v_fmac_f32 v232, v208, v48
    v_fmac_f32 v233, v209, v49
    v_fma_f32 v234, v224, v48, -v234
    v_fma_f32 v235, v225, v49, -v235
    v_cvt_pk_bf16_f32 v124, v232, v233
    v_cvt_pk_bf16_f32 v132, v234, v235
    v_pk_mul_f32 v[236:237], v[226:227], v[66:67]
    v_pk_mul_f32 v[238:239], v[210:211], v[66:67]
    v_pk_fma_f32 v[236:237], v[210:211], v[50:51], v[236:237]
    v_pk_fma_f32 v[238:239], v[226:227], v[50:51], v[238:239] neg_lo:[0,0,1] neg_hi:[0,0,1]
    v_cvt_pk_bf16_f32 v125, v236, v237
    v_cvt_pk_bf16_f32 v133, v238, v239
    v_pk_mul_f32 v[232:233], v[228:229], v[68:69]
    v_pk_mul_f32 v[234:235], v[212:213], v[68:69]
    v_pk_fma_f32 v[232:233], v[212:213], v[52:53], v[232:233]
    v_pk_fma_f32 v[234:235], v[228:229], v[52:53], v[234:235] neg_lo:[0,0,1] neg_hi:[0,0,1]
    v_cvt_pk_bf16_f32 v126, v232, v233
    v_cvt_pk_bf16_f32 v134, v234, v235
    v_pk_mul_f32 v[236:237], v[230:231], v[70:71]
    v_pk_mul_f32 v[238:239], v[214:215], v[70:71]
    v_pk_fma_f32 v[236:237], v[214:215], v[54:55], v[236:237]
    v_pk_fma_f32 v[238:239], v[230:231], v[54:55], v[238:239] neg_lo:[0,0,1] neg_hi:[0,0,1]
    v_cvt_pk_bf16_f32 v127, v236, v237
    v_cvt_pk_bf16_f32 v135, v238, v239
    v_mfma_f32_32x32x16_bf16 v[200:215], v[16:19], v[120:123], 0
    v_mfma_f32_32x32x16_bf16 v[200:215], v[20:23], v[124:127], v[200:215]
    v_mfma_f32_32x32x16_bf16 v[216:231], v[16:19], v[128:131], 0
    v_mfma_f32_32x32x16_bf16 v[216:231], v[20:23], v[132:135], v[216:231]
    v_mfma_f32_32x32x16_bf16 v[200:215], v[24:27], v[128:131], v[200:215]
    v_mfma_f32_32x32x16_bf16 v[200:215], v[28:31], v[132:135], v[200:215]
    v_mfma_f32_32x32x16_bf16 v[216:231], v[32:35], v[120:123], v[216:231]
    v_mfma_f32_32x32x16_bf16 v[216:231], v[36:39], v[124:127], v[216:231]
    s_waitcnt vmcnt(8)
    v_lshlrev_b32 v236, 16, v136
    v_and_b32 v237, 0xffff0000, v136
    v_lshlrev_b32 v238, 16, v138
    v_and_b32 v239, 0xffff0000, v138
    v_lshlrev_b32 v240, 16, v152
    v_and_b32 v241, 0xffff0000, v152
    v_lshlrev_b32 v242, 16, v154
    v_and_b32 v243, 0xffff0000, v154
    s_nop 2
    v_pk_mul_f32 v[232:233], v[216:217], v[88:89]
    v_pk_mul_f32 v[234:235], v[200:201], v[88:89]
    v_pk_fma_f32 v[232:233], v[200:201], v[72:73], v[232:233]
    v_pk_fma_f32 v[234:235], v[216:217], v[72:73], v[234:235] neg_lo:[0,0,1] neg_hi:[0,0,1]
    v_pk_add_f32 v[200:201], v[168:169], v[232:233] neg_lo:[0,1] neg_hi:[0,1]
    v_pk_add_f32 v[216:217], v[184:185], v[234:235] neg_lo:[0,1] neg_hi:[0,1]
    v_pk_add_f32 v[168:169], v[168:169], v[232:233]
    v_pk_add_f32 v[184:185], v[184:185], v[234:235]
    v_pk_mul_f32 v[232:233], v[184:185], v[238:239]
    v_pk_mul_f32 v[234:235], v[168:169], v[238:239]
    v_pk_mul_f32 v[244:245], v[216:217], v[242:243]
    v_pk_mul_f32 v[246:247], v[200:201], v[242:243]
    v_pk_fma_f32 v[232:233], v[168:169], v[236:237], v[232:233] neg_lo:[0,0,1] neg_hi:[0,0,1]
    v_pk_fma_f32 v[234:235], v[184:185], v[236:237], v[234:235]
    v_pk_fma_f32 v[244:245], v[200:201], v[240:241], v[244:245] neg_lo:[0,0,1] neg_hi:[0,0,1]
    v_pk_fma_f32 v[246:247], v[216:217], v[240:241], v[246:247]
    v_pk_add_f32 v[168:169], v[232:233], v[244:245]
    v_pk_add_f32 v[184:185], v[234:235], v[246:247]
    v_pk_add_f32 v[200:201], v[232:233], v[244:245] neg_lo:[0,1] neg_hi:[0,1]
    v_pk_add_f32 v[216:217], v[234:235], v[246:247] neg_lo:[0,1] neg_hi:[0,1]
    v_cvt_pk_bf16_f32 v104, v168, v169
    v_cvt_pk_bf16_f32 v112, v184, v185
    v_lshlrev_b32 v236, 16, v137
    v_and_b32 v237, 0xffff0000, v137
    v_lshlrev_b32 v238, 16, v139
    v_and_b32 v239, 0xffff0000, v139
    v_lshlrev_b32 v240, 16, v153
    v_and_b32 v241, 0xffff0000, v153
    v_lshlrev_b32 v242, 16, v155
    v_and_b32 v243, 0xffff0000, v155
    v_pk_mul_f32 v[232:233], v[218:219], v[90:91]
    v_pk_mul_f32 v[234:235], v[202:203], v[90:91]
    v_pk_fma_f32 v[232:233], v[202:203], v[74:75], v[232:233]
    v_pk_fma_f32 v[234:235], v[218:219], v[74:75], v[234:235] neg_lo:[0,0,1] neg_hi:[0,0,1]
    v_pk_add_f32 v[202:203], v[170:171], v[232:233] neg_lo:[0,1] neg_hi:[0,1]
    v_pk_add_f32 v[218:219], v[186:187], v[234:235] neg_lo:[0,1] neg_hi:[0,1]
    v_pk_add_f32 v[170:171], v[170:171], v[232:233]
    v_pk_add_f32 v[186:187], v[186:187], v[234:235]
    v_pk_mul_f32 v[232:233], v[186:187], v[238:239]
    v_pk_mul_f32 v[234:235], v[170:171], v[238:239]
    v_pk_mul_f32 v[244:245], v[218:219], v[242:243]
    v_pk_mul_f32 v[246:247], v[202:203], v[242:243]
    v_pk_fma_f32 v[232:233], v[170:171], v[236:237], v[232:233] neg_lo:[0,0,1] neg_hi:[0,0,1]
    v_pk_fma_f32 v[234:235], v[186:187], v[236:237], v[234:235]
    v_pk_fma_f32 v[244:245], v[202:203], v[240:241], v[244:245] neg_lo:[0,0,1] neg_hi:[0,0,1]
    v_pk_fma_f32 v[246:247], v[218:219], v[240:241], v[246:247]
    v_pk_add_f32 v[170:171], v[232:233], v[244:245]
    v_pk_add_f32 v[186:187], v[234:235], v[246:247]
    v_pk_add_f32 v[202:203], v[232:233], v[244:245] neg_lo:[0,1] neg_hi:[0,1]
    v_pk_add_f32 v[218:219], v[234:235], v[246:247] neg_lo:[0,1] neg_hi:[0,1]
    v_cvt_pk_bf16_f32 v105, v170, v171
    v_cvt_pk_bf16_f32 v113, v186, v187
    v_lshlrev_b32 v236, 16, v140
    v_and_b32 v237, 0xffff0000, v140
    v_lshlrev_b32 v238, 16, v142
    v_and_b32 v239, 0xffff0000, v142
    v_lshlrev_b32 v240, 16, v156
    v_and_b32 v241, 0xffff0000, v156
    v_lshlrev_b32 v242, 16, v158
    v_and_b32 v243, 0xffff0000, v158
    v_pk_mul_f32 v[232:233], v[220:221], v[92:93]
    v_pk_mul_f32 v[234:235], v[204:205], v[92:93]
    v_pk_fma_f32 v[232:233], v[204:205], v[76:77], v[232:233]
    v_pk_fma_f32 v[234:235], v[220:221], v[76:77], v[234:235] neg_lo:[0,0,1] neg_hi:[0,0,1]
    v_pk_add_f32 v[204:205], v[172:173], v[232:233] neg_lo:[0,1] neg_hi:[0,1]
    v_pk_add_f32 v[220:221], v[188:189], v[234:235] neg_lo:[0,1] neg_hi:[0,1]
    v_pk_add_f32 v[172:173], v[172:173], v[232:233]
    v_pk_add_f32 v[188:189], v[188:189], v[234:235]
    v_pk_mul_f32 v[232:233], v[188:189], v[238:239]
    v_pk_mul_f32 v[234:235], v[172:173], v[238:239]
    v_pk_mul_f32 v[244:245], v[220:221], v[242:243]
    v_pk_mul_f32 v[246:247], v[204:205], v[242:243]
    v_pk_fma_f32 v[232:233], v[172:173], v[236:237], v[232:233] neg_lo:[0,0,1] neg_hi:[0,0,1]
    v_pk_fma_f32 v[234:235], v[188:189], v[236:237], v[234:235]
    v_pk_fma_f32 v[244:245], v[204:205], v[240:241], v[244:245] neg_lo:[0,0,1] neg_hi:[0,0,1]
    v_pk_fma_f32 v[246:247], v[220:221], v[240:241], v[246:247]
    v_pk_add_f32 v[172:173], v[232:233], v[244:245]
    v_pk_add_f32 v[188:189], v[234:235], v[246:247]
    v_pk_add_f32 v[204:205], v[232:233], v[244:245] neg_lo:[0,1] neg_hi:[0,1]
    v_pk_add_f32 v[220:221], v[234:235], v[246:247] neg_lo:[0,1] neg_hi:[0,1]
    v_cvt_pk_bf16_f32 v106, v172, v173
    v_cvt_pk_bf16_f32 v114, v188, v189
    v_lshlrev_b32 v236, 16, v141
    v_and_b32 v237, 0xffff0000, v141
    v_lshlrev_b32 v238, 16, v143
    v_and_b32 v239, 0xffff0000, v143
    v_lshlrev_b32 v240, 16, v157
    v_and_b32 v241, 0xffff0000, v157
    v_lshlrev_b32 v242, 16, v159
    v_and_b32 v243, 0xffff0000, v159
    v_pk_mul_f32 v[232:233], v[222:223], v[94:95]
    v_pk_mul_f32 v[234:235], v[206:207], v[94:95]
    v_pk_fma_f32 v[232:233], v[206:207], v[78:79], v[232:233]
    v_pk_fma_f32 v[234:235], v[222:223], v[78:79], v[234:235] neg_lo:[0,0,1] neg_hi:[0,0,1]
    v_pk_add_f32 v[206:207], v[174:175], v[232:233] neg_lo:[0,1] neg_hi:[0,1]
    v_pk_add_f32 v[222:223], v[190:191], v[234:235] neg_lo:[0,1] neg_hi:[0,1]
    v_pk_add_f32 v[174:175], v[174:175], v[232:233]
    v_pk_add_f32 v[190:191], v[190:191], v[234:235]
    v_pk_mul_f32 v[232:233], v[190:191], v[238:239]
    v_pk_mul_f32 v[234:235], v[174:175], v[238:239]
    v_pk_mul_f32 v[244:245], v[222:223], v[242:243]
    v_pk_mul_f32 v[246:247], v[206:207], v[242:243]
    v_pk_fma_f32 v[232:233], v[174:175], v[236:237], v[232:233] neg_lo:[0,0,1] neg_hi:[0,0,1]
    v_pk_fma_f32 v[234:235], v[190:191], v[236:237], v[234:235]
    v_pk_fma_f32 v[244:245], v[206:207], v[240:241], v[244:245] neg_lo:[0,0,1] neg_hi:[0,0,1]
    v_pk_fma_f32 v[246:247], v[222:223], v[240:241], v[246:247]
    v_pk_add_f32 v[174:175], v[232:233], v[244:245]
    v_pk_add_f32 v[190:191], v[234:235], v[246:247]
    v_pk_add_f32 v[206:207], v[232:233], v[244:245] neg_lo:[0,1] neg_hi:[0,1]
    v_pk_add_f32 v[222:223], v[234:235], v[246:247] neg_lo:[0,1] neg_hi:[0,1]
    v_cvt_pk_bf16_f32 v107, v174, v175
    v_cvt_pk_bf16_f32 v115, v190, v191
    v_lshlrev_b32 v236, 16, v144
    v_and_b32 v237, 0xffff0000, v144
    v_lshlrev_b32 v238, 16, v146
    v_and_b32 v239, 0xffff0000, v146
    v_lshlrev_b32 v240, 16, v160
    v_and_b32 v241, 0xffff0000, v160
    v_lshlrev_b32 v242, 16, v162
    v_and_b32 v243, 0xffff0000, v162
    v_pk_mul_f32 v[232:233], v[224:225], v[96:97]
    v_pk_mul_f32 v[234:235], v[208:209], v[96:97]
    v_pk_fma_f32 v[232:233], v[208:209], v[80:81], v[232:233]
    v_pk_fma_f32 v[234:235], v[224:225], v[80:81], v[234:235] neg_lo:[0,0,1] neg_hi:[0,0,1]
    v_pk_add_f32 v[208:209], v[176:177], v[232:233] neg_lo:[0,1] neg_hi:[0,1]
    v_pk_add_f32 v[224:225], v[192:193], v[234:235] neg_lo:[0,1] neg_hi:[0,1]
    v_pk_add_f32 v[176:177], v[176:177], v[232:233]
    v_pk_add_f32 v[192:193], v[192:193], v[234:235]
    v_pk_mul_f32 v[232:233], v[192:193], v[238:239]
    v_pk_mul_f32 v[234:235], v[176:177], v[238:239]
    v_pk_mul_f32 v[244:245], v[224:225], v[242:243]
    v_pk_mul_f32 v[246:247], v[208:209], v[242:243]
    v_pk_fma_f32 v[232:233], v[176:177], v[236:237], v[232:233] neg_lo:[0,0,1] neg_hi:[0,0,1]
    v_pk_fma_f32 v[234:235], v[192:193], v[236:237], v[234:235]
    v_pk_fma_f32 v[244:245], v[208:209], v[240:241], v[244:245] neg_lo:[0,0,1] neg_hi:[0,0,1]
    v_pk_fma_f32 v[246:247], v[224:225], v[240:241], v[246:247]
    v_pk_add_f32 v[176:177], v[232:233], v[244:245]
    v_pk_add_f32 v[192:193], v[234:235], v[246:247]
    v_pk_add_f32 v[208:209], v[232:233], v[244:245] neg_lo:[0,1] neg_hi:[0,1]
    v_pk_add_f32 v[224:225], v[234:235], v[246:247] neg_lo:[0,1] neg_hi:[0,1]
    v_cvt_pk_bf16_f32 v108, v176, v177
    v_cvt_pk_bf16_f32 v116, v192, v193
    v_lshlrev_b32 v236, 16, v145
    v_and_b32 v237, 0xffff0000, v145
    v_lshlrev_b32 v238, 16, v147
    v_and_b32 v239, 0xffff0000, v147
    v_lshlrev_b32 v240, 16, v161
    v_and_b32 v241, 0xffff0000, v161
    v_lshlrev_b32 v242, 16, v163
    v_and_b32 v243, 0xffff0000, v163
    v_pk_mul_f32 v[232:233], v[226:227], v[98:99]
    v_pk_mul_f32 v[234:235], v[210:211], v[98:99]
    v_pk_fma_f32 v[232:233], v[210:211], v[82:83], v[232:233]
    v_pk_fma_f32 v[234:235], v[226:227], v[82:83], v[234:235] neg_lo:[0,0,1] neg_hi:[0,0,1]
    v_pk_add_f32 v[210:211], v[178:179], v[232:233] neg_lo:[0,1] neg_hi:[0,1]
    v_pk_add_f32 v[226:227], v[194:195], v[234:235] neg_lo:[0,1] neg_hi:[0,1]
    v_pk_add_f32 v[178:179], v[178:179], v[232:233]
    v_pk_add_f32 v[194:195], v[194:195], v[234:235]
    v_pk_mul_f32 v[232:233], v[194:195], v[238:239]
    v_pk_mul_f32 v[234:235], v[178:179], v[238:239]
    v_pk_mul_f32 v[244:245], v[226:227], v[242:243]
    v_pk_mul_f32 v[246:247], v[210:211], v[242:243]
    v_pk_fma_f32 v[232:233], v[178:179], v[236:237], v[232:233] neg_lo:[0,0,1] neg_hi:[0,0,1]
    v_pk_fma_f32 v[234:235], v[194:195], v[236:237], v[234:235]
    v_pk_fma_f32 v[244:245], v[210:211], v[240:241], v[244:245] neg_lo:[0,0,1] neg_hi:[0,0,1]
    v_pk_fma_f32 v[246:247], v[226:227], v[240:241], v[246:247]
    v_pk_add_f32 v[178:179], v[232:233], v[244:245]
    v_pk_add_f32 v[194:195], v[234:235], v[246:247]
    v_pk_add_f32 v[210:211], v[232:233], v[244:245] neg_lo:[0,1] neg_hi:[0,1]
    v_pk_add_f32 v[226:227], v[234:235], v[246:247] neg_lo:[0,1] neg_hi:[0,1]
    v_cvt_pk_bf16_f32 v109, v178, v179
    v_cvt_pk_bf16_f32 v117, v194, v195
    v_lshlrev_b32 v236, 16, v148
    v_and_b32 v237, 0xffff0000, v148
    v_lshlrev_b32 v238, 16, v150
    v_and_b32 v239, 0xffff0000, v150
    v_lshlrev_b32 v240, 16, v164
    v_and_b32 v241, 0xffff0000, v164
    v_lshlrev_b32 v242, 16, v166
    v_and_b32 v243, 0xffff0000, v166
    v_pk_mul_f32 v[232:233], v[228:229], v[100:101]
    v_pk_mul_f32 v[234:235], v[212:213], v[100:101]
    v_pk_fma_f32 v[232:233], v[212:213], v[84:85], v[232:233]
    v_pk_fma_f32 v[234:235], v[228:229], v[84:85], v[234:235] neg_lo:[0,0,1] neg_hi:[0,0,1]
    v_pk_add_f32 v[212:213], v[180:181], v[232:233] neg_lo:[0,1] neg_hi:[0,1]
    v_pk_add_f32 v[228:229], v[196:197], v[234:235] neg_lo:[0,1] neg_hi:[0,1]
    v_pk_add_f32 v[180:181], v[180:181], v[232:233]
    v_pk_add_f32 v[196:197], v[196:197], v[234:235]
    v_pk_mul_f32 v[232:233], v[196:197], v[238:239]
    v_pk_mul_f32 v[234:235], v[180:181], v[238:239]
    v_pk_mul_f32 v[244:245], v[228:229], v[242:243]
    v_pk_mul_f32 v[246:247], v[212:213], v[242:243]
    v_pk_fma_f32 v[232:233], v[180:181], v[236:237], v[232:233] neg_lo:[0,0,1] neg_hi:[0,0,1]
    v_pk_fma_f32 v[234:235], v[196:197], v[236:237], v[234:235]
    v_pk_fma_f32 v[244:245], v[212:213], v[240:241], v[244:245] neg_lo:[0,0,1] neg_hi:[0,0,1]
    v_pk_fma_f32 v[246:247], v[228:229], v[240:241], v[246:247]
    v_pk_add_f32 v[180:181], v[232:233], v[244:245]
    v_pk_add_f32 v[196:197], v[234:235], v[246:247]
    v_pk_add_f32 v[212:213], v[232:233], v[244:245] neg_lo:[0,1] neg_hi:[0,1]
    v_pk_add_f32 v[228:229], v[234:235], v[246:247] neg_lo:[0,1] neg_hi:[0,1]
    v_cvt_pk_bf16_f32 v110, v180, v181
    v_cvt_pk_bf16_f32 v118, v196, v197
    v_lshlrev_b32 v236, 16, v149
    v_and_b32 v237, 0xffff0000, v149
    v_lshlrev_b32 v238, 16, v151
    v_and_b32 v239, 0xffff0000, v151
    v_lshlrev_b32 v240, 16, v165
    v_and_b32 v241, 0xffff0000, v165
    v_lshlrev_b32 v242, 16, v167
    v_and_b32 v243, 0xffff0000, v167
    v_pk_mul_f32 v[232:233], v[230:231], v[102:103]
    v_pk_mul_f32 v[234:235], v[214:215], v[102:103]
    v_pk_fma_f32 v[232:233], v[214:215], v[86:87], v[232:233]
    v_pk_fma_f32 v[234:235], v[230:231], v[86:87], v[234:235] neg_lo:[0,0,1] neg_hi:[0,0,1]
    v_pk_add_f32 v[214:215], v[182:183], v[232:233] neg_lo:[0,1] neg_hi:[0,1]
    v_pk_add_f32 v[230:231], v[198:199], v[234:235] neg_lo:[0,1] neg_hi:[0,1]
    v_pk_add_f32 v[182:183], v[182:183], v[232:233]
    v_pk_add_f32 v[198:199], v[198:199], v[234:235]
    v_pk_mul_f32 v[232:233], v[198:199], v[238:239]
    v_pk_mul_f32 v[234:235], v[182:183], v[238:239]
    v_pk_mul_f32 v[244:245], v[230:231], v[242:243]
    v_pk_mul_f32 v[246:247], v[214:215], v[242:243]
    v_pk_fma_f32 v[232:233], v[182:183], v[236:237], v[232:233] neg_lo:[0,0,1] neg_hi:[0,0,1]
    v_pk_fma_f32 v[234:235], v[198:199], v[236:237], v[234:235]
    v_pk_fma_f32 v[244:245], v[214:215], v[240:241], v[244:245] neg_lo:[0,0,1] neg_hi:[0,0,1]
    v_pk_fma_f32 v[246:247], v[230:231], v[240:241], v[246:247]
    v_pk_add_f32 v[182:183], v[232:233], v[244:245]
    v_pk_add_f32 v[198:199], v[234:235], v[246:247]
    v_pk_add_f32 v[214:215], v[232:233], v[244:245] neg_lo:[0,1] neg_hi:[0,1]
    v_pk_add_f32 v[230:231], v[234:235], v[246:247] neg_lo:[0,1] neg_hi:[0,1]
    v_cvt_pk_bf16_f32 v111, v182, v183
    v_cvt_pk_bf16_f32 v119, v198, v199
    s_add_u32 s36, s36, 8
    s_cmp_lg_u32 s17, 0
    s_cbranch_scc1 L_f2_nx
    s_mov_b32 s44, 15052800
    buffer_load_dword v9, v4, s[28:31], s44 offen sc1
    s_branch L_f2_now
L_f2_nx:
    s_lshl_b32 s40, s2, 16
    s_add_u32 s40, s40, s37
    s_add_u32 m0, s37, 0
    s_add_u32 s41, s40, 0
    buffer_load_dwordx4 v12, s[24:27], s41 offen offset:0 lds
    buffer_load_dwordx4 v12, s[24:27], s41 offen offset:1024 lds
    buffer_load_dwordx4 v12, s[24:27], s41 offen offset:2048 lds
    buffer_load_dwordx4 v12, s[24:27], s41 offen offset:3072 lds
    s_add_u32 m0, s37, 4096
    s_add_u32 s41, s40, 4096
    buffer_load_dwordx4 v12, s[24:27], s41 offen offset:0 lds
    buffer_load_dwordx4 v12, s[24:27], s41 offen offset:1024 lds
    buffer_load_dwordx4 v12, s[24:27], s41 offen offset:2048 lds
    buffer_load_dwordx4 v12, s[24:27], s41 offen offset:3072 lds
    s_cmp_lt_u32 s2, 32
    s_cbranch_scc1 L_f2_now
    s_sub_u32 s37, s37, 0x8000
    s_lshl_b32 s40, s2, 16
    s_add_u32 s40, s40, s37
    s_add_u32 m0, s37, 0
    s_add_u32 s41, s40, 0
    buffer_load_dwordx4 v12, s[24:27], s41 offen offset:0 lds
    buffer_load_dwordx4 v12, s[24:27], s41 offen offset:1024 lds
    buffer_load_dwordx4 v12, s[24:27], s41 offen offset:2048 lds
    buffer_load_dwordx4 v12, s[24:27], s41 offen offset:3072 lds
    s_add_u32 m0, s37, 4096
    s_add_u32 s41, s40, 4096
    buffer_load_dwordx4 v12, s[24:27], s41 offen offset:0 lds
    buffer_load_dwordx4 v12, s[24:27], s41 offen offset:1024 lds
    buffer_load_dwordx4 v12, s[24:27], s41 offen offset:2048 lds
    buffer_load_dwordx4 v12, s[24:27], s41 offen offset:3072 lds
    s_add_u32 s37, s37, 0x8000
L_f2_now:
    v_mfma_f32_32x32x16_bf16 v[168:183], v[104:107], v[16:19], 0
    v_mul_f32 v232, v216, v88
    v_mul_f32 v233, v217, v89
    v_mul_f32 v234, v200, v88
    v_mul_f32 v235, v201, v89
    v_fma_f32 v232, v200, v72, -v232
    v_fma_f32 v233, v201, v73, -v233
    v_fmac_f32 v234, v216, v72
    v_mfma_f32_32x32x16_bf16 v[168:183], v[108:111], v[20:23], v[168:183]
    v_fmac_f32 v235, v217, v73
    v_cvt_pk_bf16_f32 v120, v232, v233
    v_cvt_pk_bf16_f32 v128, v234, v235
    v_mul_f32 v236, v218, v90
    v_mul_f32 v237, v219, v91
    v_mul_f32 v238, v202, v90
    v_mul_f32 v239, v203, v91
    v_mfma_f32_32x32x16_bf16 v[184:199], v[112:115], v[16:19], 0
    v_fma_f32 v236, v202, v74, -v236
    v_fma_f32 v237, v203, v75, -v237
    v_fmac_f32 v238, v218, v74
    v_fmac_f32 v239, v219, v75
    v_cvt_pk_bf16_f32 v121, v236, v237
    v_cvt_pk_bf16_f32 v129, v238, v239
    v_mfma_f32_32x32x16_bf16 v[184:199], v[116:119], v[20:23], v[184:199]
    v_mul_f32 v232, v220, v92
    v_mul_f32 v233, v221, v93
    v_mul_f32 v234, v204, v92
    v_mul_f32 v235, v205, v93
    v_fma_f32 v232, v204, v76, -v232
    v_fma_f32 v233, v205, v77, -v233
    v_mfma_f32_32x32x16_bf16 v[168:183], v[112:115], v[32:35], v[168:183]
    v_fmac_f32 v234, v220, v76
    v_fmac_f32 v235, v221, v77
    v_cvt_pk_bf16_f32 v122, v232, v233
    v_cvt_pk_bf16_f32 v130, v234, v235
    v_mul_f32 v236, v222, v94
    v_mul_f32 v237, v223, v95
    v_mfma_f32_32x32x16_bf16 v[168:183], v[116:119], v[36:39], v[168:183]
    v_mul_f32 v238, v206, v94
    v_mul_f32 v239, v207, v95
    v_fma_f32 v236, v206, v78, -v236
    v_fma_f32 v237, v207, v79, -v237
    v_fmac_f32 v238, v222, v78
    v_fmac_f32 v239, v223, v79
    v_mfma_f32_32x32x16_bf16 v[184:199], v[104:107], v[24:27], v[184:199]
    v_cvt_pk_bf16_f32 v123, v236, v237
    v_cvt_pk_bf16_f32 v131, v238, v239
    v_mul_f32 v232, v224, v96
    v_mul_f32 v233, v225, v97
    v_mul_f32 v234, v208, v96
    v_mul_f32 v235, v209, v97
    v_mfma_f32_32x32x16_bf16 v[184:199], v[108:111], v[28:31], v[184:199]
    v_fma_f32 v232, v208, v80, -v232
    v_fma_f32 v233, v209, v81, -v233
    v_fmac_f32 v234, v224, v80
    v_fmac_f32 v235, v225, v81
    v_cvt_pk_bf16_f32 v124, v232, v233
    v_cvt_pk_bf16_f32 v132, v234, v235
    v_pk_mul_f32 v[236:237], v[226:227], v[98:99]
    v_pk_mul_f32 v[238:239], v[210:211], v[98:99]
    v_pk_fma_f32 v[236:237], v[210:211], v[82:83], v[236:237] neg_lo:[0,0,1] neg_hi:[0,0,1]
    v_pk_fma_f32 v[238:239], v[226:227], v[82:83], v[238:239]
    v_cvt_pk_bf16_f32 v125, v236, v237
    v_cvt_pk_bf16_f32 v133, v238, v239
    v_pk_mul_f32 v[232:233], v[228:229], v[100:101]
    v_pk_mul_f32 v[234:235], v[212:213], v[100:101]
    v_pk_fma_f32 v[232:233], v[212:213], v[84:85], v[232:233] neg_lo:[0,0,1] neg_hi:[0,0,1]
    v_pk_fma_f32 v[234:235], v[228:229], v[84:85], v[234:235]
    v_cvt_pk_bf16_f32 v126, v232, v233
    v_cvt_pk_bf16_f32 v134, v234, v235
    v_pk_mul_f32 v[236:237], v[230:231], v[102:103]
    v_pk_mul_f32 v[238:239], v[214:215], v[102:103]
    v_pk_fma_f32 v[236:237], v[214:215], v[86:87], v[236:237] neg_lo:[0,0,1] neg_hi:[0,0,1]
    v_pk_fma_f32 v[238:239], v[230:231], v[86:87], v[238:239]
    v_cvt_pk_bf16_f32 v127, v236, v237
    v_cvt_pk_bf16_f32 v135, v238, v239
    v_mfma_f32_32x32x16_bf16 v[200:215], v[120:123], v[16:19], 0
    v_mul_f32 v232, v184, v56
    v_mul_f32 v233, v185, v57
    v_mul_f32 v234, v168, v56
    v_mul_f32 v235, v169, v57
    v_fma_f32 v232, v168, v40, -v232
    v_fma_f32 v233, v169, v41, -v233
    v_fmac_f32 v234, v184, v40
    v_mfma_f32_32x32x16_bf16 v[200:215], v[124:127], v[20:23], v[200:215]
    v_fmac_f32 v235, v185, v41
    v_cvt_pk_bf16_f32 v104, v232, v233
    v_cvt_pk_bf16_f32 v112, v234, v235
    v_mul_f32 v236, v186, v58
    v_mul_f32 v237, v187, v59
    v_mul_f32 v238, v170, v58
    v_mul_f32 v239, v171, v59
    v_mfma_f32_32x32x16_bf16 v[216:231], v[128:131], v[16:19], 0
    v_fma_f32 v236, v170, v42, -v236
    v_fma_f32 v237, v171, v43, -v237
    v_fmac_f32 v238, v186, v42
    v_fmac_f32 v239, v187, v43
    v_cvt_pk_bf16_f32 v105, v236, v237
    v_cvt_pk_bf16_f32 v113, v238, v239
    v_mfma_f32_32x32x16_bf16 v[216:231], v[132:135], v[20:23], v[216:231]
    v_mul_f32 v232, v188, v60
    v_mul_f32 v233, v189, v61
    v_mul_f32 v234, v172, v60
    v_mul_f32 v235, v173, v61
    v_fma_f32 v232, v172, v44, -v232
    v_fma_f32 v233, v173, v45, -v233
    v_mfma_f32_32x32x16_bf16 v[200:215], v[128:131], v[32:35], v[200:215]
    v_fmac_f32 v234, v188, v44
    v_fmac_f32 v235, v189, v45
    v_cvt_pk_bf16_f32 v106, v232, v233
    v_cvt_pk_bf16_f32 v114, v234, v235
    v_mul_f32 v236, v190, v62
    v_mul_f32 v237, v191, v63
    v_mfma_f32_32x32x16_bf16 v[200:215], v[132:135], v[36:39], v[200:215]
    v_mul_f32 v238, v174, v62
    v_mul_f32 v239, v175, v63
    v_fma_f32 v236, v174, v46, -v236
    v_fma_f32 v237, v175, v47, -v237
    v_fmac_f32 v238, v190, v46
    v_fmac_f32 v239, v191, v47
    v_mfma_f32_32x32x16_bf16 v[216:231], v[120:123], v[24:27], v[216:231]
    v_cvt_pk_bf16_f32 v107, v236, v237
    v_cvt_pk_bf16_f32 v115, v238, v239
    v_mul_f32 v232, v192, v64
    v_mul_f32 v233, v193, v65
    v_mul_f32 v234, v176, v64
    v_mul_f32 v235, v177, v65
    v_mfma_f32_32x32x16_bf16 v[216:231], v[124:127], v[28:31], v[216:231]
    v_fma_f32 v232, v176, v48, -v232
    v_fma_f32 v233, v177, v49, -v233
    v_fmac_f32 v234, v192, v48
    v_fmac_f32 v235, v193, v49
    v_cvt_pk_bf16_f32 v108, v232, v233
    v_cvt_pk_bf16_f32 v116, v234, v235
    v_pk_mul_f32 v[236:237], v[194:195], v[66:67]
    v_pk_mul_f32 v[238:239], v[178:179], v[66:67]
    v_pk_fma_f32 v[236:237], v[178:179], v[50:51], v[236:237] neg_lo:[0,0,1] neg_hi:[0,0,1]
    v_pk_fma_f32 v[238:239], v[194:195], v[50:51], v[238:239]
    v_cvt_pk_bf16_f32 v109, v236, v237
    v_cvt_pk_bf16_f32 v117, v238, v239
    v_pk_mul_f32 v[232:233], v[196:197], v[68:69]
    v_pk_mul_f32 v[234:235], v[180:181], v[68:69]
    v_pk_fma_f32 v[232:233], v[180:181], v[52:53], v[232:233] neg_lo:[0,0,1] neg_hi:[0,0,1]
    v_pk_fma_f32 v[234:235], v[196:197], v[52:53], v[234:235]
    v_cvt_pk_bf16_f32 v110, v232, v233
    v_cvt_pk_bf16_f32 v118, v234, v235
    v_pk_mul_f32 v[236:237], v[198:199], v[70:71]
    v_pk_mul_f32 v[238:239], v[182:183], v[70:71]
    v_pk_fma_f32 v[236:237], v[182:183], v[54:55], v[236:237] neg_lo:[0,0,1] neg_hi:[0,0,1]
    v_pk_fma_f32 v[238:239], v[198:199], v[54:55], v[238:239]
    v_cvt_pk_bf16_f32 v111, v236, v237
    v_cvt_pk_bf16_f32 v119, v238, v239
    v_mfma_f32_32x32x16_bf16 v[168:183], v[16:19], v[104:107], 0
    v_mul_f32 v232, v216, v56
    v_mul_f32 v233, v217, v57
    v_mul_f32 v234, v200, v56
    v_mul_f32 v235, v201, v57
    v_fma_f32 v232, v200, v40, -v232
    v_fma_f32 v233, v201, v41, -v233
    v_fmac_f32 v234, v216, v40
    v_mfma_f32_32x32x16_bf16 v[168:183], v[20:23], v[108:111], v[168:183]
    v_fmac_f32 v235, v217, v41
    v_cvt_pk_bf16_f32 v120, v232, v233
    v_cvt_pk_bf16_f32 v128, v234, v235
    v_mul_f32 v236, v218, v58
    v_mul_f32 v237, v219, v59
    v_mul_f32 v238, v202, v58
    v_mul_f32 v239, v203, v59
    v_mfma_f32_32x32x16_bf16 v[184:199], v[16:19], v[112:115], 0
    v_fma_f32 v236, v202, v42, -v236
    v_fma_f32 v237, v203, v43, -v237
    v_fmac_f32 v238, v218, v42
    v_fmac_f32 v239, v219, v43
    v_cvt_pk_bf16_f32 v121, v236, v237
    v_cvt_pk_bf16_f32 v129, v238, v239
    v_mfma_f32_32x32x16_bf16 v[184:199], v[20:23], v[116:119], v[184:199]
    v_mul_f32 v232, v220, v60
    v_mul_f32 v233, v221, v61
    v_mul_f32 v234, v204, v60
    v_mul_f32 v235, v205, v61
    v_fma_f32 v232, v204, v44, -v232
    v_fma_f32 v233, v205, v45, -v233
    v_mfma_f32_32x32x16_bf16 v[168:183], v[32:35], v[112:115], v[168:183]
    v_fmac_f32 v234, v220, v44
    v_fmac_f32 v235, v221, v45
    v_cvt_pk_bf16_f32 v122, v232, v233
    v_cvt_pk_bf16_f32 v130, v234, v235
    v_mul_f32 v236, v222, v62
    v_mul_f32 v237, v223, v63
    v_mfma_f32_32x32x16_bf16 v[168:183], v[36:39], v[116:119], v[168:183]
    v_mul_f32 v238, v206, v62
    v_mul_f32 v239, v207, v63
    v_fma_f32 v236, v206, v46, -v236
    v_fma_f32 v237, v207, v47, -v237
    v_fmac_f32 v238, v222, v46
    v_fmac_f32 v239, v223, v47
    v_mfma_f32_32x32x16_bf16 v[184:199], v[24:27], v[104:107], v[184:199]
    v_cvt_pk_bf16_f32 v123, v236, v237
    v_cvt_pk_bf16_f32 v131, v238, v239
    v_mul_f32 v232, v224, v64
    v_mul_f32 v233, v225, v65
    v_mul_f32 v234, v208, v64
    v_mul_f32 v235, v209, v65
    v_mfma_f32_32x32x16_bf16 v[184:199], v[28:31], v[108:111], v[184:199]
    v_fma_f32 v232, v208, v48, -v232
    v_fma_f32 v233, v209, v49, -v233
    v_fmac_f32 v234, v224, v48
    v_fmac_f32 v235, v225, v49
    v_cvt_pk_bf16_f32 v124, v232, v233
    v_cvt_pk_bf16_f32 v132, v234, v235
    v_pk_mul_f32 v[236:237], v[226:227], v[66:67]
    v_pk_mul_f32 v[238:239], v[210:211], v[66:67]
    v_pk_fma_f32 v[236:237], v[210:211], v[50:51], v[236:237] neg_lo:[0,0,1] neg_hi:[0,0,1]
    v_pk_fma_f32 v[238:239], v[226:227], v[50:51], v[238:239]
    v_cvt_pk_bf16_f32 v125, v236, v237
    v_cvt_pk_bf16_f32 v133, v238, v239
    v_pk_mul_f32 v[232:233], v[228:229], v[68:69]
    v_pk_mul_f32 v[234:235], v[212:213], v[68:69]
    v_pk_fma_f32 v[232:233], v[212:213], v[52:53], v[232:233] neg_lo:[0,0,1] neg_hi:[0,0,1]
    v_pk_fma_f32 v[234:235], v[228:229], v[52:53], v[234:235]
    v_cvt_pk_bf16_f32 v126, v232, v233
    v_cvt_pk_bf16_f32 v134, v234, v235
    v_pk_mul_f32 v[236:237], v[230:231], v[70:71]
    v_pk_mul_f32 v[238:239], v[214:215], v[70:71]
    v_pk_fma_f32 v[236:237], v[214:215], v[54:55], v[236:237] neg_lo:[0,0,1] neg_hi:[0,0,1]
    v_pk_fma_f32 v[238:239], v[230:231], v[54:55], v[238:239]
    v_cvt_pk_bf16_f32 v127, v236, v237
    v_cvt_pk_bf16_f32 v135, v238, v239
    v_mfma_f32_32x32x16_bf16 v[200:215], v[16:19], v[120:123], 0
    v_cvt_pk_bf16_f32 v168, v168, v184
    v_cvt_pk_bf16_f32 v169, v169, v185
    v_cvt_pk_bf16_f32 v170, v170, v186
    v_mfma_f32_32x32x16_bf16 v[200:215], v[20:23], v[124:127], v[200:215]
    v_cvt_pk_bf16_f32 v171, v171, v187
    ds_write_b128 v7, v[168:171] offset:0
    v_cvt_pk_bf16_f32 v172, v172, v188
    v_mfma_f32_32x32x16_bf16 v[216:231], v[16:19], v[128:131], 0
    v_cvt_pk_bf16_f32 v173, v173, v189
    v_cvt_pk_bf16_f32 v174, v174, v190
    v_cvt_pk_bf16_f32 v175, v175, v191
    v_mfma_f32_32x32x16_bf16 v[216:231], v[20:23], v[132:135], v[216:231]
    ds_write_b128 v7, v[172:175] offset:1024
    v_cvt_pk_bf16_f32 v176, v176, v192
    v_cvt_pk_bf16_f32 v177, v177, v193
    v_mfma_f32_32x32x16_bf16 v[200:215], v[32:35], v[128:131], v[200:215]
    v_cvt_pk_bf16_f32 v178, v178, v194
    v_cvt_pk_bf16_f32 v179, v179, v195
    v_mfma_f32_32x32x16_bf16 v[200:215], v[36:39], v[132:135], v[200:215]
    ds_write_b128 v7, v[176:179] offset:2048
    v_cvt_pk_bf16_f32 v180, v180, v196
    v_mfma_f32_32x32x16_bf16 v[216:231], v[24:27], v[120:123], v[216:231]
    v_cvt_pk_bf16_f32 v181, v181, v197
    v_cvt_pk_bf16_f32 v182, v182, v198
    v_mfma_f32_32x32x16_bf16 v[216:231], v[28:31], v[124:127], v[216:231]
    v_cvt_pk_bf16_f32 v183, v183, v199
    ds_write_b128 v7, v[180:183] offset:3072
    s_nop 9
    v_cvt_pk_bf16_f32 v200, v200, v216
    v_cvt_pk_bf16_f32 v201, v201, v217
    v_cvt_pk_bf16_f32 v202, v202, v218
    v_cvt_pk_bf16_f32 v203, v203, v219
    ds_write_b128 v15, v[200:203] offset:4096
    v_cvt_pk_bf16_f32 v204, v204, v220
    v_cvt_pk_bf16_f32 v205, v205, v221
    v_cvt_pk_bf16_f32 v206, v206, v222
    v_cvt_pk_bf16_f32 v207, v207, v223
    ds_write_b128 v15, v[204:207] offset:5120
    v_cvt_pk_bf16_f32 v208, v208, v224
    v_cvt_pk_bf16_f32 v209, v209, v225
    v_cvt_pk_bf16_f32 v210, v210, v226
    v_cvt_pk_bf16_f32 v211, v211, v227
    ds_write_b128 v15, v[208:211] offset:6144
    v_cvt_pk_bf16_f32 v212, v212, v228
    v_cvt_pk_bf16_f32 v213, v213, v229
    v_cvt_pk_bf16_f32 v214, v214, v230
    v_cvt_pk_bf16_f32 v215, v215, v231
    ds_write_b128 v15, v[212:215] offset:7168
    s_cmp_lg_u32 s17, 0
    s_cbranch_scc1 L_f2_end
    s_mov_b32 s83, 0x20000
    s_waitcnt vmcnt(0)
    s_branch L_f2_w2p_w
L_f2_w2p:
    buffer_load_dword v9, v4, s[28:31], s44 offen sc1
    s_waitcnt vmcnt(0)
L_f2_w2p_w:
    v_cmp_ne_u32 vcc, s74, v9
    s_nop 0
    s_mov_b64 s[80:81], vcc
    s_cmp_eq_u64 s[80:81], 0
    s_cbranch_scc1 L_f2_w2p_ok
    s_sleep 8
    s_sub_u32 s83, s83, 1
    s_cmp_lg_u32 s83, 0
    s_cbranch_scc1 L_f2_w2p
L_f2_w2p_ok:
    s_cmp_ge_u32 s16, 4
    s_cbranch_scc1 L_f2_nw2
    s_lshl_b32 s39, s36, 13
    s_add_u32 s39, s39, 20971520
    s_add_u32 s40, s39, 4096
    buffer_load_dwordx4 v[136:139], v12, s[28:31], s39 offen offset:0 sc1
    buffer_load_dwordx4 v[140:143], v12, s[28:31], s39 offen offset:1024 sc1
    buffer_load_dwordx4 v[144:147], v12, s[28:31], s39 offen offset:2048 sc1
    buffer_load_dwordx4 v[148:151], v12, s[28:31], s39 offen offset:3072 sc1
    buffer_load_dwordx4 v[152:155], v12, s[28:31], s40 offen offset:0 sc1
    buffer_load_dwordx4 v[156:159], v12, s[28:31], s40 offen offset:1024 sc1
    buffer_load_dwordx4 v[160:163], v12, s[28:31], s40 offen offset:2048 sc1
    buffer_load_dwordx4 v[164:167], v12, s[28:31], s40 offen offset:3072 sc1
L_f2_nw2:
    s_waitcnt lgkmcnt(0)
    s_barrier
    ds_read2st64_b32 v[168:169], v10 offset0:0 offset1:32
    ds_read2st64_b32 v[170:171], v10 offset0:64 offset1:96
    ds_read2st64_b32 v[172:173], v10 offset0:4 offset1:36
    ds_read2st64_b32 v[174:175], v10 offset0:68 offset1:100
    ds_read2st64_b32 v[176:177], v10 offset0:8 offset1:40
    ds_read2st64_b32 v[178:179], v10 offset0:72 offset1:104
    ds_read2st64_b32 v[180:181], v10 offset0:12 offset1:44
    ds_read2st64_b32 v[182:183], v10 offset0:76 offset1:108
    ds_read2st64_b32 v[184:185], v8 offset0:0 offset1:32
    ds_read2st64_b32 v[186:187], v8 offset0:64 offset1:96
    ds_read2st64_b32 v[188:189], v8 offset0:4 offset1:36
    ds_read2st64_b32 v[190:191], v8 offset0:68 offset1:100
    ds_read2st64_b32 v[192:193], v8 offset0:8 offset1:40
    ds_read2st64_b32 v[194:195], v8 offset0:72 offset1:104
    ds_read2st64_b32 v[196:197], v8 offset0:12 offset1:44
    ds_read2st64_b32 v[198:199], v8 offset0:76 offset1:108
    s_waitcnt lgkmcnt(14)
    s_add_u32 s44, s45, 0
    buffer_store_dwordx4 v[168:171], v11, s[28:31], s44 offen sc1
    s_waitcnt lgkmcnt(12)
    s_add_u32 s44, s45, 1048576
    buffer_store_dwordx4 v[172:175], v11, s[28:31], s44 offen sc1
    s_waitcnt lgkmcnt(10)
    s_add_u32 s44, s45, 2097152
    buffer_store_dwordx4 v[176:179], v11, s[28:31], s44 offen sc1
    s_waitcnt lgkmcnt(8)
    s_add_u32 s44, s45, 3145728
    buffer_store_dwordx4 v[180:183], v11, s[28:31], s44 offen sc1
    s_waitcnt lgkmcnt(6)
    s_add_u32 s44, s45, 4096
    buffer_store_dwordx4 v[184:187], v11, s[28:31], s44 offen sc1
    s_waitcnt lgkmcnt(4)
    s_add_u32 s44, s45, 1052672
    buffer_store_dwordx4 v[188:191], v11, s[28:31], s44 offen sc1
    s_waitcnt lgkmcnt(2)
    s_add_u32 s44, s45, 2101248
    buffer_store_dwordx4 v[192:195], v11, s[28:31], s44 offen sc1
    s_waitcnt lgkmcnt(0)
    s_add_u32 s44, s45, 3149824
    buffer_store_dwordx4 v[196:199], v11, s[28:31], s44 offen sc1
    s_add_u32 s45, s45, 8192
    s_mov_b32 s17, 1
    s_cmp_lt_u32 s16, 4
    s_cbranch_scc1 L_f2_round
L_f2_idle:
    s_barrier
    s_lshl_b32 s40, s2, 16
    s_add_u32 s40, s40, s37
    s_add_u32 m0, s37, 0
    s_add_u32 s41, s40, 0
    buffer_load_dwordx4 v12, s[24:27], s41 offen offset:0 lds
    buffer_load_dwordx4 v12, s[24:27], s41 offen offset:1024 lds
    buffer_load_dwordx4 v12, s[24:27], s41 offen offset:2048 lds
    buffer_load_dwordx4 v12, s[24:27], s41 offen offset:3072 lds
    s_add_u32 m0, s37, 4096
    s_add_u32 s41, s40, 4096
    buffer_load_dwordx4 v12, s[24:27], s41 offen offset:0 lds
    buffer_load_dwordx4 v12, s[24:27], s41 offen offset:1024 lds
    buffer_load_dwordx4 v12, s[24:27], s41 offen offset:2048 lds
    buffer_load_dwordx4 v12, s[24:27], s41 offen offset:3072 lds
L_f2_end:
    s_cmp_ge_u32 s2, 32
    s_cbranch_scc1 L_fs_el
    s_waitcnt lgkmcnt(0)
    s_barrier
    s_branch L_fs_ex
L_fs_el:
    v_lshlrev_b32 v248, 2, v1
    v_add_u32 v248, 163776, v248
    v_mov_b32 v249, 5
    s_waitcnt lgkmcnt(0)
    ds_write_b32 v248, v249
    v_and_b32 v250, 3, v2
    v_and_b32 v251, 4, v1
    v_or_b32 v250, v250, v251
    v_lshlrev_b32 v250, 2, v250
    v_add_u32 v250, 163776, v250
    s_mov_b32 s83, 0x400000
L_fs_e:
    ds_read_b32 v251, v250
    s_sub_u32 s83, s83, 1
    s_cmp_eq_u32 s83, 0
    s_cbranch_scc1 L_fs_ex
    s_waitcnt lgkmcnt(0)
    v_cmp_gt_u32 vcc, 5, v251
    s_nop 4
    s_cbranch_vccnz L_fs_e
L_fs_ex:
    ds_read2st64_b32 v[168:169], v10 offset0:0 offset1:32
    ds_read2st64_b32 v[170:171], v10 offset0:64 offset1:96
    ds_read2st64_b32 v[172:173], v10 offset0:4 offset1:36
    ds_read2st64_b32 v[174:175], v10 offset0:68 offset1:100
    ds_read2st64_b32 v[176:177], v10 offset0:8 offset1:40
    ds_read2st64_b32 v[178:179], v10 offset0:72 offset1:104
    ds_read2st64_b32 v[180:181], v10 offset0:12 offset1:44
    ds_read2st64_b32 v[182:183], v10 offset0:76 offset1:108
    s_waitcnt lgkmcnt(6)
    s_add_u32 s44, s45, 0
    buffer_store_dwordx4 v[168:171], v11, s[28:31], s44 offen sc1
    s_waitcnt lgkmcnt(4)
    s_add_u32 s44, s45, 1048576
    buffer_store_dwordx4 v[172:175], v11, s[28:31], s44 offen sc1
    s_waitcnt lgkmcnt(2)
    s_add_u32 s44, s45, 2097152
    buffer_store_dwordx4 v[176:179], v11, s[28:31], s44 offen sc1
    s_waitcnt lgkmcnt(0)
    s_add_u32 s44, s45, 3145728
    buffer_store_dwordx4 v[180:183], v11, s[28:31], s44 offen sc1
    s_cmp_lt_u32 s2, 32
    s_cbranch_scc1 L_f2_done
    v_subrev_u32 v10, 512, v10
    v_subrev_u32 v11, 0x80000, v11
    ds_read2st64_b32 v[184:185], v10 offset0:0 offset1:32
    ds_read2st64_b32 v[186:187], v10 offset0:64 offset1:96
    ds_read2st64_b32 v[188:189], v10 offset0:4 offset1:36
    ds_read2st64_b32 v[190:191], v10 offset0:68 offset1:100
    ds_read2st64_b32 v[192:193], v10 offset0:8 offset1:40
    ds_read2st64_b32 v[194:195], v10 offset0:72 offset1:104
    ds_read2st64_b32 v[196:197], v10 offset0:12 offset1:44
    ds_read2st64_b32 v[198:199], v10 offset0:76 offset1:108
    s_waitcnt lgkmcnt(6)
    s_add_u32 s44, s45, 0
    buffer_store_dwordx4 v[184:187], v11, s[28:31], s44 offen sc1
    s_waitcnt lgkmcnt(4)
    s_add_u32 s44, s45, 1048576
    buffer_store_dwordx4 v[188:191], v11, s[28:31], s44 offen sc1
    s_waitcnt lgkmcnt(2)
    s_add_u32 s44, s45, 2097152
    buffer_store_dwordx4 v[192:195], v11, s[28:31], s44 offen sc1
    s_waitcnt lgkmcnt(0)
    s_add_u32 s44, s45, 3145728
    buffer_store_dwordx4 v[196:199], v11, s[28:31], s44 offen sc1
L_f2_done:
    s_branch L_f3_t
L_phaseB:
L_g2_dma:
    s_cmp_lg_u32 s13, 4
    s_cbranch_scc1 L_g2_dm2
    s_waitcnt vmcnt(27)
    s_barrier
    s_waitcnt vmcnt(3)
    s_barrier
    s_branch L_f3_x
L_g2_dm2:
    s_lshl_b32 s12, s14, 2
    s_add_u32 s12, s12, s13
    v_lshrrev_b32 v5, 5, v2
    s_lshl_b32 s36, s18, 1
    v_add_u32 v5, s36, v5
    v_bfe_u32 v7, v2, 1, 4
    v_xor_b32 v7, v7, v5
    v_lshlrev_b32 v7, 5, v7
    v_and_b32 v8, 1, v2
    v_lshl_add_u32 v7, v8, 4, v7
    v_mul_u32_u24 v5, 2048, v5
    v_add_u32 v3, v5, v7
    v_xor_b32 v7, 128, v7
    v_add_u32 v9, v5, v7
    s_lshl_b32 s40, s18, 10
    s_add_u32 s41, s40, 32768
    v_lshlrev_b32 v4, 4, v2
    s_mov_b32 s20, s68
    s_mov_b32 s21, s69
    s_mov_b32 s22, 7340032
    s_mov_b32 s23, 0x20000
    s_mov_b32 s24, s10
    s_mov_b32 s25, s11
    s_mov_b32 s26, 14680064
    s_mov_b32 s27, 0x20000
    s_mul_i32 s58, s17, 20
    s_add_u32 s61, s58, 16
    s_sub_u32 s60, s58, 4
    s_mov_b32 s62, 0
    s_lshl_b32 s63, s13, 9
    s_lshl_b32 s64, s14, 14
    s_add_u32 s64, s64, s40
    s_lshl_b32 s65, s15, 2
    s_mul_i32 s66, s17, 0x101
    s_add_u32 s66, s66, 655565840
    s_lshl_b32 s42, s15, 19
    s_add_u32 s42, s42, s63
    s_mul_i32 s39, s14, 14
    s_lshl_b32 s39, s39, 9
    s_add_u32 s36, s39, 15335424
    s_add_u32 s38, s36, 131072
    s_mul_i32 s37, s17, 2560
    v_and_b32 v10, 15, v2
    v_lshlrev_b32 v10, 7, v10
    v_add_u32 v10, s37, v10
    v_and_b32 v11, 3, v2
    v_lshlrev_b32 v11, 7, v11
    v_bfe_u32 v13, v2, 2, 1
    v_mul_u32_u24 v13, 2560, v13
    v_add_u32 v11, v11, v13
    v_add_u32 v11, 2048, v11
    s_add_u32 s40, s40, 49152
    s_mov_b32 s47, 0
    s_waitcnt vmcnt(27)
L_g2_pa:
    s_barrier
    s_add_u32 m0, s40, 0
    s_add_u32 s46, s42, 0
    buffer_load_dwordx4 v3, s[20:23], s46 offen lds
    s_add_u32 m0, s40, 2048
    s_add_u32 s46, s42, 8192
    buffer_load_dwordx4 v9, s[20:23], s46 offen lds
    s_add_u32 m0, s40, 4096
    s_add_u32 s46, s42, 16384
    buffer_load_dwordx4 v3, s[20:23], s46 offen lds
    s_add_u32 m0, s40, 6144
    s_add_u32 s46, s42, 24576
    buffer_load_dwordx4 v9, s[20:23], s46 offen lds
    s_add_u32 m0, s40, 8192
    s_add_u32 s46, s42, 32768
    buffer_load_dwordx4 v3, s[20:23], s46 offen lds
    s_add_u32 m0, s40, 10240
    s_add_u32 s46, s42, 40960
    buffer_load_dwordx4 v9, s[20:23], s46 offen lds
    s_add_u32 m0, s40, 12288
    s_add_u32 s46, s42, 49152
    buffer_load_dwordx4 v3, s[20:23], s46 offen lds
    s_add_u32 m0, s40, 14336
    s_add_u32 s46, s42, 57344
    buffer_load_dwordx4 v9, s[20:23], s46 offen lds
    s_add_u32 m0, s40, 16384
    s_add_u32 s46, s42, 262144
    buffer_load_dwordx4 v3, s[20:23], s46 offen lds
    s_add_u32 m0, s40, 18432
    s_add_u32 s46, s42, 270336
    buffer_load_dwordx4 v9, s[20:23], s46 offen lds
    s_add_u32 m0, s40, 20480
    s_add_u32 s46, s42, 278528
    buffer_load_dwordx4 v3, s[20:23], s46 offen lds
    s_add_u32 m0, s40, 22528
    s_add_u32 s46, s42, 286720
    buffer_load_dwordx4 v9, s[20:23], s46 offen lds
    s_add_u32 m0, s40, 24576
    s_add_u32 s46, s42, 294912
    buffer_load_dwordx4 v3, s[20:23], s46 offen lds
    s_add_u32 m0, s40, 26624
    s_add_u32 s46, s42, 303104
    buffer_load_dwordx4 v9, s[20:23], s46 offen lds
    s_add_u32 m0, s40, 28672
    s_add_u32 s46, s42, 311296
    buffer_load_dwordx4 v3, s[20:23], s46 offen lds
    s_add_u32 m0, s40, 30720
    s_add_u32 s46, s42, 319488
    buffer_load_dwordx4 v9, s[20:23], s46 offen lds
    s_add_u32 s42, s42, 65536
    s_add_u32 s47, s47, 1
    s_cmp_eq_u32 s47, 2
    s_cselect_b32 s45, s50, s51
    s_add_u32 s40, s40, s45
    s_waitcnt vmcnt(19)
    s_cmp_lt_u32 s47, 3
    s_cbranch_scc1 L_g2_pa
L_adv_3:
    s_add_u32 s60, s60, 4
    s_add_u32 s45, s62, 1
    s_add_u32 s44, s45, s58
    s_cmp_ge_u32 s60, s61
    s_cselect_b32 s60, s44, s60
    s_cselect_b32 s62, s45, s62
    s_sub_u32 s44, s60, s65
    s_cmp_lt_u32 s44, 3
    s_cbranch_scc1 L_adv_3
    s_and_b32 s44, s66, 0xff
    s_lshr_b32 s45, s66, 8
    s_cmp_ge_u32 s62, 4
    s_cselect_b32 s44, s44, s60
    s_cselect_b32 s66, s45, s66
    s_lshr_b32 s42, s44, 2
    s_lshl_b32 s42, s42, 19
    s_and_b32 s45, s44, 3
    s_lshl_b32 s45, s45, 16
    s_add_u32 s42, s42, s45
    s_add_u32 s42, s42, s63
    s_lshl_b32 s43, s44, 18
    s_add_u32 s43, s43, s64
    s_add_u32 s41, s41, 49152
    s_mov_b32 s48, 1
    s_waitcnt vmcnt(0)
    s_barrier
    buffer_load_dword v6, v10, s[28:31], s36 offen sc1
    s_barrier
    s_barrier
    s_mov_b32 s83, 0x20000
    s_waitcnt vmcnt(0)
    s_branch L_g2_hw_w
L_g2_hw:
    buffer_load_dword v6, v10, s[28:31], s36 offen sc1
    s_waitcnt vmcnt(0)
L_g2_hw_w:
    v_cmp_ne_u32 vcc, s74, v6
    s_nop 0
    s_mov_b64 s[80:81], vcc
    s_cmp_eq_u64 s[80:81], 0
    s_cbranch_scc1 L_g2_hw_ok
    s_sleep 4
    s_sub_u32 s83, s83, 1
    s_cmp_lg_u32 s83, 0
    s_cbranch_scc1 L_g2_hw
L_g2_hw_ok:
    s_mov_b32 s67, 5
    s_mov_b32 s47, 3
.p2alignl 6, 0xbf800000
L_g2_ld:
    s_add_u32 m0, s41, 0
    s_add_u32 s46, s43, 0
    buffer_load_dwordx4 v4, s[24:27], s46 offen sc1 lds
    s_add_u32 m0, s41, 2048
    s_add_u32 s46, s43, 2048
    buffer_load_dwordx4 v4, s[24:27], s46 offen sc1 lds
    s_add_u32 m0, s41, 4096
    s_add_u32 s46, s43, 4096
    buffer_load_dwordx4 v4, s[24:27], s46 offen sc1 lds
    s_add_u32 m0, s41, 6144
    s_add_u32 s46, s43, 6144
    buffer_load_dwordx4 v4, s[24:27], s46 offen sc1 lds
    s_add_u32 m0, s41, 8192
    s_add_u32 s46, s43, 8192
    buffer_load_dwordx4 v4, s[24:27], s46 offen sc1 lds
    s_add_u32 m0, s41, 10240
    s_add_u32 s46, s43, 10240
    buffer_load_dwordx4 v4, s[24:27], s46 offen sc1 lds
    s_add_u32 m0, s41, 12288
    s_add_u32 s46, s43, 12288
    buffer_load_dwordx4 v4, s[24:27], s46 offen sc1 lds
    s_add_u32 m0, s41, 14336
    s_add_u32 s46, s43, 14336
    buffer_load_dwordx4 v4, s[24:27], s46 offen sc1 lds
    s_add_u32 m0, s40, 0
    s_add_u32 s46, s42, 0
    buffer_load_dwordx4 v3, s[20:23], s46 offen lds
    s_add_u32 m0, s40, 2048
    s_add_u32 s46, s42, 8192
    buffer_load_dwordx4 v9, s[20:23], s46 offen lds
    s_add_u32 m0, s40, 4096
    s_add_u32 s46, s42, 16384
    buffer_load_dwordx4 v3, s[20:23], s46 offen lds
    s_add_u32 m0, s40, 6144
    s_add_u32 s46, s42, 24576
    buffer_load_dwordx4 v9, s[20:23], s46 offen lds
    s_add_u32 m0, s40, 8192
    s_add_u32 s46, s42, 32768
    buffer_load_dwordx4 v3, s[20:23], s46 offen lds
    s_add_u32 m0, s40, 10240
    s_add_u32 s46, s42, 40960
    buffer_load_dwordx4 v9, s[20:23], s46 offen lds
    s_add_u32 m0, s40, 12288
    s_add_u32 s46, s42, 49152
    buffer_load_dwordx4 v3, s[20:23], s46 offen lds
    s_add_u32 m0, s40, 14336
    s_add_u32 s46, s42, 57344
    buffer_load_dwordx4 v9, s[20:23], s46 offen lds
    s_add_u32 m0, s40, 16384
    s_add_u32 s46, s42, 262144
    buffer_load_dwordx4 v3, s[20:23], s46 offen lds
    s_add_u32 m0, s40, 18432
    s_add_u32 s46, s42, 270336
    buffer_load_dwordx4 v9, s[20:23], s46 offen lds
    s_add_u32 m0, s40, 20480
    s_add_u32 s46, s42, 278528
    buffer_load_dwordx4 v3, s[20:23], s46 offen lds
    s_add_u32 m0, s40, 22528
    s_add_u32 s46, s42, 286720
    buffer_load_dwordx4 v9, s[20:23], s46 offen lds
    s_add_u32 m0, s40, 24576
    s_add_u32 s46, s42, 294912
    buffer_load_dwordx4 v3, s[20:23], s46 offen lds
    s_add_u32 m0, s40, 26624
    s_add_u32 s46, s42, 303104
    buffer_load_dwordx4 v9, s[20:23], s46 offen lds
    s_add_u32 m0, s40, 28672
    s_add_u32 s46, s42, 311296
    buffer_load_dwordx4 v3, s[20:23], s46 offen lds
    s_add_u32 m0, s40, 30720
    s_add_u32 s46, s42, 319488
    buffer_load_dwordx4 v9, s[20:23], s46 offen lds
L_adv_4:
    s_add_u32 s60, s60, 4
    s_add_u32 s45, s62, 1
    s_add_u32 s44, s45, s58
    s_cmp_ge_u32 s60, s61
    s_cselect_b32 s60, s44, s60
    s_cselect_b32 s62, s45, s62
    s_sub_u32 s44, s60, s65
    s_cmp_lt_u32 s44, 3
    s_cbranch_scc1 L_adv_4
    s_and_b32 s44, s66, 0xff
    s_lshr_b32 s45, s66, 8
    s_cmp_ge_u32 s62, 4
    s_cselect_b32 s44, s44, s60
    s_cselect_b32 s66, s45, s66
    s_lshr_b32 s42, s44, 2
    s_lshl_b32 s42, s42, 19
    s_and_b32 s45, s44, 3
    s_lshl_b32 s45, s45, 16
    s_add_u32 s42, s42, s45
    s_add_u32 s42, s42, s63
    s_lshl_b32 s43, s44, 18
    s_add_u32 s43, s43, s64
    s_add_u32 s48, s48, 1
    s_cmp_eq_u32 s48, 3
    s_cselect_b32 s45, s50, s51
    s_cselect_b32 s48, 0, s48
    s_add_u32 s40, s40, s45
    s_add_u32 s41, s41, s45
    s_add_u32 s47, s47, 1
    s_waitcnt vmcnt(24)
    s_barrier
    s_cmp_eq_u32 s47, s67
    s_cbranch_scc1 L_g2_ev
L_g2_evr:
    s_cmp_lt_u32 s47, 20
    s_cbranch_scc1 L_g2_ld
    s_waitcnt vmcnt(0)
    s_barrier
    s_endpgm
L_g2_ev:
    s_cmp_lg_u32 s47, 5
    s_cbranch_scc1 L_g2_ev6
    buffer_load_dword v6, v10, s[28:31], s38 offen sc1
    s_mov_b32 s67, 6
    s_branch L_g2_evr
L_g2_ev6:
    s_cmp_lg_u32 s47, 6
    s_cbranch_scc1 L_g2_ev7
    s_mov_b32 s67, 15
    v_cmp_ne_u32 vcc, s74, v6
    s_nop 4
    s_cbranch_vccz L_g2_evr
    s_mov_b32 s83, 0x20000
L_g2_h2:
    buffer_load_dword v6, v10, s[28:31], s38 offen sc1
    s_waitcnt vmcnt(0)
L_g2_h2_w:
    v_cmp_ne_u32 vcc, s74, v6
    s_nop 0
    s_mov_b64 s[80:81], vcc
    s_cmp_eq_u64 s[80:81], 0
    s_cbranch_scc1 L_g2_h2_ok
    s_sleep 4
    s_sub_u32 s83, s83, 1
    s_cmp_lg_u32 s83, 0
    s_cbranch_scc1 L_g2_h2
L_g2_h2_ok:
    s_branch L_g2_evr
L_g2_ev7:
    s_cmp_lg_u32 s47, 15
    s_cbranch_scc1 L_g2_ev8
    s_getpc_b64 s[76:77]
L_pc_5:
    s_lshr_b32 s78, s2, 3
    s_and_b32 s78, s78, 1
    s_lshl_b32 s78, s78, 13
    s_add_u32 s76, s76, L_g2_tail-L_pc_5
    s_addc_u32 s77, s77, 0
    v_and_b32 v250, 63, v0
    v_lshl_add_u32 v250, v250, 7, s78
    v_min_u32 v250, L_code_end-L_g2_tail-4, v250
    v_mov_b32 v251, s77
    v_add_co_u32 v250, vcc, s76, v250
    s_nop 1
    v_addc_co_u32 v251, vcc, 0, v251, vcc
    global_load_dword v252, v[250:251], off
    buffer_load_dword v6, v11, s[28:31], s38 offen sc1
    s_mov_b32 s67, 16
    s_branch L_g2_evr
L_g2_ev8:
    v_cmp_ne_u32 vcc, s74, v6
    s_nop 4
    s_cbranch_vccz L_g2_evr
    s_mov_b32 s83, 0x20000
L_g2_h3:
    buffer_load_dword v6, v11, s[28:31], s38 offen sc1
    s_waitcnt vmcnt(0)
L_g2_h3_w:
    v_cmp_ne_u32 vcc, s74, v6
    s_nop 0
    s_mov_b64 s[80:81], vcc
    s_cmp_eq_u64 s[80:81], 0
    s_cbranch_scc1 L_g2_h3_ok
    s_sleep 4
    s_sub_u32 s83, s83, 1
    s_cmp_lg_u32 s83, 0
    s_cbranch_scc1 L_g2_h3
L_g2_h3_ok:
    s_branch L_g2_evr
L_g2_c:
    s_lshl_b32 s12, s14, 2
    s_add_u32 s12, s12, s13
    s_mov_b32 s48, 1
    s_waitcnt lgkmcnt(0)
    s_barrier
    ds_read_b64_tr_b16 v[216:217], v12 offset:0
    ds_read_b64_tr_b16 v[218:219], v12 offset:8192
    ds_read_b64_tr_b16 v[220:221], v12 offset:16384
    ds_read_b64_tr_b16 v[222:223], v12 offset:24576
    ds_read_b128 v[152:155], v20 offset:0
    ds_read_b128 v[168:171], v21 offset:0
    ds_read_b128 v[172:175], v21 offset:2048
    ds_read_b128 v[156:159], v20 offset:2048
    ds_read_b128 v[160:163], v20 offset:4096
    ds_read_b128 v[176:179], v21 offset:4096
    ds_read_b128 v[180:183], v21 offset:6144
    ds_read_b128 v[164:167], v20 offset:6144
    ds_read_b64_tr_b16 v[224:225], v13 offset:0
    ds_read_b64_tr_b16 v[226:227], v13 offset:8192
    ds_read_b64_tr_b16 v[228:229], v13 offset:16384
    ds_read_b64_tr_b16 v[230:231], v13 offset:24576
    ds_read_b64_tr_b16 v[232:233], v14 offset:0
    ds_read_b64_tr_b16 v[234:235], v14 offset:8192
    ds_read_b64_tr_b16 v[236:237], v14 offset:16384
    ds_read_b64_tr_b16 v[238:239], v14 offset:24576
    s_waitcnt lgkmcnt(8)
    v_mfma_f32_16x16x32_bf16 v[24:27], v[216:219], v[152:155], 0
    ds_read_b64_tr_b16 v[240:241], v15 offset:0
    s_add_u32 s48, s48, 1
    s_cmp_eq_u32 s48, 3
    s_cselect_b32 s49, s50, s51
    s_cselect_b32 s48, 0, s48
    v_mfma_f32_16x16x32_bf16 v[24:27], v[220:223], v[168:171], v[24:27]
    ds_read_b64_tr_b16 v[242:243], v15 offset:8192
    v_mfma_f32_16x16x32_bf16 v[28:31], v[220:223], v[172:175], 0
    ds_read_b64_tr_b16 v[244:245], v15 offset:16384
    v_lshrrev_b32 v22, 4, v2
    v_and_b32 v6, 15, v2
    v_mfma_f32_16x16x32_bf16 v[28:31], v[216:219], v[156:159], v[28:31]
    ds_read_b64_tr_b16 v[246:247], v15 offset:24576
    v_and_b32 v7, 1, v22
    v_mfma_f32_16x16x32_bf16 v[32:35], v[216:219], v[160:163], 0
    v_add_u32 v15, s49, v15
    v_lshrrev_b32 v8, 1, v22
    v_mfma_f32_16x16x32_bf16 v[32:35], v[220:223], v[176:179], v[32:35]
    v_add_u32 v12, s49, v12
    v_lshlrev_b32 v10, 11, v6
    v_lshl_add_u32 v9, v7, 5, v10
    v_mfma_f32_16x16x32_bf16 v[36:39], v[220:223], v[180:183], 0
    v_add_u32 v13, s49, v13
    v_lshl_add_u32 v9, v8, 4, v9
    v_mfma_f32_16x16x32_bf16 v[36:39], v[216:219], v[164:167], v[36:39]
    s_lshl_b32 s54, s14, 1
    s_waitcnt lgkmcnt(8)
    v_mfma_f32_16x16x32_bf16 v[52:55], v[224:227], v[164:167], 0
    ds_read_b64_tr_b16 v[216:217], v16 offset:0
    s_add_u32 s54, s54, s19
    s_lshl_b32 s60, s54, 8
    v_mfma_f32_16x16x32_bf16 v[52:55], v[228:231], v[180:183], v[52:55]
    ds_read_b64_tr_b16 v[218:219], v16 offset:8192
    s_add_u32 s60, s60, 15073280
    v_mfma_f32_16x16x32_bf16 v[48:51], v[228:231], v[176:179], 0
    ds_read_b64_tr_b16 v[220:221], v16 offset:16384
    s_lshl_b32 s54, s54, 17
    v_mfma_f32_16x16x32_bf16 v[48:51], v[224:227], v[160:163], v[48:51]
    ds_read_b64_tr_b16 v[222:223], v16 offset:24576
    s_lshl_b32 s55, s13, 3
    s_lshl_b32 s36, s18, 2
    v_mfma_f32_16x16x32_bf16 v[44:47], v[224:227], v[156:159], 0
    v_add_u32 v16, s49, v16
    s_add_u32 s55, s55, s36
    v_mfma_f32_16x16x32_bf16 v[44:47], v[228:231], v[172:175], v[44:47]
    v_add_u32 v20, s49, v20
    s_lshl_b32 s56, s55, 6
    v_mfma_f32_16x16x32_bf16 v[40:43], v[228:231], v[168:171], 0
    v_add_u32 v21, s49, v21
    s_add_u32 s56, s56, s54
    s_lshl_b32 s57, s55, 10
    v_mfma_f32_16x16x32_bf16 v[40:43], v[224:227], v[152:155], v[40:43]
    s_add_u32 s57, s57, s54
    s_waitcnt lgkmcnt(8)
    v_mfma_f32_16x16x32_bf16 v[56:59], v[232:235], v[152:155], 0
    ds_read_b64_tr_b16 v[224:225], v17 offset:0
    s_add_u32 s57, s57, 25165824
    v_mfma_f32_16x16x32_bf16 v[56:59], v[236:239], v[168:171], v[56:59]
    ds_read_b64_tr_b16 v[226:227], v17 offset:8192
    s_lshl_b32 s36, s12, 2
    s_add_u32 s36, s36, s16
    v_mfma_f32_16x16x32_bf16 v[60:63], v[236:239], v[172:175], 0
    ds_read_b64_tr_b16 v[228:229], v17 offset:16384
    s_lshl_b32 s61, s36, 15
    v_mfma_f32_16x16x32_bf16 v[60:63], v[232:235], v[156:159], v[60:63]
    ds_read_b64_tr_b16 v[230:231], v17 offset:24576
    s_add_u32 s61, s61, 29360128
    v_mfma_f32_16x16x32_bf16 v[64:67], v[232:235], v[160:163], 0
    v_add_u32 v17, s49, v17
    s_mul_i32 s62, s36, 384
    s_add_u32 s62, s62, 15204352
    v_mfma_f32_16x16x32_bf16 v[64:67], v[236:239], v[176:179], v[64:67]
    v_add_u32 v14, s49, v14
    s_lshl_b32 s63, s17, 7
    v_mfma_f32_16x16x32_bf16 v[68:71], v[236:239], v[180:183], 0
    s_add_u32 s63, s63, s62
    v_mfma_f32_16x16x32_bf16 v[68:71], v[232:235], v[164:167], v[68:71]
    v_lshlrev_b32 v3, 7, v2
    s_sub_u32 s36, s60, s62
    s_waitcnt lgkmcnt(8)
    v_mfma_f32_16x16x32_bf16 v[84:87], v[240:243], v[164:167], 0
    ds_read_b64_tr_b16 v[232:233], v18 offset:0
    s_sub_u32 s36, s36, 384
    v_mfma_f32_16x16x32_bf16 v[84:87], v[244:247], v[180:183], v[84:87]
    ds_read_b64_tr_b16 v[234:235], v18 offset:8192
    v_add_u32 v6, s36, v3
    v_mfma_f32_16x16x32_bf16 v[80:83], v[244:247], v[176:179], 0
    ds_read_b64_tr_b16 v[236:237], v18 offset:16384
    v_cmp_lt_u32 vcc, 2, v2
    s_mov_b32 s64, 0x3f317218
    v_mfma_f32_16x16x32_bf16 v[80:83], v[240:243], v[160:163], v[80:83]
    ds_read_b64_tr_b16 v[238:239], v18 offset:24576
    s_mov_b32 s65, s64
    v_mfma_f32_16x16x32_bf16 v[76:79], v[240:243], v[156:159], 0
    v_add_u32 v18, s49, v18
    v_cndmask_b32 v3, v3, v6, vcc
    v_mfma_f32_16x16x32_bf16 v[76:79], v[244:247], v[172:175], v[76:79]
    v_add_u32 v3, s62, v3
    s_mov_b32 s24, s70
    v_mfma_f32_16x16x32_bf16 v[72:75], v[244:247], v[168:171], 0
    s_mov_b32 s25, s71
    v_mfma_f32_16x16x32_bf16 v[72:75], v[240:243], v[152:155], v[72:75]
    s_mov_b32 s26, 4194304
    s_waitcnt lgkmcnt(8)
    v_mfma_f32_16x16x32_bf16 v[88:91], v[216:219], v[152:155], 0
    ds_read_b64_tr_b16 v[240:241], v19 offset:0
    s_mov_b32 s27, 0x20000
    v_min_u32 v10, 4, v2
    v_mfma_f32_16x16x32_bf16 v[88:91], v[220:223], v[168:171], v[88:91]
    ds_read_b64_tr_b16 v[242:243], v19 offset:8192
    v_max_u32 v10, 3, v10
    v_mfma_f32_16x16x32_bf16 v[92:95], v[220:223], v[172:175], 0
    ds_read_b64_tr_b16 v[244:245], v19 offset:16384
    v_subrev_u32 v10, 3, v10
    v_mfma_f32_16x16x32_bf16 v[92:95], v[216:219], v[156:159], v[92:95]
    ds_read_b64_tr_b16 v[246:247], v19 offset:24576
    v_lshlrev_b32 v10, 7, v10
    v_mfma_f32_16x16x32_bf16 v[96:99], v[216:219], v[160:163], 0
    v_add_u32 v19, s49, v19
    v_mfma_f32_16x16x32_bf16 v[96:99], v[220:223], v[176:179], v[96:99]
    v_mfma_f32_16x16x32_bf16 v[100:103], v[220:223], v[180:183], 0
    v_mfma_f32_16x16x32_bf16 v[100:103], v[216:219], v[164:167], v[100:103]
    s_waitcnt lgkmcnt(0)
    s_barrier
    v_mfma_f32_16x16x32_bf16 v[116:119], v[224:227], v[164:167], 0
    ds_read_b64_tr_b16 v[216:217], v12 offset:0
    v_mfma_f32_16x16x32_bf16 v[116:119], v[228:231], v[180:183], v[116:119]
    ds_read_b64_tr_b16 v[218:219], v12 offset:8192
    v_mfma_f32_16x16x32_bf16 v[112:115], v[228:231], v[176:179], 0
    ds_read_b64_tr_b16 v[220:221], v12 offset:16384
    v_mfma_f32_16x16x32_bf16 v[112:115], v[224:227], v[160:163], v[112:115]
    ds_read_b64_tr_b16 v[222:223], v12 offset:24576
    v_mfma_f32_16x16x32_bf16 v[108:111], v[224:227], v[156:159], 0
    ds_read_b128 v[184:187], v20 offset:0
    v_mfma_f32_16x16x32_bf16 v[108:111], v[228:231], v[172:175], v[108:111]
    ds_read_b128 v[200:203], v21 offset:0
    v_mfma_f32_16x16x32_bf16 v[104:107], v[228:231], v[168:171], 0
    ds_read_b128 v[204:207], v21 offset:2048
    v_mfma_f32_16x16x32_bf16 v[104:107], v[224:227], v[152:155], v[104:107]
    ds_read_b128 v[188:191], v20 offset:2048
    v_mfma_f32_16x16x32_bf16 v[120:123], v[232:235], v[152:155], 0
    ds_read_b128 v[192:195], v20 offset:4096
    v_mfma_f32_16x16x32_bf16 v[120:123], v[236:239], v[168:171], v[120:123]
    ds_read_b128 v[208:211], v21 offset:4096
    v_mfma_f32_16x16x32_bf16 v[124:127], v[236:239], v[172:175], 0
    ds_read_b128 v[212:215], v21 offset:6144
    v_mfma_f32_16x16x32_bf16 v[124:127], v[232:235], v[156:159], v[124:127]
    ds_read_b128 v[196:199], v20 offset:6144
    v_mfma_f32_16x16x32_bf16 v[128:131], v[232:235], v[160:163], 0
    ds_read_b64_tr_b16 v[224:225], v13 offset:0
    v_mfma_f32_16x16x32_bf16 v[128:131], v[236:239], v[176:179], v[128:131]
    ds_read_b64_tr_b16 v[226:227], v13 offset:8192
    v_mfma_f32_16x16x32_bf16 v[132:135], v[236:239], v[180:183], 0
    ds_read_b64_tr_b16 v[228:229], v13 offset:16384
    v_mfma_f32_16x16x32_bf16 v[132:135], v[232:235], v[164:167], v[132:135]
    ds_read_b64_tr_b16 v[230:231], v13 offset:24576
    v_mfma_f32_16x16x32_bf16 v[148:151], v[240:243], v[164:167], 0
    ds_read_b64_tr_b16 v[232:233], v14 offset:0
    v_mfma_f32_16x16x32_bf16 v[148:151], v[244:247], v[180:183], v[148:151]
    ds_read_b64_tr_b16 v[234:235], v14 offset:8192
    v_mfma_f32_16x16x32_bf16 v[144:147], v[244:247], v[176:179], 0
    ds_read_b64_tr_b16 v[236:237], v14 offset:16384
    v_mfma_f32_16x16x32_bf16 v[144:147], v[240:243], v[160:163], v[144:147]
    ds_read_b64_tr_b16 v[238:239], v14 offset:24576
    v_mfma_f32_16x16x32_bf16 v[140:143], v[240:243], v[156:159], 0
    v_mfma_f32_16x16x32_bf16 v[140:143], v[244:247], v[172:175], v[140:143]
    v_mfma_f32_16x16x32_bf16 v[136:139], v[244:247], v[168:171], 0
    v_mfma_f32_16x16x32_bf16 v[136:139], v[240:243], v[152:155], v[136:139]
    s_waitcnt vmcnt(0)
    s_mov_b64 exec, 1
    buffer_store_dword v4, v5, s[28:31], s75 offen sc1
    s_mov_b64 exec, -1
    s_mov_b32 s47, 16
.p2alignl 6, 0xbf800000
L_g2_loop:
    s_waitcnt lgkmcnt(8)
    v_mfma_f32_16x16x32_bf16 v[24:27], v[216:219], v[184:187], v[24:27]
    ds_read_b64_tr_b16 v[240:241], v15 offset:0
    s_add_u32 s48, s48, 1
    s_cmp_eq_u32 s48, 3
    s_cselect_b32 s49, s50, s51
    s_cselect_b32 s48, 0, s48
    v_mfma_f32_16x16x32_bf16 v[24:27], v[220:223], v[200:203], v[24:27]
    ds_read_b64_tr_b16 v[242:243], v15 offset:8192
    v_mfma_f32_16x16x32_bf16 v[28:31], v[220:223], v[204:207], v[28:31]
    ds_read_b64_tr_b16 v[244:245], v15 offset:16384
    v_mfma_f32_16x16x32_bf16 v[28:31], v[216:219], v[188:191], v[28:31]
    ds_read_b64_tr_b16 v[246:247], v15 offset:24576
    v_mfma_f32_16x16x32_bf16 v[32:35], v[216:219], v[192:195], v[32:35]
    v_add_u32 v15, s49, v15
    v_mfma_f32_16x16x32_bf16 v[32:35], v[220:223], v[208:211], v[32:35]
    v_add_u32 v12, s49, v12
    v_mfma_f32_16x16x32_bf16 v[36:39], v[220:223], v[212:215], v[36:39]
    v_add_u32 v13, s49, v13
    v_mfma_f32_16x16x32_bf16 v[36:39], v[216:219], v[196:199], v[36:39]
    s_waitcnt lgkmcnt(8)
    v_mfma_f32_16x16x32_bf16 v[52:55], v[224:227], v[196:199], v[52:55]
    ds_read_b64_tr_b16 v[216:217], v16 offset:0
    v_mfma_f32_16x16x32_bf16 v[52:55], v[228:231], v[212:215], v[52:55]
    ds_read_b64_tr_b16 v[218:219], v16 offset:8192
    v_mfma_f32_16x16x32_bf16 v[48:51], v[228:231], v[208:211], v[48:51]
    ds_read_b64_tr_b16 v[220:221], v16 offset:16384
    v_mfma_f32_16x16x32_bf16 v[48:51], v[224:227], v[192:195], v[48:51]
    ds_read_b64_tr_b16 v[222:223], v16 offset:24576
    v_mfma_f32_16x16x32_bf16 v[44:47], v[224:227], v[188:191], v[44:47]
    v_add_u32 v16, s49, v16
    v_mfma_f32_16x16x32_bf16 v[44:47], v[228:231], v[204:207], v[44:47]
    v_add_u32 v20, s49, v20
    v_mfma_f32_16x16x32_bf16 v[40:43], v[228:231], v[200:203], v[40:43]
    v_add_u32 v21, s49, v21
    v_mfma_f32_16x16x32_bf16 v[40:43], v[224:227], v[184:187], v[40:43]
    s_waitcnt lgkmcnt(8)
    v_mfma_f32_16x16x32_bf16 v[56:59], v[232:235], v[184:187], v[56:59]
    ds_read_b64_tr_b16 v[224:225], v17 offset:0
    v_mfma_f32_16x16x32_bf16 v[56:59], v[236:239], v[200:203], v[56:59]
    ds_read_b64_tr_b16 v[226:227], v17 offset:8192
    v_mfma_f32_16x16x32_bf16 v[60:63], v[236:239], v[204:207], v[60:63]
    ds_read_b64_tr_b16 v[228:229], v17 offset:16384
    v_mfma_f32_16x16x32_bf16 v[60:63], v[232:235], v[188:191], v[60:63]
    ds_read_b64_tr_b16 v[230:231], v17 offset:24576
    v_mfma_f32_16x16x32_bf16 v[64:67], v[232:235], v[192:195], v[64:67]
    v_add_u32 v17, s49, v17
    v_mfma_f32_16x16x32_bf16 v[64:67], v[236:239], v[208:211], v[64:67]
    v_add_u32 v14, s49, v14
    v_mfma_f32_16x16x32_bf16 v[68:71], v[236:239], v[212:215], v[68:71]
    v_mfma_f32_16x16x32_bf16 v[68:71], v[232:235], v[196:199], v[68:71]
    s_waitcnt lgkmcnt(8)
    v_mfma_f32_16x16x32_bf16 v[84:87], v[240:243], v[196:199], v[84:87]
    ds_read_b64_tr_b16 v[232:233], v18 offset:0
    v_mfma_f32_16x16x32_bf16 v[84:87], v[244:247], v[212:215], v[84:87]
    ds_read_b64_tr_b16 v[234:235], v18 offset:8192
    v_mfma_f32_16x16x32_bf16 v[80:83], v[244:247], v[208:211], v[80:83]
    ds_read_b64_tr_b16 v[236:237], v18 offset:16384
    v_mfma_f32_16x16x32_bf16 v[80:83], v[240:243], v[192:195], v[80:83]
    ds_read_b64_tr_b16 v[238:239], v18 offset:24576
    v_mfma_f32_16x16x32_bf16 v[76:79], v[240:243], v[188:191], v[76:79]
    v_add_u32 v18, s49, v18
    v_mfma_f32_16x16x32_bf16 v[76:79], v[244:247], v[204:207], v[76:79]
    v_mfma_f32_16x16x32_bf16 v[72:75], v[244:247], v[200:203], v[72:75]
    v_mfma_f32_16x16x32_bf16 v[72:75], v[240:243], v[184:187], v[72:75]
    s_waitcnt lgkmcnt(8)
    v_mfma_f32_16x16x32_bf16 v[88:91], v[216:219], v[184:187], v[88:91]
    ds_read_b64_tr_b16 v[240:241], v19 offset:0
    v_mfma_f32_16x16x32_bf16 v[88:91], v[220:223], v[200:203], v[88:91]
    ds_read_b64_tr_b16 v[242:243], v19 offset:8192
    v_mfma_f32_16x16x32_bf16 v[92:95], v[220:223], v[204:207], v[92:95]
    ds_read_b64_tr_b16 v[244:245], v19 offset:16384
    v_mfma_f32_16x16x32_bf16 v[92:95], v[216:219], v[188:191], v[92:95]
    ds_read_b64_tr_b16 v[246:247], v19 offset:24576
    v_mfma_f32_16x16x32_bf16 v[96:99], v[216:219], v[192:195], v[96:99]
    v_add_u32 v19, s49, v19
    v_mfma_f32_16x16x32_bf16 v[96:99], v[220:223], v[208:211], v[96:99]
    v_mfma_f32_16x16x32_bf16 v[100:103], v[220:223], v[212:215], v[100:103]
    v_mfma_f32_16x16x32_bf16 v[100:103], v[216:219], v[196:199], v[100:103]
    s_waitcnt lgkmcnt(0)
    s_barrier
    v_mfma_f32_16x16x32_bf16 v[116:119], v[224:227], v[196:199], v[116:119]
    ds_read_b64_tr_b16 v[216:217], v12 offset:0
    v_mfma_f32_16x16x32_bf16 v[116:119], v[228:231], v[212:215], v[116:119]
    ds_read_b64_tr_b16 v[218:219], v12 offset:8192
    v_mfma_f32_16x16x32_bf16 v[112:115], v[228:231], v[208:211], v[112:115]
    ds_read_b64_tr_b16 v[220:221], v12 offset:16384
    v_mfma_f32_16x16x32_bf16 v[112:115], v[224:227], v[192:195], v[112:115]
    ds_read_b64_tr_b16 v[222:223], v12 offset:24576
    v_mfma_f32_16x16x32_bf16 v[108:111], v[224:227], v[188:191], v[108:111]
    ds_read_b128 v[152:155], v20 offset:0
    v_mfma_f32_16x16x32_bf16 v[108:111], v[228:231], v[204:207], v[108:111]
    ds_read_b128 v[168:171], v21 offset:0
    v_mfma_f32_16x16x32_bf16 v[104:107], v[228:231], v[200:203], v[104:107]
    ds_read_b128 v[172:175], v21 offset:2048
    v_mfma_f32_16x16x32_bf16 v[104:107], v[224:227], v[184:187], v[104:107]
    ds_read_b128 v[156:159], v20 offset:2048
    v_mfma_f32_16x16x32_bf16 v[120:123], v[232:235], v[184:187], v[120:123]
    ds_read_b128 v[160:163], v20 offset:4096
    v_mfma_f32_16x16x32_bf16 v[120:123], v[236:239], v[200:203], v[120:123]
    ds_read_b128 v[176:179], v21 offset:4096
    v_mfma_f32_16x16x32_bf16 v[124:127], v[236:239], v[204:207], v[124:127]
    ds_read_b128 v[180:183], v21 offset:6144
    v_mfma_f32_16x16x32_bf16 v[124:127], v[232:235], v[188:191], v[124:127]
    ds_read_b128 v[164:167], v20 offset:6144
    v_mfma_f32_16x16x32_bf16 v[128:131], v[232:235], v[192:195], v[128:131]
    ds_read_b64_tr_b16 v[224:225], v13 offset:0
    v_mfma_f32_16x16x32_bf16 v[128:131], v[236:239], v[208:211], v[128:131]
    ds_read_b64_tr_b16 v[226:227], v13 offset:8192
    v_mfma_f32_16x16x32_bf16 v[132:135], v[236:239], v[212:215], v[132:135]
    ds_read_b64_tr_b16 v[228:229], v13 offset:16384
    v_mfma_f32_16x16x32_bf16 v[132:135], v[232:235], v[196:199], v[132:135]
    ds_read_b64_tr_b16 v[230:231], v13 offset:24576
    v_mfma_f32_16x16x32_bf16 v[148:151], v[240:243], v[196:199], v[148:151]
    ds_read_b64_tr_b16 v[232:233], v14 offset:0
    v_mfma_f32_16x16x32_bf16 v[148:151], v[244:247], v[212:215], v[148:151]
    ds_read_b64_tr_b16 v[234:235], v14 offset:8192
    v_mfma_f32_16x16x32_bf16 v[144:147], v[244:247], v[208:211], v[144:147]
    ds_read_b64_tr_b16 v[236:237], v14 offset:16384
    v_mfma_f32_16x16x32_bf16 v[144:147], v[240:243], v[192:195], v[144:147]
    ds_read_b64_tr_b16 v[238:239], v14 offset:24576
    v_mfma_f32_16x16x32_bf16 v[140:143], v[240:243], v[188:191], v[140:143]
    v_mfma_f32_16x16x32_bf16 v[140:143], v[244:247], v[204:207], v[140:143]
    s_sub_u32 s47, s47, 1
    s_cmp_lg_u32 s47, 0
    v_mfma_f32_16x16x32_bf16 v[136:139], v[244:247], v[200:203], v[136:139]
    v_mfma_f32_16x16x32_bf16 v[136:139], v[240:243], v[184:187], v[136:139]
    s_waitcnt lgkmcnt(8)
    v_mfma_f32_16x16x32_bf16 v[24:27], v[216:219], v[152:155], v[24:27]
    ds_read_b64_tr_b16 v[240:241], v15 offset:0
    s_add_u32 s48, s48, 1
    s_cmp_eq_u32 s48, 3
    s_cselect_b32 s49, s50, s51
    s_cselect_b32 s48, 0, s48
    v_mfma_f32_16x16x32_bf16 v[24:27], v[220:223], v[168:171], v[24:27]
    ds_read_b64_tr_b16 v[242:243], v15 offset:8192
    v_mfma_f32_16x16x32_bf16 v[28:31], v[220:223], v[172:175], v[28:31]
    ds_read_b64_tr_b16 v[244:245], v15 offset:16384
    v_mfma_f32_16x16x32_bf16 v[28:31], v[216:219], v[156:159], v[28:31]
    ds_read_b64_tr_b16 v[246:247], v15 offset:24576
    v_mfma_f32_16x16x32_bf16 v[32:35], v[216:219], v[160:163], v[32:35]
    v_add_u32 v15, s49, v15
    v_mfma_f32_16x16x32_bf16 v[32:35], v[220:223], v[176:179], v[32:35]
    v_add_u32 v12, s49, v12
    v_mfma_f32_16x16x32_bf16 v[36:39], v[220:223], v[180:183], v[36:39]
    v_add_u32 v13, s49, v13
    v_mfma_f32_16x16x32_bf16 v[36:39], v[216:219], v[164:167], v[36:39]
    s_waitcnt lgkmcnt(8)
    v_mfma_f32_16x16x32_bf16 v[52:55], v[224:227], v[164:167], v[52:55]
    ds_read_b64_tr_b16 v[216:217], v16 offset:0
    v_mfma_f32_16x16x32_bf16 v[52:55], v[228:231], v[180:183], v[52:55]
    ds_read_b64_tr_b16 v[218:219], v16 offset:8192
    v_mfma_f32_16x16x32_bf16 v[48:51], v[228:231], v[176:179], v[48:51]
    ds_read_b64_tr_b16 v[220:221], v16 offset:16384
    v_mfma_f32_16x16x32_bf16 v[48:51], v[224:227], v[160:163], v[48:51]
    ds_read_b64_tr_b16 v[222:223], v16 offset:24576
    v_mfma_f32_16x16x32_bf16 v[44:47], v[224:227], v[156:159], v[44:47]
    v_add_u32 v16, s49, v16
    v_mfma_f32_16x16x32_bf16 v[44:47], v[228:231], v[172:175], v[44:47]
    v_add_u32 v20, s49, v20
    v_mfma_f32_16x16x32_bf16 v[40:43], v[228:231], v[168:171], v[40:43]
    v_add_u32 v21, s49, v21
    v_mfma_f32_16x16x32_bf16 v[40:43], v[224:227], v[152:155], v[40:43]
    s_waitcnt lgkmcnt(8)
    v_mfma_f32_16x16x32_bf16 v[56:59], v[232:235], v[152:155], v[56:59]
    ds_read_b64_tr_b16 v[224:225], v17 offset:0
    v_mfma_f32_16x16x32_bf16 v[56:59], v[236:239], v[168:171], v[56:59]
    ds_read_b64_tr_b16 v[226:227], v17 offset:8192
    v_mfma_f32_16x16x32_bf16 v[60:63], v[236:239], v[172:175], v[60:63]
    ds_read_b64_tr_b16 v[228:229], v17 offset:16384
    v_mfma_f32_16x16x32_bf16 v[60:63], v[232:235], v[156:159], v[60:63]
    ds_read_b64_tr_b16 v[230:231], v17 offset:24576
    v_mfma_f32_16x16x32_bf16 v[64:67], v[232:235], v[160:163], v[64:67]
    v_add_u32 v17, s49, v17
    v_mfma_f32_16x16x32_bf16 v[64:67], v[236:239], v[176:179], v[64:67]
    v_add_u32 v14, s49, v14
    v_mfma_f32_16x16x32_bf16 v[68:71], v[236:239], v[180:183], v[68:71]
    v_mfma_f32_16x16x32_bf16 v[68:71], v[232:235], v[164:167], v[68:71]
    s_waitcnt lgkmcnt(8)
    v_mfma_f32_16x16x32_bf16 v[84:87], v[240:243], v[164:167], v[84:87]
    ds_read_b64_tr_b16 v[232:233], v18 offset:0
    v_mfma_f32_16x16x32_bf16 v[84:87], v[244:247], v[180:183], v[84:87]
    ds_read_b64_tr_b16 v[234:235], v18 offset:8192
    v_mfma_f32_16x16x32_bf16 v[80:83], v[244:247], v[176:179], v[80:83]
    ds_read_b64_tr_b16 v[236:237], v18 offset:16384
    v_mfma_f32_16x16x32_bf16 v[80:83], v[240:243], v[160:163], v[80:83]
    ds_read_b64_tr_b16 v[238:239], v18 offset:24576
    v_mfma_f32_16x16x32_bf16 v[76:79], v[240:243], v[156:159], v[76:79]
    v_add_u32 v18, s49, v18
    v_mfma_f32_16x16x32_bf16 v[76:79], v[244:247], v[172:175], v[76:79]
    v_mfma_f32_16x16x32_bf16 v[72:75], v[244:247], v[168:171], v[72:75]
    v_mfma_f32_16x16x32_bf16 v[72:75], v[240:243], v[152:155], v[72:75]
    s_waitcnt lgkmcnt(8)
    v_mfma_f32_16x16x32_bf16 v[88:91], v[216:219], v[152:155], v[88:91]
    ds_read_b64_tr_b16 v[240:241], v19 offset:0
    v_mfma_f32_16x16x32_bf16 v[88:91], v[220:223], v[168:171], v[88:91]
    ds_read_b64_tr_b16 v[242:243], v19 offset:8192
    v_mfma_f32_16x16x32_bf16 v[92:95], v[220:223], v[172:175], v[92:95]
    ds_read_b64_tr_b16 v[244:245], v19 offset:16384
    v_mfma_f32_16x16x32_bf16 v[92:95], v[216:219], v[156:159], v[92:95]
    ds_read_b64_tr_b16 v[246:247], v19 offset:24576
    v_mfma_f32_16x16x32_bf16 v[96:99], v[216:219], v[160:163], v[96:99]
    v_add_u32 v19, s49, v19
    v_mfma_f32_16x16x32_bf16 v[96:99], v[220:223], v[176:179], v[96:99]
    v_mfma_f32_16x16x32_bf16 v[100:103], v[220:223], v[180:183], v[100:103]
    v_mfma_f32_16x16x32_bf16 v[100:103], v[216:219], v[164:167], v[100:103]
    s_waitcnt lgkmcnt(0)
    s_barrier
    v_mfma_f32_16x16x32_bf16 v[116:119], v[224:227], v[164:167], v[116:119]
    ds_read_b64_tr_b16 v[216:217], v12 offset:0
    v_mfma_f32_16x16x32_bf16 v[116:119], v[228:231], v[180:183], v[116:119]
    ds_read_b64_tr_b16 v[218:219], v12 offset:8192
    v_mfma_f32_16x16x32_bf16 v[112:115], v[228:231], v[176:179], v[112:115]
    ds_read_b64_tr_b16 v[220:221], v12 offset:16384
    v_mfma_f32_16x16x32_bf16 v[112:115], v[224:227], v[160:163], v[112:115]
    ds_read_b64_tr_b16 v[222:223], v12 offset:24576
    v_mfma_f32_16x16x32_bf16 v[108:111], v[224:227], v[156:159], v[108:111]
    ds_read_b128 v[184:187], v20 offset:0
    v_mfma_f32_16x16x32_bf16 v[108:111], v[228:231], v[172:175], v[108:111]
    ds_read_b128 v[200:203], v21 offset:0
    v_mfma_f32_16x16x32_bf16 v[104:107], v[228:231], v[168:171], v[104:107]
    ds_read_b128 v[204:207], v21 offset:2048
    v_mfma_f32_16x16x32_bf16 v[104:107], v[224:227], v[152:155], v[104:107]
    ds_read_b128 v[188:191], v20 offset:2048
    v_mfma_f32_16x16x32_bf16 v[120:123], v[232:235], v[152:155], v[120:123]
    ds_read_b128 v[192:195], v20 offset:4096
    v_mfma_f32_16x16x32_bf16 v[120:123], v[236:239], v[168:171], v[120:123]
    ds_read_b128 v[208:211], v21 offset:4096
    v_mfma_f32_16x16x32_bf16 v[124:127], v[236:239], v[172:175], v[124:127]
    ds_read_b128 v[212:215], v21 offset:6144
    v_mfma_f32_16x16x32_bf16 v[124:127], v[232:235], v[156:159], v[124:127]
    ds_read_b128 v[196:199], v20 offset:6144
    v_mfma_f32_16x16x32_bf16 v[128:131], v[232:235], v[160:163], v[128:131]
    ds_read_b64_tr_b16 v[224:225], v13 offset:0
    v_mfma_f32_16x16x32_bf16 v[128:131], v[236:239], v[176:179], v[128:131]
    ds_read_b64_tr_b16 v[226:227], v13 offset:8192
    v_mfma_f32_16x16x32_bf16 v[132:135], v[236:239], v[180:183], v[132:135]
    ds_read_b64_tr_b16 v[228:229], v13 offset:16384
    v_mfma_f32_16x16x32_bf16 v[132:135], v[232:235], v[164:167], v[132:135]
    ds_read_b64_tr_b16 v[230:231], v13 offset:24576
    v_mfma_f32_16x16x32_bf16 v[148:151], v[240:243], v[164:167], v[148:151]
    ds_read_b64_tr_b16 v[232:233], v14 offset:0
    v_mfma_f32_16x16x32_bf16 v[148:151], v[244:247], v[180:183], v[148:151]
    ds_read_b64_tr_b16 v[234:235], v14 offset:8192
    v_mfma_f32_16x16x32_bf16 v[144:147], v[244:247], v[176:179], v[144:147]
    ds_read_b64_tr_b16 v[236:237], v14 offset:16384
    v_mfma_f32_16x16x32_bf16 v[144:147], v[240:243], v[160:163], v[144:147]
    ds_read_b64_tr_b16 v[238:239], v14 offset:24576
    v_mfma_f32_16x16x32_bf16 v[140:143], v[240:243], v[156:159], v[140:143]
    v_mfma_f32_16x16x32_bf16 v[140:143], v[244:247], v[172:175], v[140:143]
    s_sub_u32 s47, s47, 1
    s_cmp_lg_u32 s47, 0
    v_mfma_f32_16x16x32_bf16 v[136:139], v[244:247], v[168:171], v[136:139]
    v_mfma_f32_16x16x32_bf16 v[136:139], v[240:243], v[152:155], v[136:139]
    s_cbranch_scc1 L_g2_loop
L_g2_tail:
    s_cmp_lg_u32 s17, 0
    s_cbranch_scc1 L_g2_k1
    s_waitcnt lgkmcnt(8)
    v_mfma_f32_16x16x32_bf16 v[24:27], v[216:219], v[184:187], v[24:27]
    ds_read_b64_tr_b16 v[240:241], v15 offset:0
    s_add_u32 s48, s48, 1
    s_cmp_eq_u32 s48, 3
    s_cselect_b32 s49, s50, s51
    s_cselect_b32 s48, 0, s48
    v_mfma_f32_16x16x32_bf16 v[24:27], v[220:223], v[200:203], v[24:27]
    ds_read_b64_tr_b16 v[242:243], v15 offset:8192
    v_mfma_f32_16x16x32_bf16 v[28:31], v[220:223], v[204:207], v[28:31]
    ds_read_b64_tr_b16 v[244:245], v15 offset:16384
    v_mfma_f32_16x16x32_bf16 v[28:31], v[216:219], v[188:191], v[28:31]
    ds_read_b64_tr_b16 v[246:247], v15 offset:24576
    v_mfma_f32_16x16x32_bf16 v[32:35], v[216:219], v[192:195], v[32:35]
    v_add_u32 v15, s49, v15
    v_mfma_f32_16x16x32_bf16 v[32:35], v[220:223], v[208:211], v[32:35]
    v_add_u32 v12, s49, v12
    v_mfma_f32_16x16x32_bf16 v[36:39], v[220:223], v[212:215], v[36:39]
    v_add_u32 v13, s49, v13
    v_mfma_f32_16x16x32_bf16 v[36:39], v[216:219], v[196:199], v[36:39]
    s_waitcnt lgkmcnt(8)
    v_mfma_f32_16x16x32_bf16 v[52:55], v[224:227], v[196:199], v[52:55]
    ds_read_b64_tr_b16 v[216:217], v16 offset:0
    v_mfma_f32_16x16x32_bf16 v[52:55], v[228:231], v[212:215], v[52:55]
    ds_read_b64_tr_b16 v[218:219], v16 offset:8192
    v_mfma_f32_16x16x32_bf16 v[48:51], v[228:231], v[208:211], v[48:51]
    ds_read_b64_tr_b16 v[220:221], v16 offset:16384
    v_mfma_f32_16x16x32_bf16 v[48:51], v[224:227], v[192:195], v[48:51]
    ds_read_b64_tr_b16 v[222:223], v16 offset:24576
    v_mfma_f32_16x16x32_bf16 v[44:47], v[224:227], v[188:191], v[44:47]
    v_add_u32 v16, s49, v16
    v_mfma_f32_16x16x32_bf16 v[44:47], v[228:231], v[204:207], v[44:47]
    v_add_u32 v20, s49, v20
    v_mfma_f32_16x16x32_bf16 v[40:43], v[228:231], v[200:203], v[40:43]
    v_add_u32 v21, s49, v21
    v_mfma_f32_16x16x32_bf16 v[40:43], v[224:227], v[184:187], v[40:43]
    s_waitcnt lgkmcnt(8)
    v_mfma_f32_16x16x32_bf16 v[56:59], v[232:235], v[184:187], v[56:59]
    ds_read_b64_tr_b16 v[224:225], v17 offset:0
    v_mfma_f32_16x16x32_bf16 v[56:59], v[236:239], v[200:203], v[56:59]
    ds_read_b64_tr_b16 v[226:227], v17 offset:8192
    v_mfma_f32_16x16x32_bf16 v[60:63], v[236:239], v[204:207], v[60:63]
    ds_read_b64_tr_b16 v[228:229], v17 offset:16384
    v_mfma_f32_16x16x32_bf16 v[60:63], v[232:235], v[188:191], v[60:63]
    ds_read_b64_tr_b16 v[230:231], v17 offset:24576
    v_mfma_f32_16x16x32_bf16 v[64:67], v[232:235], v[192:195], v[64:67]
    v_add_u32 v17, s49, v17
    v_cvt_pk_bf16_f32 v24, v24, v25
    v_cvt_pk_bf16_f32 v25, v26, v27
    v_mfma_f32_16x16x32_bf16 v[64:67], v[236:239], v[208:211], v[64:67]
    v_add_u32 v14, s49, v14
    v_cvt_pk_bf16_f32 v26, v40, v41
    v_mfma_f32_16x16x32_bf16 v[68:71], v[236:239], v[212:215], v[68:71]
    v_cvt_pk_bf16_f32 v27, v42, v43
    v_mfma_f32_16x16x32_bf16 v[68:71], v[232:235], v[196:199], v[68:71]
    s_add_u32 s37, s61, 0
    buffer_store_dwordx4 v[24:27], v11, s[28:31], s37 offen offset:0 sc1
    v_cvt_pk_bf16_f32 v32, v32, v33
    s_waitcnt lgkmcnt(8)
    v_mfma_f32_16x16x32_bf16 v[84:87], v[240:243], v[196:199], v[84:87]
    ds_read_b64_tr_b16 v[232:233], v18 offset:0
    v_cvt_pk_bf16_f32 v33, v34, v35
    v_mfma_f32_16x16x32_bf16 v[84:87], v[244:247], v[212:215], v[84:87]
    ds_read_b64_tr_b16 v[234:235], v18 offset:8192
    v_cvt_pk_bf16_f32 v34, v48, v49
    v_mfma_f32_16x16x32_bf16 v[80:83], v[244:247], v[208:211], v[80:83]
    ds_read_b64_tr_b16 v[236:237], v18 offset:16384
    v_cvt_pk_bf16_f32 v35, v50, v51
    s_add_u32 s37, s61, 16384
    buffer_store_dwordx4 v[32:35], v11, s[28:31], s37 offen offset:1024 sc1
    v_mfma_f32_16x16x32_bf16 v[80:83], v[240:243], v[192:195], v[80:83]
    ds_read_b64_tr_b16 v[238:239], v18 offset:24576
    v_cvt_pk_bf16_f32 v36, v36, v37
    v_mfma_f32_16x16x32_bf16 v[76:79], v[240:243], v[188:191], v[76:79]
    v_add_u32 v18, s49, v18
    v_cvt_pk_bf16_f32 v37, v38, v39
    v_mfma_f32_16x16x32_bf16 v[76:79], v[244:247], v[204:207], v[76:79]
    v_cvt_pk_bf16_f32 v38, v52, v53
    v_cvt_pk_bf16_f32 v39, v54, v55
    v_mfma_f32_16x16x32_bf16 v[72:75], v[244:247], v[200:203], v[72:75]
    s_add_u32 s37, s61, 24576
    buffer_store_dwordx4 v[36:39], v11, s[28:31], s37 offen offset:0 sc1
    v_mfma_f32_16x16x32_bf16 v[72:75], v[240:243], v[184:187], v[72:75]
    s_waitcnt lgkmcnt(8)
    v_mfma_f32_16x16x32_bf16 v[88:91], v[216:219], v[184:187], v[88:91]
    ds_read_b64_tr_b16 v[240:241], v19 offset:0
    v_mfma_f32_16x16x32_bf16 v[88:91], v[220:223], v[200:203], v[88:91]
    ds_read_b64_tr_b16 v[242:243], v19 offset:8192
    v_mfma_f32_16x16x32_bf16 v[92:95], v[220:223], v[204:207], v[92:95]
    ds_read_b64_tr_b16 v[244:245], v19 offset:16384
    v_mfma_f32_16x16x32_bf16 v[92:95], v[216:219], v[188:191], v[92:95]
    ds_read_b64_tr_b16 v[246:247], v19 offset:24576
    v_mfma_f32_16x16x32_bf16 v[96:99], v[216:219], v[192:195], v[96:99]
    v_add_u32 v19, s49, v19
    v_cvt_pk_bf16_f32 v60, v60, v61
    v_cvt_pk_bf16_f32 v61, v62, v63
    v_mfma_f32_16x16x32_bf16 v[96:99], v[220:223], v[208:211], v[96:99]
    v_cvt_pk_bf16_f32 v62, v76, v77
    v_mfma_f32_16x16x32_bf16 v[100:103], v[220:223], v[212:215], v[100:103]
    v_cvt_pk_bf16_f32 v63, v78, v79
    v_mfma_f32_16x16x32_bf16 v[100:103], v[216:219], v[196:199], v[100:103]
    s_add_u32 s37, s61, 8192
    buffer_store_dwordx4 v[60:63], v11, s[28:31], s37 offen offset:3072 sc1
    v_cvt_pk_bf16_f32 v64, v64, v65
    s_waitcnt lgkmcnt(0)
    s_barrier
    v_mfma_f32_16x16x32_bf16 v[116:119], v[224:227], v[196:199], v[116:119]
    ds_read_b64_tr_b16 v[216:217], v12 offset:0
    v_cvt_pk_bf16_f32 v65, v66, v67
    v_mfma_f32_16x16x32_bf16 v[116:119], v[228:231], v[212:215], v[116:119]
    ds_read_b64_tr_b16 v[218:219], v12 offset:8192
    v_cvt_pk_bf16_f32 v66, v80, v81
    v_mfma_f32_16x16x32_bf16 v[112:115], v[228:231], v[208:211], v[112:115]
    ds_read_b64_tr_b16 v[220:221], v12 offset:16384
    v_cvt_pk_bf16_f32 v67, v82, v83
    s_add_u32 s37, s61, 16384
    buffer_store_dwordx4 v[64:67], v11, s[28:31], s37 offen offset:2048 sc1
    v_mfma_f32_16x16x32_bf16 v[112:115], v[224:227], v[192:195], v[112:115]
    ds_read_b64_tr_b16 v[222:223], v12 offset:24576
    v_mfma_f32_16x16x32_bf16 v[108:111], v[224:227], v[188:191], v[108:111]
    ds_read_b128 v[152:155], v20 offset:0
    v_mfma_f32_16x16x32_bf16 v[108:111], v[228:231], v[204:207], v[108:111]
    ds_read_b128 v[168:171], v21 offset:0
    v_mfma_f32_16x16x32_bf16 v[104:107], v[228:231], v[200:203], v[104:107]
    ds_read_b128 v[172:175], v21 offset:2048
    v_mfma_f32_16x16x32_bf16 v[104:107], v[224:227], v[184:187], v[104:107]
    ds_read_b128 v[156:159], v20 offset:2048
    v_mfma_f32_16x16x32_bf16 v[120:123], v[232:235], v[184:187], v[120:123]
    ds_read_b128 v[160:163], v20 offset:4096
    v_mfma_f32_16x16x32_bf16 v[120:123], v[236:239], v[200:203], v[120:123]
    ds_read_b128 v[176:179], v21 offset:4096
    v_mfma_f32_16x16x32_bf16 v[124:127], v[236:239], v[204:207], v[124:127]
    ds_read_b128 v[180:183], v21 offset:6144
    v_mfma_f32_16x16x32_bf16 v[124:127], v[232:235], v[188:191], v[124:127]
    ds_read_b128 v[164:167], v20 offset:6144
    v_mfma_f32_16x16x32_bf16 v[128:131], v[232:235], v[192:195], v[128:131]
    ds_read_b64_tr_b16 v[224:225], v13 offset:0
    v_cvt_pk_bf16_f32 v88, v88, v89
    v_cvt_pk_bf16_f32 v89, v90, v91
    v_mfma_f32_16x16x32_bf16 v[128:131], v[236:239], v[208:211], v[128:131]
    ds_read_b64_tr_b16 v[226:227], v13 offset:8192
    v_cvt_pk_bf16_f32 v90, v104, v105
    v_mfma_f32_16x16x32_bf16 v[132:135], v[236:239], v[212:215], v[132:135]
    ds_read_b64_tr_b16 v[228:229], v13 offset:16384
    v_cvt_pk_bf16_f32 v91, v106, v107
    v_mfma_f32_16x16x32_bf16 v[132:135], v[232:235], v[196:199], v[132:135]
    ds_read_b64_tr_b16 v[230:231], v13 offset:24576
    s_add_u32 s37, s61, 4096
    buffer_store_dwordx4 v[88:91], v11, s[28:31], s37 offen offset:1024 sc1
    v_cvt_pk_bf16_f32 v92, v92, v93
    v_mfma_f32_16x16x32_bf16 v[148:151], v[240:243], v[196:199], v[148:151]
    ds_read_b64_tr_b16 v[232:233], v14 offset:0
    v_cvt_pk_bf16_f32 v93, v94, v95
    v_mfma_f32_16x16x32_bf16 v[148:151], v[244:247], v[212:215], v[148:151]
    ds_read_b64_tr_b16 v[234:235], v14 offset:8192
    v_cvt_pk_bf16_f32 v94, v108, v109
    v_mfma_f32_16x16x32_bf16 v[144:147], v[244:247], v[208:211], v[144:147]
    ds_read_b64_tr_b16 v[236:237], v14 offset:16384
    v_cvt_pk_bf16_f32 v95, v110, v111
    s_add_u32 s37, s61, 12288
    buffer_store_dwordx4 v[92:95], v11, s[28:31], s37 offen offset:0 sc1
    v_mfma_f32_16x16x32_bf16 v[144:147], v[240:243], v[192:195], v[144:147]
    ds_read_b64_tr_b16 v[238:239], v14 offset:24576
    v_cvt_pk_bf16_f32 v100, v100, v101
    v_mfma_f32_16x16x32_bf16 v[140:143], v[240:243], v[188:191], v[140:143]
    v_cvt_pk_bf16_f32 v101, v102, v103
    v_mfma_f32_16x16x32_bf16 v[140:143], v[244:247], v[204:207], v[140:143]
    v_cvt_pk_bf16_f32 v102, v116, v117
    v_cvt_pk_bf16_f32 v103, v118, v119
    v_mfma_f32_16x16x32_bf16 v[136:139], v[244:247], v[200:203], v[136:139]
    s_add_u32 s37, s61, 28672
    buffer_store_dwordx4 v[100:103], v11, s[28:31], s37 offen offset:1024 sc1
    v_mfma_f32_16x16x32_bf16 v[136:139], v[240:243], v[184:187], v[136:139]
    buffer_load_dword v7, v10, s[28:31], s60 offen sc1
    s_waitcnt lgkmcnt(8)
    ds_read_b64_tr_b16 v[240:241], v15 offset:0
    s_add_u32 s48, s48, 1
    s_cmp_eq_u32 s48, 3
    s_cselect_b32 s49, s50, s51
    s_cselect_b32 s48, 0, s48
    ds_read_b64_tr_b16 v[242:243], v15 offset:8192
    v_mfma_f32_16x16x32_bf16 v[28:31], v[220:223], v[172:175], v[28:31]
    ds_read_b64_tr_b16 v[244:245], v15 offset:16384
    v_mfma_f32_16x16x32_bf16 v[28:31], v[216:219], v[156:159], v[28:31]
    ds_read_b64_tr_b16 v[246:247], v15 offset:24576
    v_add_u32 v15, s49, v15
    v_cvt_pk_bf16_f32 v120, v120, v121
    v_cvt_pk_bf16_f32 v121, v122, v123
    v_add_u32 v12, s49, v12
    v_cvt_pk_bf16_f32 v122, v136, v137
    v_cvt_pk_bf16_f32 v123, v138, v139
    v_add_u32 v13, s49, v13
    s_add_u32 s37, s61, 4096
    buffer_store_dwordx4 v[120:123], v11, s[28:31], s37 offen offset:2048 sc1
    v_cvt_pk_bf16_f32 v128, v128, v129
    v_cvt_pk_bf16_f32 v129, v130, v131
    v_cvt_pk_bf16_f32 v130, v144, v145
    s_waitcnt lgkmcnt(8)
    ds_read_b64_tr_b16 v[216:217], v16 offset:0
    v_cvt_pk_bf16_f32 v131, v146, v147
    s_add_u32 s37, s61, 20480
    buffer_store_dwordx4 v[128:131], v11, s[28:31], s37 offen offset:3072 sc1
    ds_read_b64_tr_b16 v[218:219], v16 offset:8192
    v_cvt_pk_bf16_f32 v132, v132, v133
    v_cvt_pk_bf16_f32 v133, v134, v135
    ds_read_b64_tr_b16 v[220:221], v16 offset:16384
    v_cvt_pk_bf16_f32 v134, v148, v149
    v_cvt_pk_bf16_f32 v135, v150, v151
    ds_read_b64_tr_b16 v[222:223], v16 offset:24576
    s_add_u32 s37, s61, 28672
    buffer_store_dwordx4 v[132:135], v11, s[28:31], s37 offen offset:2048 sc1
    v_mfma_f32_16x16x32_bf16 v[44:47], v[224:227], v[156:159], v[44:47]
    v_add_u32 v16, s49, v16
    v_mfma_f32_16x16x32_bf16 v[44:47], v[228:231], v[172:175], v[44:47]
    v_add_u32 v20, s49, v20
    v_add_u32 v21, s49, v21
    s_waitcnt lgkmcnt(8)
    v_mfma_f32_16x16x32_bf16 v[56:59], v[232:235], v[152:155], v[56:59]
    ds_read_b64_tr_b16 v[224:225], v17 offset:0
    v_mfma_f32_16x16x32_bf16 v[56:59], v[236:239], v[168:171], v[56:59]
    ds_read_b64_tr_b16 v[226:227], v17 offset:8192
    ds_read_b64_tr_b16 v[228:229], v17 offset:16384
    ds_read_b64_tr_b16 v[230:231], v17 offset:24576
    v_add_u32 v17, s49, v17
    v_add_u32 v14, s49, v14
    v_mfma_f32_16x16x32_bf16 v[68:71], v[236:239], v[180:183], v[68:71]
    v_mfma_f32_16x16x32_bf16 v[68:71], v[232:235], v[164:167], v[68:71]
    s_waitcnt lgkmcnt(8)
    v_mfma_f32_16x16x32_bf16 v[84:87], v[240:243], v[164:167], v[84:87]
    ds_read_b64_tr_b16 v[232:233], v18 offset:0
    v_mfma_f32_16x16x32_bf16 v[84:87], v[244:247], v[180:183], v[84:87]
    ds_read_b64_tr_b16 v[234:235], v18 offset:8192
    ds_read_b64_tr_b16 v[236:237], v18 offset:16384
    ds_read_b64_tr_b16 v[238:239], v18 offset:24576
    v_add_u32 v18, s49, v18
    v_mfma_f32_16x16x32_bf16 v[72:75], v[244:247], v[168:171], v[72:75]
    v_mfma_f32_16x16x32_bf16 v[72:75], v[240:243], v[152:155], v[72:75]
    s_waitcnt lgkmcnt(8)
    ds_read_b64_tr_b16 v[240:241], v19 offset:0
    ds_read_b64_tr_b16 v[242:243], v19 offset:8192
    ds_read_b64_tr_b16 v[244:245], v19 offset:16384
    ds_read_b64_tr_b16 v[246:247], v19 offset:24576
    v_mfma_f32_16x16x32_bf16 v[96:99], v[216:219], v[160:163], v[96:99]
    v_add_u32 v19, s49, v19
    v_mfma_f32_16x16x32_bf16 v[96:99], v[220:223], v[176:179], v[96:99]
    s_waitcnt lgkmcnt(0)
    s_barrier
    ds_read_b64_tr_b16 v[216:217], v12 offset:0
    ds_read_b64_tr_b16 v[218:219], v12 offset:8192
    v_mfma_f32_16x16x32_bf16 v[112:115], v[228:231], v[176:179], v[112:115]
    ds_read_b64_tr_b16 v[220:221], v12 offset:16384
    v_mfma_f32_16x16x32_bf16 v[112:115], v[224:227], v[160:163], v[112:115]
    ds_read_b64_tr_b16 v[222:223], v12 offset:24576
    ds_read_b128 v[184:187], v20 offset:0
    ds_read_b128 v[200:203], v21 offset:0
    ds_read_b128 v[204:207], v21 offset:2048
    ds_read_b128 v[188:191], v20 offset:2048
    ds_read_b128 v[192:195], v20 offset:4096
    ds_read_b128 v[208:211], v21 offset:4096
    v_mfma_f32_16x16x32_bf16 v[124:127], v[236:239], v[172:175], v[124:127]
    ds_read_b128 v[212:215], v21 offset:6144
    v_mfma_f32_16x16x32_bf16 v[124:127], v[232:235], v[156:159], v[124:127]
    ds_read_b128 v[196:199], v20 offset:6144
    ds_read_b64_tr_b16 v[224:225], v13 offset:0
    ds_read_b64_tr_b16 v[226:227], v13 offset:8192
    ds_read_b64_tr_b16 v[228:229], v13 offset:16384
    ds_read_b64_tr_b16 v[230:231], v13 offset:24576
    ds_read_b64_tr_b16 v[232:233], v14 offset:0
    ds_read_b64_tr_b16 v[234:235], v14 offset:8192
    ds_read_b64_tr_b16 v[236:237], v14 offset:16384
    ds_read_b64_tr_b16 v[238:239], v14 offset:24576
    v_mfma_f32_16x16x32_bf16 v[140:143], v[240:243], v[156:159], v[140:143]
    v_mfma_f32_16x16x32_bf16 v[140:143], v[244:247], v[172:175], v[140:143]
    s_waitcnt vmcnt(0)
    s_mov_b64 exec, 1
    buffer_store_dword v4, v5, s[28:31], s63 offen sc1
    s_mov_b64 exec, -1
    s_waitcnt lgkmcnt(8)
    ds_read_b64_tr_b16 v[240:241], v15 offset:0
    ds_read_b64_tr_b16 v[242:243], v15 offset:8192
    v_mfma_f32_16x16x32_bf16 v[28:31], v[220:223], v[204:207], v[28:31]
    ds_read_b64_tr_b16 v[244:245], v15 offset:16384
    v_mfma_f32_16x16x32_bf16 v[28:31], v[216:219], v[188:191], v[28:31]
    ds_read_b64_tr_b16 v[246:247], v15 offset:24576
    s_waitcnt lgkmcnt(8)
    ds_read_b64_tr_b16 v[216:217], v16 offset:0
    ds_read_b64_tr_b16 v[218:219], v16 offset:8192
    ds_read_b64_tr_b16 v[220:221], v16 offset:16384
    ds_read_b64_tr_b16 v[222:223], v16 offset:24576
    v_mfma_f32_16x16x32_bf16 v[44:47], v[224:227], v[188:191], v[44:47]
    v_mfma_f32_16x16x32_bf16 v[44:47], v[228:231], v[204:207], v[44:47]
    s_waitcnt lgkmcnt(8)
    v_mfma_f32_16x16x32_bf16 v[56:59], v[232:235], v[184:187], v[56:59]
    ds_read_b64_tr_b16 v[224:225], v17 offset:0
    v_mfma_f32_16x16x32_bf16 v[56:59], v[236:239], v[200:203], v[56:59]
    ds_read_b64_tr_b16 v[226:227], v17 offset:8192
    ds_read_b64_tr_b16 v[228:229], v17 offset:16384
    ds_read_b64_tr_b16 v[230:231], v17 offset:24576
    v_mfma_f32_16x16x32_bf16 v[68:71], v[236:239], v[212:215], v[68:71]
    v_mfma_f32_16x16x32_bf16 v[68:71], v[232:235], v[196:199], v[68:71]
    s_waitcnt lgkmcnt(8)
    v_mfma_f32_16x16x32_bf16 v[84:87], v[240:243], v[196:199], v[84:87]
    ds_read_b64_tr_b16 v[232:233], v18 offset:0
    v_mfma_f32_16x16x32_bf16 v[84:87], v[244:247], v[212:215], v[84:87]
    ds_read_b64_tr_b16 v[234:235], v18 offset:8192
    ds_read_b64_tr_b16 v[236:237], v18 offset:16384
    ds_read_b64_tr_b16 v[238:239], v18 offset:24576
    v_mfma_f32_16x16x32_bf16 v[72:75], v[244:247], v[200:203], v[72:75]
    v_mfma_f32_16x16x32_bf16 v[72:75], v[240:243], v[184:187], v[72:75]
    s_waitcnt lgkmcnt(8)
    ds_read_b64_tr_b16 v[240:241], v19 offset:0
    ds_read_b64_tr_b16 v[242:243], v19 offset:8192
    ds_read_b64_tr_b16 v[244:245], v19 offset:16384
    ds_read_b64_tr_b16 v[246:247], v19 offset:24576
    v_mfma_f32_16x16x32_bf16 v[96:99], v[216:219], v[192:195], v[96:99]
    v_mfma_f32_16x16x32_bf16 v[96:99], v[220:223], v[208:211], v[96:99]
    s_waitcnt lgkmcnt(0)
    v_mfma_f32_16x16x32_bf16 v[112:115], v[228:231], v[208:211], v[112:115]
    v_mfma_f32_16x16x32_bf16 v[112:115], v[224:227], v[192:195], v[112:115]
    v_mfma_f32_16x16x32_bf16 v[124:127], v[236:239], v[204:207], v[124:127]
    v_mfma_f32_16x16x32_bf16 v[124:127], v[232:235], v[188:191], v[124:127]
    v_mfma_f32_16x16x32_bf16 v[140:143], v[240:243], v[188:191], v[140:143]
    v_mfma_f32_16x16x32_bf16 v[140:143], v[244:247], v[204:207], v[140:143]
    s_waitcnt vmcnt(3)
    s_mov_b64 exec, 0x18
    v_cmp_ne_u32 vcc, s74, v7
    s_mov_b64 exec, -1
    s_mov_b64 s[66:67], vcc
    s_cmp_lg_u64 s[66:67], 0
    s_cbranch_scc1 L_g2_nx0
    s_add_u32 s38, s57, 0
    buffer_load_dwordx4 v[160:163], v11, s[28:31], s38 offen offset:1024 sc1
    s_add_u32 s38, s57, 32768
    buffer_load_dwordx4 v[172:175], v11, s[28:31], s38 offen offset:0 sc1
    s_add_u32 s38, s57, 32768
    buffer_load_dwordx4 v[184:187], v11, s[28:31], s38 offen offset:3072 sc1
    s_add_u32 s38, s57, 65536
    buffer_load_dwordx4 v[196:199], v11, s[28:31], s38 offen offset:2048 sc1
    s_add_u32 s38, s57, 98304
    buffer_load_dwordx4 v[208:211], v11, s[28:31], s38 offen offset:1024 sc1
L_g2_nx0:
    s_mov_b64 exec, 30
    s_mov_b32 s83, 0x20000
L_g2_tw0:
    buffer_load_dword v6, v3, s[28:31], 0 offen sc1
    s_waitcnt vmcnt(0)
L_g2_tw0_w:
    v_cmp_ne_u32 vcc, s74, v6
    s_nop 0
    s_mov_b64 s[80:81], vcc
    s_cmp_eq_u64 s[80:81], 0
    s_cbranch_scc1 L_g2_tw0_ok
    s_sleep 4
    s_sub_u32 s83, s83, 1
    s_cmp_lg_u32 s83, 0
    s_cbranch_scc1 L_g2_tw0
L_g2_tw0_ok:
    s_mov_b64 exec, -1
    s_cmp_eq_u64 s[66:67], 0
    s_cbranch_scc1 L_g2_hx0
    s_add_u32 s38, s57, 0
    buffer_load_dwordx4 v[160:163], v11, s[28:31], s38 offen offset:1024 sc1
    s_add_u32 s38, s57, 32768
    buffer_load_dwordx4 v[172:175], v11, s[28:31], s38 offen offset:0 sc1
    s_add_u32 s38, s57, 32768
    buffer_load_dwordx4 v[184:187], v11, s[28:31], s38 offen offset:3072 sc1
    s_add_u32 s38, s57, 65536
    buffer_load_dwordx4 v[196:199], v11, s[28:31], s38 offen offset:2048 sc1
    s_add_u32 s38, s57, 98304
    buffer_load_dwordx4 v[208:211], v11, s[28:31], s38 offen offset:1024 sc1
L_g2_hx0:
    s_add_u32 s37, s61, 0
    buffer_load_dwordx4 v[152:155], v11, s[28:31], s37 offen offset:2048 sc1
    buffer_load_dwordx4 v[156:159], v11, s[28:31], s37 offen offset:3072 sc1
    s_add_u32 s37, s61, 8192
    buffer_load_dwordx4 v[164:167], v11, s[28:31], s37 offen offset:0 sc1
    buffer_load_dwordx4 v[168:171], v11, s[28:31], s37 offen offset:1024 sc1
    s_add_u32 s37, s61, 12288
    buffer_load_dwordx4 v[176:179], v11, s[28:31], s37 offen offset:2048 sc1
    buffer_load_dwordx4 v[180:183], v11, s[28:31], s37 offen offset:3072 sc1
    s_add_u32 s37, s61, 20480
    buffer_load_dwordx4 v[188:191], v11, s[28:31], s37 offen offset:0 sc1
    buffer_load_dwordx4 v[192:195], v11, s[28:31], s37 offen offset:1024 sc1
    s_add_u32 s37, s61, 24576
    buffer_load_dwordx4 v[200:203], v11, s[28:31], s37 offen offset:2048 sc1
    buffer_load_dwordx4 v[204:207], v11, s[28:31], s37 offen offset:3072 sc1
    s_waitcnt vmcnt(10)
    v_lshlrev_b32 v248, 16, v160
    v_and_b32 v249, 0xffff0000, v160
    v_pk_fma_f32 v[56:57], v[56:57], s[64:65], v[248:249]
    v_lshlrev_b32 v250, 16, v161
    v_and_b32 v251, 0xffff0000, v161
    v_pk_fma_f32 v[58:59], v[58:59], s[64:65], v[250:251]
    v_lshlrev_b32 v248, 16, v162
    v_and_b32 v249, 0xffff0000, v162
    v_pk_fma_f32 v[72:73], v[72:73], s[64:65], v[248:249]
    v_lshlrev_b32 v250, 16, v163
    v_and_b32 v251, 0xffff0000, v163
    v_pk_fma_f32 v[74:75], v[74:75], s[64:65], v[250:251]
    v_lshlrev_b32 v248, 16, v172
    v_and_b32 v249, 0xffff0000, v172
    v_pk_fma_f32 v[28:29], v[28:29], s[64:65], v[248:249]
    v_lshlrev_b32 v250, 16, v173
    v_and_b32 v251, 0xffff0000, v173
    v_pk_fma_f32 v[30:31], v[30:31], s[64:65], v[250:251]
    v_lshlrev_b32 v248, 16, v174
    v_and_b32 v249, 0xffff0000, v174
    v_pk_fma_f32 v[44:45], v[44:45], s[64:65], v[248:249]
    v_lshlrev_b32 v250, 16, v175
    v_and_b32 v251, 0xffff0000, v175
    v_pk_fma_f32 v[46:47], v[46:47], s[64:65], v[250:251]
    v_lshlrev_b32 v248, 16, v184
    v_and_b32 v249, 0xffff0000, v184
    v_pk_fma_f32 v[124:125], v[124:125], s[64:65], v[248:249]
    v_lshlrev_b32 v250, 16, v185
    v_and_b32 v251, 0xffff0000, v185
    v_pk_fma_f32 v[126:127], v[126:127], s[64:65], v[250:251]
    v_lshlrev_b32 v248, 16, v186
    v_and_b32 v249, 0xffff0000, v186
    v_pk_fma_f32 v[140:141], v[140:141], s[64:65], v[248:249]
    v_lshlrev_b32 v250, 16, v187
    v_and_b32 v251, 0xffff0000, v187
    v_pk_fma_f32 v[142:143], v[142:143], s[64:65], v[250:251]
    v_lshlrev_b32 v248, 16, v196
    v_and_b32 v249, 0xffff0000, v196
    v_pk_fma_f32 v[96:97], v[96:97], s[64:65], v[248:249]
    v_lshlrev_b32 v250, 16, v197
    v_and_b32 v251, 0xffff0000, v197
    v_pk_fma_f32 v[98:99], v[98:99], s[64:65], v[250:251]
    v_lshlrev_b32 v248, 16, v198
    v_and_b32 v249, 0xffff0000, v198
    v_pk_fma_f32 v[112:113], v[112:113], s[64:65], v[248:249]
    v_lshlrev_b32 v250, 16, v199
    v_and_b32 v251, 0xffff0000, v199
    v_pk_fma_f32 v[114:115], v[114:115], s[64:65], v[250:251]
    v_lshlrev_b32 v248, 16, v208
    v_and_b32 v249, 0xffff0000, v208
    v_pk_fma_f32 v[68:69], v[68:69], s[64:65], v[248:249]
    v_lshlrev_b32 v250, 16, v209
    v_and_b32 v251, 0xffff0000, v209
    v_pk_fma_f32 v[70:71], v[70:71], s[64:65], v[250:251]
    v_lshlrev_b32 v248, 16, v210
    v_and_b32 v249, 0xffff0000, v210
    v_pk_fma_f32 v[84:85], v[84:85], s[64:65], v[248:249]
    v_lshlrev_b32 v250, 16, v211
    v_and_b32 v251, 0xffff0000, v211
    v_pk_fma_f32 v[86:87], v[86:87], s[64:65], v[250:251]
    s_waitcnt vmcnt(8)
    v_lshlrev_b32 v248, 16, v152
    v_and_b32 v249, 0xffff0000, v152
    v_lshlrev_b32 v250, 16, v156
    v_and_b32 v251, 0xffff0000, v156
    v_pk_add_f32 v[248:249], v[248:249], v[250:251]
    v_pk_fma_f32 v[56:57], v[248:249], s[64:65], v[56:57]
    v_cvt_pk_bf16_f32 v12, v56, v57
    v_lshlrev_b32 v252, 16, v153
    v_and_b32 v253, 0xffff0000, v153
    v_lshlrev_b32 v254, 16, v157
    v_and_b32 v255, 0xffff0000, v157
    v_pk_add_f32 v[252:253], v[252:253], v[254:255]
    v_pk_fma_f32 v[58:59], v[252:253], s[64:65], v[58:59]
    v_cvt_pk_bf16_f32 v13, v58, v59
    v_lshlrev_b32 v248, 16, v154
    v_and_b32 v249, 0xffff0000, v154
    v_lshlrev_b32 v250, 16, v158
    v_and_b32 v251, 0xffff0000, v158
    v_pk_add_f32 v[248:249], v[248:249], v[250:251]
    v_pk_fma_f32 v[72:73], v[248:249], s[64:65], v[72:73]
    v_cvt_pk_bf16_f32 v14, v72, v73
    v_lshlrev_b32 v252, 16, v155
    v_and_b32 v253, 0xffff0000, v155
    v_lshlrev_b32 v254, 16, v159
    v_and_b32 v255, 0xffff0000, v159
    v_pk_add_f32 v[252:253], v[252:253], v[254:255]
    v_pk_fma_f32 v[74:75], v[252:253], s[64:65], v[74:75]
    v_cvt_pk_bf16_f32 v15, v74, v75
    v_permlane16_swap_b32 v12, v14
    s_nop 0
    v_permlane16_swap_b32 v13, v15
    s_add_u32 s37, s56, 0
    buffer_store_dwordx4 v[12:15], v9, s[24:27], s37 offen offset:64 nt
    s_waitcnt vmcnt(7)
    v_lshlrev_b32 v248, 16, v164
    v_and_b32 v249, 0xffff0000, v164
    v_lshlrev_b32 v250, 16, v168
    v_and_b32 v251, 0xffff0000, v168
    v_pk_add_f32 v[248:249], v[248:249], v[250:251]
    v_pk_fma_f32 v[28:29], v[248:249], s[64:65], v[28:29]
    v_cvt_pk_bf16_f32 v16, v28, v29
    v_lshlrev_b32 v252, 16, v165
    v_and_b32 v253, 0xffff0000, v165
    v_lshlrev_b32 v254, 16, v169
    v_and_b32 v255, 0xffff0000, v169
    v_pk_add_f32 v[252:253], v[252:253], v[254:255]
    v_pk_fma_f32 v[30:31], v[252:253], s[64:65], v[30:31]
    v_cvt_pk_bf16_f32 v17, v30, v31
    v_lshlrev_b32 v248, 16, v166
    v_and_b32 v249, 0xffff0000, v166
    v_lshlrev_b32 v250, 16, v170
    v_and_b32 v251, 0xffff0000, v170
    v_pk_add_f32 v[248:249], v[248:249], v[250:251]
    v_pk_fma_f32 v[44:45], v[248:249], s[64:65], v[44:45]
    v_cvt_pk_bf16_f32 v18, v44, v45
    v_lshlrev_b32 v252, 16, v167
    v_and_b32 v253, 0xffff0000, v167
    v_lshlrev_b32 v254, 16, v171
    v_and_b32 v255, 0xffff0000, v171
    v_pk_add_f32 v[252:253], v[252:253], v[254:255]
    v_pk_fma_f32 v[46:47], v[252:253], s[64:65], v[46:47]
    v_cvt_pk_bf16_f32 v19, v46, v47
    v_permlane16_swap_b32 v16, v18
    s_nop 0
    v_permlane16_swap_b32 v17, v19
    s_add_u32 s37, s56, 32768
    buffer_store_dwordx4 v[16:19], v9, s[24:27], s37 offen offset:0 nt
    s_waitcnt vmcnt(6)
    v_lshlrev_b32 v248, 16, v176
    v_and_b32 v249, 0xffff0000, v176
    v_lshlrev_b32 v250, 16, v180
    v_and_b32 v251, 0xffff0000, v180
    v_pk_add_f32 v[248:249], v[248:249], v[250:251]
    v_pk_fma_f32 v[124:125], v[248:249], s[64:65], v[124:125]
    v_cvt_pk_bf16_f32 v12, v124, v125
    v_lshlrev_b32 v252, 16, v177
    v_and_b32 v253, 0xffff0000, v177
    v_lshlrev_b32 v254, 16, v181
    v_and_b32 v255, 0xffff0000, v181
    v_pk_add_f32 v[252:253], v[252:253], v[254:255]
    v_pk_fma_f32 v[126:127], v[252:253], s[64:65], v[126:127]
    v_cvt_pk_bf16_f32 v13, v126, v127
    v_lshlrev_b32 v248, 16, v178
    v_and_b32 v249, 0xffff0000, v178
    v_lshlrev_b32 v250, 16, v182
    v_and_b32 v251, 0xffff0000, v182
    v_pk_add_f32 v[248:249], v[248:249], v[250:251]
    v_pk_fma_f32 v[140:141], v[248:249], s[64:65], v[140:141]
    v_cvt_pk_bf16_f32 v14, v140, v141
    v_lshlrev_b32 v252, 16, v179
    v_and_b32 v253, 0xffff0000, v179
    v_lshlrev_b32 v254, 16, v183
    v_and_b32 v255, 0xffff0000, v183
    v_pk_add_f32 v[252:253], v[252:253], v[254:255]
    v_pk_fma_f32 v[142:143], v[252:253], s[64:65], v[142:143]
    v_cvt_pk_bf16_f32 v15, v142, v143
    v_permlane16_swap_b32 v12, v14
    s_nop 0
    v_permlane16_swap_b32 v13, v15
    s_add_u32 s37, s56, 32768
    buffer_store_dwordx4 v[12:15], v9, s[24:27], s37 offen offset:192 nt
    s_waitcnt vmcnt(5)
    v_lshlrev_b32 v248, 16, v188
    v_and_b32 v249, 0xffff0000, v188
    v_lshlrev_b32 v250, 16, v192
    v_and_b32 v251, 0xffff0000, v192
    v_pk_add_f32 v[248:249], v[248:249], v[250:251]
    v_pk_fma_f32 v[96:97], v[248:249], s[64:65], v[96:97]
    v_cvt_pk_bf16_f32 v16, v96, v97
    v_lshlrev_b32 v252, 16, v189
    v_and_b32 v253, 0xffff0000, v189
    v_lshlrev_b32 v254, 16, v193
    v_and_b32 v255, 0xffff0000, v193
    v_pk_add_f32 v[252:253], v[252:253], v[254:255]
    v_pk_fma_f32 v[98:99], v[252:253], s[64:65], v[98:99]
    v_cvt_pk_bf16_f32 v17, v98, v99
    v_lshlrev_b32 v248, 16, v190
    v_and_b32 v249, 0xffff0000, v190
    v_lshlrev_b32 v250, 16, v194
    v_and_b32 v251, 0xffff0000, v194
    v_pk_add_f32 v[248:249], v[248:249], v[250:251]
    v_pk_fma_f32 v[112:113], v[248:249], s[64:65], v[112:113]
    v_cvt_pk_bf16_f32 v18, v112, v113
    v_lshlrev_b32 v252, 16, v191
    v_and_b32 v253, 0xffff0000, v191
    v_lshlrev_b32 v254, 16, v195
    v_and_b32 v255, 0xffff0000, v195
    v_pk_add_f32 v[252:253], v[252:253], v[254:255]
    v_pk_fma_f32 v[114:115], v[252:253], s[64:65], v[114:115]
    v_cvt_pk_bf16_f32 v19, v114, v115
    v_permlane16_swap_b32 v16, v18
    s_nop 0
    v_permlane16_swap_b32 v17, v19
    s_add_u32 s37, s56, 65536
    buffer_store_dwordx4 v[16:19], v9, s[24:27], s37 offen offset:128 nt
    s_waitcnt vmcnt(4)
    v_lshlrev_b32 v248, 16, v200
    v_and_b32 v249, 0xffff0000, v200
    v_lshlrev_b32 v250, 16, v204
    v_and_b32 v251, 0xffff0000, v204
    v_pk_add_f32 v[248:249], v[248:249], v[250:251]
    v_pk_fma_f32 v[68:69], v[248:249], s[64:65], v[68:69]
    v_cvt_pk_bf16_f32 v12, v68, v69
    v_lshlrev_b32 v252, 16, v201
    v_and_b32 v253, 0xffff0000, v201
    v_lshlrev_b32 v254, 16, v205
    v_and_b32 v255, 0xffff0000, v205
    v_pk_add_f32 v[252:253], v[252:253], v[254:255]
    v_pk_fma_f32 v[70:71], v[252:253], s[64:65], v[70:71]
    v_cvt_pk_bf16_f32 v13, v70, v71
    v_lshlrev_b32 v248, 16, v202
    v_and_b32 v249, 0xffff0000, v202
    v_lshlrev_b32 v250, 16, v206
    v_and_b32 v251, 0xffff0000, v206
    v_pk_add_f32 v[248:249], v[248:249], v[250:251]
    v_pk_fma_f32 v[84:85], v[248:249], s[64:65], v[84:85]
    v_cvt_pk_bf16_f32 v14, v84, v85
    v_lshlrev_b32 v252, 16, v203
    v_and_b32 v253, 0xffff0000, v203
    v_lshlrev_b32 v254, 16, v207
    v_and_b32 v255, 0xffff0000, v207
    v_pk_add_f32 v[252:253], v[252:253], v[254:255]
    v_pk_fma_f32 v[86:87], v[252:253], s[64:65], v[86:87]
    v_cvt_pk_bf16_f32 v15, v86, v87
    v_permlane16_swap_b32 v12, v14
    s_nop 0
    v_permlane16_swap_b32 v13, v15
    s_add_u32 s37, s56, 98304
    buffer_store_dwordx4 v[12:15], v9, s[24:27], s37 offen offset:64 nt
    s_branch L_g2_fin
L_g2_k1:
    s_cmp_lg_u32 s17, 1
    s_cbranch_scc1 L_g2_k2
    s_waitcnt lgkmcnt(8)
    v_mfma_f32_16x16x32_bf16 v[24:27], v[216:219], v[184:187], v[24:27]
    ds_read_b64_tr_b16 v[240:241], v15 offset:0
    s_add_u32 s48, s48, 1
    s_cmp_eq_u32 s48, 3
    s_cselect_b32 s49, s50, s51
    s_cselect_b32 s48, 0, s48
    v_mfma_f32_16x16x32_bf16 v[24:27], v[220:223], v[200:203], v[24:27]
    ds_read_b64_tr_b16 v[242:243], v15 offset:8192
    v_mfma_f32_16x16x32_bf16 v[28:31], v[220:223], v[204:207], v[28:31]
    ds_read_b64_tr_b16 v[244:245], v15 offset:16384
    v_mfma_f32_16x16x32_bf16 v[28:31], v[216:219], v[188:191], v[28:31]
    ds_read_b64_tr_b16 v[246:247], v15 offset:24576
    v_mfma_f32_16x16x32_bf16 v[32:35], v[216:219], v[192:195], v[32:35]
    v_add_u32 v15, s49, v15
    v_mfma_f32_16x16x32_bf16 v[32:35], v[220:223], v[208:211], v[32:35]
    v_add_u32 v12, s49, v12
    v_mfma_f32_16x16x32_bf16 v[36:39], v[220:223], v[212:215], v[36:39]
    v_add_u32 v13, s49, v13
    v_mfma_f32_16x16x32_bf16 v[36:39], v[216:219], v[196:199], v[36:39]
    s_waitcnt lgkmcnt(8)
    v_mfma_f32_16x16x32_bf16 v[52:55], v[224:227], v[196:199], v[52:55]
    ds_read_b64_tr_b16 v[216:217], v16 offset:0
    v_mfma_f32_16x16x32_bf16 v[52:55], v[228:231], v[212:215], v[52:55]
    ds_read_b64_tr_b16 v[218:219], v16 offset:8192
    v_mfma_f32_16x16x32_bf16 v[48:51], v[228:231], v[208:211], v[48:51]
    ds_read_b64_tr_b16 v[220:221], v16 offset:16384
    v_mfma_f32_16x16x32_bf16 v[48:51], v[224:227], v[192:195], v[48:51]
    ds_read_b64_tr_b16 v[222:223], v16 offset:24576
    v_mfma_f32_16x16x32_bf16 v[44:47], v[224:227], v[188:191], v[44:47]
    v_add_u32 v16, s49, v16
    v_mfma_f32_16x16x32_bf16 v[44:47], v[228:231], v[204:207], v[44:47]
    v_add_u32 v20, s49, v20
    v_mfma_f32_16x16x32_bf16 v[40:43], v[228:231], v[200:203], v[40:43]
    v_add_u32 v21, s49, v21
    v_mfma_f32_16x16x32_bf16 v[40:43], v[224:227], v[184:187], v[40:43]
    s_waitcnt lgkmcnt(8)
    v_mfma_f32_16x16x32_bf16 v[56:59], v[232:235], v[184:187], v[56:59]
    ds_read_b64_tr_b16 v[224:225], v17 offset:0
    v_mfma_f32_16x16x32_bf16 v[56:59], v[236:239], v[200:203], v[56:59]
    ds_read_b64_tr_b16 v[226:227], v17 offset:8192
    v_mfma_f32_16x16x32_bf16 v[60:63], v[236:239], v[204:207], v[60:63]
    ds_read_b64_tr_b16 v[228:229], v17 offset:16384
    v_mfma_f32_16x16x32_bf16 v[60:63], v[232:235], v[188:191], v[60:63]
    ds_read_b64_tr_b16 v[230:231], v17 offset:24576
    v_mfma_f32_16x16x32_bf16 v[64:67], v[232:235], v[192:195], v[64:67]
    v_add_u32 v17, s49, v17
    v_cvt_pk_bf16_f32 v24, v24, v25
    v_cvt_pk_bf16_f32 v25, v26, v27
    v_mfma_f32_16x16x32_bf16 v[64:67], v[236:239], v[208:211], v[64:67]
    v_add_u32 v14, s49, v14
    v_cvt_pk_bf16_f32 v26, v40, v41
    v_mfma_f32_16x16x32_bf16 v[68:71], v[236:239], v[212:215], v[68:71]
    v_cvt_pk_bf16_f32 v27, v42, v43
    v_mfma_f32_16x16x32_bf16 v[68:71], v[232:235], v[196:199], v[68:71]
    s_add_u32 s37, s61, 0
    buffer_store_dwordx4 v[24:27], v11, s[28:31], s37 offen offset:1024 sc1
    v_cvt_pk_bf16_f32 v28, v28, v29
    s_waitcnt lgkmcnt(8)
    v_mfma_f32_16x16x32_bf16 v[84:87], v[240:243], v[196:199], v[84:87]
    ds_read_b64_tr_b16 v[232:233], v18 offset:0
    v_cvt_pk_bf16_f32 v29, v30, v31
    v_mfma_f32_16x16x32_bf16 v[84:87], v[244:247], v[212:215], v[84:87]
    ds_read_b64_tr_b16 v[234:235], v18 offset:8192
    v_cvt_pk_bf16_f32 v30, v44, v45
    v_mfma_f32_16x16x32_bf16 v[80:83], v[244:247], v[208:211], v[80:83]
    ds_read_b64_tr_b16 v[236:237], v18 offset:16384
    v_cvt_pk_bf16_f32 v31, v46, v47
    s_add_u32 s37, s61, 8192
    buffer_store_dwordx4 v[28:31], v11, s[28:31], s37 offen offset:0 sc1
    v_mfma_f32_16x16x32_bf16 v[80:83], v[240:243], v[192:195], v[80:83]
    ds_read_b64_tr_b16 v[238:239], v18 offset:24576
    v_cvt_pk_bf16_f32 v36, v36, v37
    v_mfma_f32_16x16x32_bf16 v[76:79], v[240:243], v[188:191], v[76:79]
    v_add_u32 v18, s49, v18
    v_cvt_pk_bf16_f32 v37, v38, v39
    v_mfma_f32_16x16x32_bf16 v[76:79], v[244:247], v[204:207], v[76:79]
    v_cvt_pk_bf16_f32 v38, v52, v53
    v_cvt_pk_bf16_f32 v39, v54, v55
    v_mfma_f32_16x16x32_bf16 v[72:75], v[244:247], v[200:203], v[72:75]
    s_add_u32 s37, s61, 24576
    buffer_store_dwordx4 v[36:39], v11, s[28:31], s37 offen offset:1024 sc1
    v_mfma_f32_16x16x32_bf16 v[72:75], v[240:243], v[184:187], v[72:75]
    s_waitcnt lgkmcnt(8)
    v_mfma_f32_16x16x32_bf16 v[88:91], v[216:219], v[184:187], v[88:91]
    ds_read_b64_tr_b16 v[240:241], v19 offset:0
    v_mfma_f32_16x16x32_bf16 v[88:91], v[220:223], v[200:203], v[88:91]
    ds_read_b64_tr_b16 v[242:243], v19 offset:8192
    v_mfma_f32_16x16x32_bf16 v[92:95], v[220:223], v[204:207], v[92:95]
    ds_read_b64_tr_b16 v[244:245], v19 offset:16384
    v_mfma_f32_16x16x32_bf16 v[92:95], v[216:219], v[188:191], v[92:95]
    ds_read_b64_tr_b16 v[246:247], v19 offset:24576
    v_mfma_f32_16x16x32_bf16 v[96:99], v[216:219], v[192:195], v[96:99]
    v_add_u32 v19, s49, v19
    v_cvt_pk_bf16_f32 v56, v56, v57
    v_cvt_pk_bf16_f32 v57, v58, v59
    v_mfma_f32_16x16x32_bf16 v[96:99], v[220:223], v[208:211], v[96:99]
    v_cvt_pk_bf16_f32 v58, v72, v73
    v_mfma_f32_16x16x32_bf16 v[100:103], v[220:223], v[212:215], v[100:103]
    v_cvt_pk_bf16_f32 v59, v74, v75
    v_mfma_f32_16x16x32_bf16 v[100:103], v[216:219], v[196:199], v[100:103]
    s_add_u32 s37, s61, 0
    buffer_store_dwordx4 v[56:59], v11, s[28:31], s37 offen offset:2048 sc1
    v_cvt_pk_bf16_f32 v64, v64, v65
    s_waitcnt lgkmcnt(0)
    s_barrier
    v_mfma_f32_16x16x32_bf16 v[116:119], v[224:227], v[196:199], v[116:119]
    ds_read_b64_tr_b16 v[216:217], v12 offset:0
    v_cvt_pk_bf16_f32 v65, v66, v67
    v_mfma_f32_16x16x32_bf16 v[116:119], v[228:231], v[212:215], v[116:119]
    ds_read_b64_tr_b16 v[218:219], v12 offset:8192
    v_cvt_pk_bf16_f32 v66, v80, v81
    v_mfma_f32_16x16x32_bf16 v[112:115], v[228:231], v[208:211], v[112:115]
    ds_read_b64_tr_b16 v[220:221], v12 offset:16384
    v_cvt_pk_bf16_f32 v67, v82, v83
    s_add_u32 s37, s61, 16384
    buffer_store_dwordx4 v[64:67], v11, s[28:31], s37 offen offset:3072 sc1
    v_mfma_f32_16x16x32_bf16 v[112:115], v[224:227], v[192:195], v[112:115]
    ds_read_b64_tr_b16 v[222:223], v12 offset:24576
    v_cvt_pk_bf16_f32 v68, v68, v69
    v_mfma_f32_16x16x32_bf16 v[108:111], v[224:227], v[188:191], v[108:111]
    ds_read_b128 v[152:155], v20 offset:0
    v_cvt_pk_bf16_f32 v69, v70, v71
    v_mfma_f32_16x16x32_bf16 v[108:111], v[228:231], v[204:207], v[108:111]
    ds_read_b128 v[168:171], v21 offset:0
    v_cvt_pk_bf16_f32 v70, v84, v85
    v_cvt_pk_bf16_f32 v71, v86, v87
    v_mfma_f32_16x16x32_bf16 v[104:107], v[228:231], v[200:203], v[104:107]
    ds_read_b128 v[172:175], v21 offset:2048
    s_add_u32 s37, s61, 24576
    buffer_store_dwordx4 v[68:71], v11, s[28:31], s37 offen offset:2048 sc1
    v_mfma_f32_16x16x32_bf16 v[104:107], v[224:227], v[184:187], v[104:107]
    ds_read_b128 v[156:159], v20 offset:2048
    v_mfma_f32_16x16x32_bf16 v[120:123], v[232:235], v[184:187], v[120:123]
    ds_read_b128 v[160:163], v20 offset:4096
    v_mfma_f32_16x16x32_bf16 v[120:123], v[236:239], v[200:203], v[120:123]
    ds_read_b128 v[176:179], v21 offset:4096
    v_mfma_f32_16x16x32_bf16 v[124:127], v[236:239], v[204:207], v[124:127]
    ds_read_b128 v[180:183], v21 offset:6144
    v_mfma_f32_16x16x32_bf16 v[124:127], v[232:235], v[188:191], v[124:127]
    ds_read_b128 v[164:167], v20 offset:6144
    v_mfma_f32_16x16x32_bf16 v[128:131], v[232:235], v[192:195], v[128:131]
    ds_read_b64_tr_b16 v[224:225], v13 offset:0
    v_cvt_pk_bf16_f32 v92, v92, v93
    v_cvt_pk_bf16_f32 v93, v94, v95
    v_mfma_f32_16x16x32_bf16 v[128:131], v[236:239], v[208:211], v[128:131]
    ds_read_b64_tr_b16 v[226:227], v13 offset:8192
    v_cvt_pk_bf16_f32 v94, v108, v109
    v_mfma_f32_16x16x32_bf16 v[132:135], v[236:239], v[212:215], v[132:135]
    ds_read_b64_tr_b16 v[228:229], v13 offset:16384
    v_cvt_pk_bf16_f32 v95, v110, v111
    v_mfma_f32_16x16x32_bf16 v[132:135], v[232:235], v[196:199], v[132:135]
    ds_read_b64_tr_b16 v[230:231], v13 offset:24576
    s_add_u32 s37, s61, 12288
    buffer_store_dwordx4 v[92:95], v11, s[28:31], s37 offen offset:1024 sc1
    v_cvt_pk_bf16_f32 v96, v96, v97
    v_mfma_f32_16x16x32_bf16 v[148:151], v[240:243], v[196:199], v[148:151]
    ds_read_b64_tr_b16 v[232:233], v14 offset:0
    v_cvt_pk_bf16_f32 v97, v98, v99
    v_mfma_f32_16x16x32_bf16 v[148:151], v[244:247], v[212:215], v[148:151]
    ds_read_b64_tr_b16 v[234:235], v14 offset:8192
    v_cvt_pk_bf16_f32 v98, v112, v113
    v_mfma_f32_16x16x32_bf16 v[144:147], v[244:247], v[208:211], v[144:147]
    ds_read_b64_tr_b16 v[236:237], v14 offset:16384
    v_cvt_pk_bf16_f32 v99, v114, v115
    s_add_u32 s37, s61, 20480
    buffer_store_dwordx4 v[96:99], v11, s[28:31], s37 offen offset:0 sc1
    v_mfma_f32_16x16x32_bf16 v[144:147], v[240:243], v[192:195], v[144:147]
    ds_read_b64_tr_b16 v[238:239], v14 offset:24576
    v_mfma_f32_16x16x32_bf16 v[140:143], v[240:243], v[188:191], v[140:143]
    v_mfma_f32_16x16x32_bf16 v[140:143], v[244:247], v[204:207], v[140:143]
    v_mfma_f32_16x16x32_bf16 v[136:139], v[244:247], v[200:203], v[136:139]
    v_mfma_f32_16x16x32_bf16 v[136:139], v[240:243], v[184:187], v[136:139]
    buffer_load_dword v7, v10, s[28:31], s60 offen sc1
    s_waitcnt lgkmcnt(8)
    ds_read_b64_tr_b16 v[240:241], v15 offset:0
    s_add_u32 s48, s48, 1
    s_cmp_eq_u32 s48, 3
    s_cselect_b32 s49, s50, s51
    s_cselect_b32 s48, 0, s48
    ds_read_b64_tr_b16 v[242:243], v15 offset:8192
    ds_read_b64_tr_b16 v[244:245], v15 offset:16384
    ds_read_b64_tr_b16 v[246:247], v15 offset:24576
    v_mfma_f32_16x16x32_bf16 v[32:35], v[216:219], v[160:163], v[32:35]
    v_add_u32 v15, s49, v15
    v_cvt_pk_bf16_f32 v120, v120, v121
    v_cvt_pk_bf16_f32 v121, v122, v123
    v_mfma_f32_16x16x32_bf16 v[32:35], v[220:223], v[176:179], v[32:35]
    v_add_u32 v12, s49, v12
    v_cvt_pk_bf16_f32 v122, v136, v137
    v_cvt_pk_bf16_f32 v123, v138, v139
    v_add_u32 v13, s49, v13
    s_add_u32 s37, s61, 4096
    buffer_store_dwordx4 v[120:123], v11, s[28:31], s37 offen offset:3072 sc1
    v_cvt_pk_bf16_f32 v124, v124, v125
    v_cvt_pk_bf16_f32 v125, v126, v127
    v_cvt_pk_bf16_f32 v126, v140, v141
    s_waitcnt lgkmcnt(8)
    ds_read_b64_tr_b16 v[216:217], v16 offset:0
    v_cvt_pk_bf16_f32 v127, v142, v143
    s_add_u32 s37, s61, 12288
    buffer_store_dwordx4 v[124:127], v11, s[28:31], s37 offen offset:2048 sc1
    ds_read_b64_tr_b16 v[218:219], v16 offset:8192
    v_cvt_pk_bf16_f32 v132, v132, v133
    v_cvt_pk_bf16_f32 v133, v134, v135
    v_mfma_f32_16x16x32_bf16 v[48:51], v[228:231], v[176:179], v[48:51]
    ds_read_b64_tr_b16 v[220:221], v16 offset:16384
    v_cvt_pk_bf16_f32 v134, v148, v149
    v_cvt_pk_bf16_f32 v135, v150, v151
    v_mfma_f32_16x16x32_bf16 v[48:51], v[224:227], v[160:163], v[48:51]
    ds_read_b64_tr_b16 v[222:223], v16 offset:24576
    s_add_u32 s37, s61, 28672
    buffer_store_dwordx4 v[132:135], v11, s[28:31], s37 offen offset:3072 sc1
    v_add_u32 v16, s49, v16
    v_add_u32 v20, s49, v20
    v_add_u32 v21, s49, v21
    s_waitcnt lgkmcnt(8)
    ds_read_b64_tr_b16 v[224:225], v17 offset:0
    ds_read_b64_tr_b16 v[226:227], v17 offset:8192
    v_mfma_f32_16x16x32_bf16 v[60:63], v[236:239], v[172:175], v[60:63]
    ds_read_b64_tr_b16 v[228:229], v17 offset:16384
    v_mfma_f32_16x16x32_bf16 v[60:63], v[232:235], v[156:159], v[60:63]
    ds_read_b64_tr_b16 v[230:231], v17 offset:24576
    v_add_u32 v17, s49, v17
    v_add_u32 v14, s49, v14
    s_waitcnt lgkmcnt(8)
    ds_read_b64_tr_b16 v[232:233], v18 offset:0
    ds_read_b64_tr_b16 v[234:235], v18 offset:8192
    ds_read_b64_tr_b16 v[236:237], v18 offset:16384
    ds_read_b64_tr_b16 v[238:239], v18 offset:24576
    v_mfma_f32_16x16x32_bf16 v[76:79], v[240:243], v[156:159], v[76:79]
    v_add_u32 v18, s49, v18
    v_mfma_f32_16x16x32_bf16 v[76:79], v[244:247], v[172:175], v[76:79]
    s_waitcnt lgkmcnt(8)
    v_mfma_f32_16x16x32_bf16 v[88:91], v[216:219], v[152:155], v[88:91]
    ds_read_b64_tr_b16 v[240:241], v19 offset:0
    v_mfma_f32_16x16x32_bf16 v[88:91], v[220:223], v[168:171], v[88:91]
    ds_read_b64_tr_b16 v[242:243], v19 offset:8192
    ds_read_b64_tr_b16 v[244:245], v19 offset:16384
    ds_read_b64_tr_b16 v[246:247], v19 offset:24576
    v_add_u32 v19, s49, v19
    v_mfma_f32_16x16x32_bf16 v[100:103], v[220:223], v[180:183], v[100:103]
    v_mfma_f32_16x16x32_bf16 v[100:103], v[216:219], v[164:167], v[100:103]
    s_waitcnt lgkmcnt(0)
    s_barrier
    v_mfma_f32_16x16x32_bf16 v[116:119], v[224:227], v[164:167], v[116:119]
    ds_read_b64_tr_b16 v[216:217], v12 offset:0
    v_mfma_f32_16x16x32_bf16 v[116:119], v[228:231], v[180:183], v[116:119]
    ds_read_b64_tr_b16 v[218:219], v12 offset:8192
    ds_read_b64_tr_b16 v[220:221], v12 offset:16384
    ds_read_b64_tr_b16 v[222:223], v12 offset:24576
    ds_read_b128 v[184:187], v20 offset:0
    ds_read_b128 v[200:203], v21 offset:0
    v_mfma_f32_16x16x32_bf16 v[104:107], v[228:231], v[168:171], v[104:107]
    ds_read_b128 v[204:207], v21 offset:2048
    v_mfma_f32_16x16x32_bf16 v[104:107], v[224:227], v[152:155], v[104:107]
    ds_read_b128 v[188:191], v20 offset:2048
    ds_read_b128 v[192:195], v20 offset:4096
    ds_read_b128 v[208:211], v21 offset:4096
    ds_read_b128 v[212:215], v21 offset:6144
    ds_read_b128 v[196:199], v20 offset:6144
    v_mfma_f32_16x16x32_bf16 v[128:131], v[232:235], v[160:163], v[128:131]
    ds_read_b64_tr_b16 v[224:225], v13 offset:0
    v_mfma_f32_16x16x32_bf16 v[128:131], v[236:239], v[176:179], v[128:131]
    ds_read_b64_tr_b16 v[226:227], v13 offset:8192
    ds_read_b64_tr_b16 v[228:229], v13 offset:16384
    ds_read_b64_tr_b16 v[230:231], v13 offset:24576
    ds_read_b64_tr_b16 v[232:233], v14 offset:0
    ds_read_b64_tr_b16 v[234:235], v14 offset:8192
    v_mfma_f32_16x16x32_bf16 v[144:147], v[244:247], v[176:179], v[144:147]
    ds_read_b64_tr_b16 v[236:237], v14 offset:16384
    v_mfma_f32_16x16x32_bf16 v[144:147], v[240:243], v[160:163], v[144:147]
    ds_read_b64_tr_b16 v[238:239], v14 offset:24576
    s_waitcnt vmcnt(0)
    s_mov_b64 exec, 1
    buffer_store_dword v4, v5, s[28:31], s63 offen sc1
    s_mov_b64 exec, -1
    s_waitcnt lgkmcnt(8)
    ds_read_b64_tr_b16 v[240:241], v15 offset:0
    ds_read_b64_tr_b16 v[242:243], v15 offset:8192
    ds_read_b64_tr_b16 v[244:245], v15 offset:16384
    ds_read_b64_tr_b16 v[246:247], v15 offset:24576
    v_mfma_f32_16x16x32_bf16 v[32:35], v[216:219], v[192:195], v[32:35]
    v_mfma_f32_16x16x32_bf16 v[32:35], v[220:223], v[208:211], v[32:35]
    s_waitcnt lgkmcnt(8)
    ds_read_b64_tr_b16 v[216:217], v16 offset:0
    ds_read_b64_tr_b16 v[218:219], v16 offset:8192
    v_mfma_f32_16x16x32_bf16 v[48:51], v[228:231], v[208:211], v[48:51]
    ds_read_b64_tr_b16 v[220:221], v16 offset:16384
    v_mfma_f32_16x16x32_bf16 v[48:51], v[224:227], v[192:195], v[48:51]
    ds_read_b64_tr_b16 v[222:223], v16 offset:24576
    s_waitcnt lgkmcnt(8)
    ds_read_b64_tr_b16 v[224:225], v17 offset:0
    ds_read_b64_tr_b16 v[226:227], v17 offset:8192
    v_mfma_f32_16x16x32_bf16 v[60:63], v[236:239], v[204:207], v[60:63]
    ds_read_b64_tr_b16 v[228:229], v17 offset:16384
    v_mfma_f32_16x16x32_bf16 v[60:63], v[232:235], v[188:191], v[60:63]
    ds_read_b64_tr_b16 v[230:231], v17 offset:24576
    s_waitcnt lgkmcnt(8)
    ds_read_b64_tr_b16 v[232:233], v18 offset:0
    ds_read_b64_tr_b16 v[234:235], v18 offset:8192
    ds_read_b64_tr_b16 v[236:237], v18 offset:16384
    ds_read_b64_tr_b16 v[238:239], v18 offset:24576
    v_mfma_f32_16x16x32_bf16 v[76:79], v[240:243], v[188:191], v[76:79]
    v_mfma_f32_16x16x32_bf16 v[76:79], v[244:247], v[204:207], v[76:79]
    s_waitcnt lgkmcnt(8)
    v_mfma_f32_16x16x32_bf16 v[88:91], v[216:219], v[184:187], v[88:91]
    ds_read_b64_tr_b16 v[240:241], v19 offset:0
    v_mfma_f32_16x16x32_bf16 v[88:91], v[220:223], v[200:203], v[88:91]
    ds_read_b64_tr_b16 v[242:243], v19 offset:8192
    ds_read_b64_tr_b16 v[244:245], v19 offset:16384
    ds_read_b64_tr_b16 v[246:247], v19 offset:24576
    v_mfma_f32_16x16x32_bf16 v[100:103], v[220:223], v[212:215], v[100:103]
    v_mfma_f32_16x16x32_bf16 v[100:103], v[216:219], v[196:199], v[100:103]
    s_waitcnt lgkmcnt(0)
    v_mfma_f32_16x16x32_bf16 v[116:119], v[224:227], v[196:199], v[116:119]
    v_mfma_f32_16x16x32_bf16 v[116:119], v[228:231], v[212:215], v[116:119]
    v_mfma_f32_16x16x32_bf16 v[104:107], v[228:231], v[200:203], v[104:107]
    v_mfma_f32_16x16x32_bf16 v[104:107], v[224:227], v[184:187], v[104:107]
    v_mfma_f32_16x16x32_bf16 v[128:131], v[232:235], v[192:195], v[128:131]
    v_mfma_f32_16x16x32_bf16 v[128:131], v[236:239], v[208:211], v[128:131]
    v_mfma_f32_16x16x32_bf16 v[144:147], v[244:247], v[208:211], v[144:147]
    v_mfma_f32_16x16x32_bf16 v[144:147], v[240:243], v[192:195], v[144:147]
    s_waitcnt vmcnt(3)
    s_mov_b64 exec, 0x18
    v_cmp_ne_u32 vcc, s74, v7
    s_mov_b64 exec, -1
    s_mov_b64 s[66:67], vcc
    s_cmp_lg_u64 s[66:67], 0
    s_cbranch_scc1 L_g2_nx1
    s_add_u32 s38, s57, 0
    buffer_load_dwordx4 v[160:163], v11, s[28:31], s38 offen offset:2048 sc1
    s_add_u32 s38, s57, 32768
    buffer_load_dwordx4 v[172:175], v11, s[28:31], s38 offen offset:1024 sc1
    s_add_u32 s38, s57, 65536
    buffer_load_dwordx4 v[184:187], v11, s[28:31], s38 offen offset:0 sc1
    s_add_u32 s38, s57, 65536
    buffer_load_dwordx4 v[196:199], v11, s[28:31], s38 offen offset:3072 sc1
    s_add_u32 s38, s57, 98304
    buffer_load_dwordx4 v[208:211], v11, s[28:31], s38 offen offset:2048 sc1
L_g2_nx1:
    s_mov_b64 exec, 29
    s_mov_b32 s83, 0x20000
L_g2_tw1:
    buffer_load_dword v6, v3, s[28:31], 0 offen sc1
    s_waitcnt vmcnt(0)
L_g2_tw1_w:
    v_cmp_ne_u32 vcc, s74, v6
    s_nop 0
    s_mov_b64 s[80:81], vcc
    s_cmp_eq_u64 s[80:81], 0
    s_cbranch_scc1 L_g2_tw1_ok
    s_sleep 4
    s_sub_u32 s83, s83, 1
    s_cmp_lg_u32 s83, 0
    s_cbranch_scc1 L_g2_tw1
L_g2_tw1_ok:
    s_mov_b64 exec, -1
    s_cmp_eq_u64 s[66:67], 0
    s_cbranch_scc1 L_g2_hx1
    s_add_u32 s38, s57, 0
    buffer_load_dwordx4 v[160:163], v11, s[28:31], s38 offen offset:2048 sc1
    s_add_u32 s38, s57, 32768
    buffer_load_dwordx4 v[172:175], v11, s[28:31], s38 offen offset:1024 sc1
    s_add_u32 s38, s57, 65536
    buffer_load_dwordx4 v[184:187], v11, s[28:31], s38 offen offset:0 sc1
    s_add_u32 s38, s57, 65536
    buffer_load_dwordx4 v[196:199], v11, s[28:31], s38 offen offset:3072 sc1
    s_add_u32 s38, s57, 98304
    buffer_load_dwordx4 v[208:211], v11, s[28:31], s38 offen offset:2048 sc1
L_g2_hx1:
    s_add_u32 s37, s61, 4096
    buffer_load_dwordx4 v[152:155], v11, s[28:31], s37 offen offset:0 sc1
    buffer_load_dwordx4 v[156:159], v11, s[28:31], s37 offen offset:1024 sc1
    s_add_u32 s37, s61, 8192
    buffer_load_dwordx4 v[164:167], v11, s[28:31], s37 offen offset:2048 sc1
    buffer_load_dwordx4 v[168:171], v11, s[28:31], s37 offen offset:3072 sc1
    s_add_u32 s37, s61, 16384
    buffer_load_dwordx4 v[176:179], v11, s[28:31], s37 offen offset:0 sc1
    buffer_load_dwordx4 v[180:183], v11, s[28:31], s37 offen offset:1024 sc1
    s_add_u32 s37, s61, 20480
    buffer_load_dwordx4 v[188:191], v11, s[28:31], s37 offen offset:2048 sc1
    buffer_load_dwordx4 v[192:195], v11, s[28:31], s37 offen offset:3072 sc1
    s_add_u32 s37, s61, 28672
    buffer_load_dwordx4 v[200:203], v11, s[28:31], s37 offen offset:0 sc1
    buffer_load_dwordx4 v[204:207], v11, s[28:31], s37 offen offset:1024 sc1
    s_waitcnt vmcnt(10)
    v_lshlrev_b32 v248, 16, v160
    v_and_b32 v249, 0xffff0000, v160
    v_pk_fma_f32 v[88:89], v[88:89], s[64:65], v[248:249]
    v_lshlrev_b32 v250, 16, v161
    v_and_b32 v251, 0xffff0000, v161
    v_pk_fma_f32 v[90:91], v[90:91], s[64:65], v[250:251]
    v_lshlrev_b32 v248, 16, v162
    v_and_b32 v249, 0xffff0000, v162
    v_pk_fma_f32 v[104:105], v[104:105], s[64:65], v[248:249]
    v_lshlrev_b32 v250, 16, v163
    v_and_b32 v251, 0xffff0000, v163
    v_pk_fma_f32 v[106:107], v[106:107], s[64:65], v[250:251]
    v_lshlrev_b32 v248, 16, v172
    v_and_b32 v249, 0xffff0000, v172
    v_pk_fma_f32 v[60:61], v[60:61], s[64:65], v[248:249]
    v_lshlrev_b32 v250, 16, v173
    v_and_b32 v251, 0xffff0000, v173
    v_pk_fma_f32 v[62:63], v[62:63], s[64:65], v[250:251]
    v_lshlrev_b32 v248, 16, v174
    v_and_b32 v249, 0xffff0000, v174
    v_pk_fma_f32 v[76:77], v[76:77], s[64:65], v[248:249]
    v_lshlrev_b32 v250, 16, v175
    v_and_b32 v251, 0xffff0000, v175
    v_pk_fma_f32 v[78:79], v[78:79], s[64:65], v[250:251]
    v_lshlrev_b32 v248, 16, v184
    v_and_b32 v249, 0xffff0000, v184
    v_pk_fma_f32 v[32:33], v[32:33], s[64:65], v[248:249]
    v_lshlrev_b32 v250, 16, v185
    v_and_b32 v251, 0xffff0000, v185
    v_pk_fma_f32 v[34:35], v[34:35], s[64:65], v[250:251]
    v_lshlrev_b32 v248, 16, v186
    v_and_b32 v249, 0xffff0000, v186
    v_pk_fma_f32 v[48:49], v[48:49], s[64:65], v[248:249]
    v_lshlrev_b32 v250, 16, v187
    v_and_b32 v251, 0xffff0000, v187
    v_pk_fma_f32 v[50:51], v[50:51], s[64:65], v[250:251]
    v_lshlrev_b32 v248, 16, v196
    v_and_b32 v249, 0xffff0000, v196
    v_pk_fma_f32 v[128:129], v[128:129], s[64:65], v[248:249]
    v_lshlrev_b32 v250, 16, v197
    v_and_b32 v251, 0xffff0000, v197
    v_pk_fma_f32 v[130:131], v[130:131], s[64:65], v[250:251]
    v_lshlrev_b32 v248, 16, v198
    v_and_b32 v249, 0xffff0000, v198
    v_pk_fma_f32 v[144:145], v[144:145], s[64:65], v[248:249]
    v_lshlrev_b32 v250, 16, v199
    v_and_b32 v251, 0xffff0000, v199
    v_pk_fma_f32 v[146:147], v[146:147], s[64:65], v[250:251]
    v_lshlrev_b32 v248, 16, v208
    v_and_b32 v249, 0xffff0000, v208
    v_pk_fma_f32 v[100:101], v[100:101], s[64:65], v[248:249]
    v_lshlrev_b32 v250, 16, v209
    v_and_b32 v251, 0xffff0000, v209
    v_pk_fma_f32 v[102:103], v[102:103], s[64:65], v[250:251]
    v_lshlrev_b32 v248, 16, v210
    v_and_b32 v249, 0xffff0000, v210
    v_pk_fma_f32 v[116:117], v[116:117], s[64:65], v[248:249]
    v_lshlrev_b32 v250, 16, v211
    v_and_b32 v251, 0xffff0000, v211
    v_pk_fma_f32 v[118:119], v[118:119], s[64:65], v[250:251]
    s_waitcnt vmcnt(8)
    v_lshlrev_b32 v248, 16, v152
    v_and_b32 v249, 0xffff0000, v152
    v_lshlrev_b32 v250, 16, v156
    v_and_b32 v251, 0xffff0000, v156
    v_pk_add_f32 v[248:249], v[248:249], v[250:251]
    v_pk_fma_f32 v[88:89], v[248:249], s[64:65], v[88:89]
    v_cvt_pk_bf16_f32 v12, v88, v89
    v_lshlrev_b32 v252, 16, v153
    v_and_b32 v253, 0xffff0000, v153
    v_lshlrev_b32 v254, 16, v157
    v_and_b32 v255, 0xffff0000, v157
    v_pk_add_f32 v[252:253], v[252:253], v[254:255]
    v_pk_fma_f32 v[90:91], v[252:253], s[64:65], v[90:91]
    v_cvt_pk_bf16_f32 v13, v90, v91
    v_lshlrev_b32 v248, 16, v154
    v_and_b32 v249, 0xffff0000, v154
    v_lshlrev_b32 v250, 16, v158
    v_and_b32 v251, 0xffff0000, v158
    v_pk_add_f32 v[248:249], v[248:249], v[250:251]
    v_pk_fma_f32 v[104:105], v[248:249], s[64:65], v[104:105]
    v_cvt_pk_bf16_f32 v14, v104, v105
    v_lshlrev_b32 v252, 16, v155
    v_and_b32 v253, 0xffff0000, v155
    v_lshlrev_b32 v254, 16, v159
    v_and_b32 v255, 0xffff0000, v159
    v_pk_add_f32 v[252:253], v[252:253], v[254:255]
    v_pk_fma_f32 v[106:107], v[252:253], s[64:65], v[106:107]
    v_cvt_pk_bf16_f32 v15, v106, v107
    v_permlane16_swap_b32 v12, v14
    s_nop 0
    v_permlane16_swap_b32 v13, v15
    s_add_u32 s37, s56, 0
    buffer_store_dwordx4 v[12:15], v9, s[24:27], s37 offen offset:128 nt
    s_waitcnt vmcnt(7)
    v_lshlrev_b32 v248, 16, v164
    v_and_b32 v249, 0xffff0000, v164
    v_lshlrev_b32 v250, 16, v168
    v_and_b32 v251, 0xffff0000, v168
    v_pk_add_f32 v[248:249], v[248:249], v[250:251]
    v_pk_fma_f32 v[60:61], v[248:249], s[64:65], v[60:61]
    v_cvt_pk_bf16_f32 v16, v60, v61
    v_lshlrev_b32 v252, 16, v165
    v_and_b32 v253, 0xffff0000, v165
    v_lshlrev_b32 v254, 16, v169
    v_and_b32 v255, 0xffff0000, v169
    v_pk_add_f32 v[252:253], v[252:253], v[254:255]
    v_pk_fma_f32 v[62:63], v[252:253], s[64:65], v[62:63]
    v_cvt_pk_bf16_f32 v17, v62, v63
    v_lshlrev_b32 v248, 16, v166
    v_and_b32 v249, 0xffff0000, v166
    v_lshlrev_b32 v250, 16, v170
    v_and_b32 v251, 0xffff0000, v170
    v_pk_add_f32 v[248:249], v[248:249], v[250:251]
    v_pk_fma_f32 v[76:77], v[248:249], s[64:65], v[76:77]
    v_cvt_pk_bf16_f32 v18, v76, v77
    v_lshlrev_b32 v252, 16, v167
    v_and_b32 v253, 0xffff0000, v167
    v_lshlrev_b32 v254, 16, v171
    v_and_b32 v255, 0xffff0000, v171
    v_pk_add_f32 v[252:253], v[252:253], v[254:255]
    v_pk_fma_f32 v[78:79], v[252:253], s[64:65], v[78:79]
    v_cvt_pk_bf16_f32 v19, v78, v79
    v_permlane16_swap_b32 v16, v18
    s_nop 0
    v_permlane16_swap_b32 v17, v19
    s_add_u32 s37, s56, 32768
    buffer_store_dwordx4 v[16:19], v9, s[24:27], s37 offen offset:64 nt
    s_waitcnt vmcnt(6)
    v_lshlrev_b32 v248, 16, v176
    v_and_b32 v249, 0xffff0000, v176
    v_lshlrev_b32 v250, 16, v180
    v_and_b32 v251, 0xffff0000, v180
    v_pk_add_f32 v[248:249], v[248:249], v[250:251]
    v_pk_fma_f32 v[32:33], v[248:249], s[64:65], v[32:33]
    v_cvt_pk_bf16_f32 v12, v32, v33
    v_lshlrev_b32 v252, 16, v177
    v_and_b32 v253, 0xffff0000, v177
    v_lshlrev_b32 v254, 16, v181
    v_and_b32 v255, 0xffff0000, v181
    v_pk_add_f32 v[252:253], v[252:253], v[254:255]
    v_pk_fma_f32 v[34:35], v[252:253], s[64:65], v[34:35]
    v_cvt_pk_bf16_f32 v13, v34, v35
    v_lshlrev_b32 v248, 16, v178
    v_and_b32 v249, 0xffff0000, v178
    v_lshlrev_b32 v250, 16, v182
    v_and_b32 v251, 0xffff0000, v182
    v_pk_add_f32 v[248:249], v[248:249], v[250:251]
    v_pk_fma_f32 v[48:49], v[248:249], s[64:65], v[48:49]
    v_cvt_pk_bf16_f32 v14, v48, v49
    v_lshlrev_b32 v252, 16, v179
    v_and_b32 v253, 0xffff0000, v179
    v_lshlrev_b32 v254, 16, v183
    v_and_b32 v255, 0xffff0000, v183
    v_pk_add_f32 v[252:253], v[252:253], v[254:255]
    v_pk_fma_f32 v[50:51], v[252:253], s[64:65], v[50:51]
    v_cvt_pk_bf16_f32 v15, v50, v51
    v_permlane16_swap_b32 v12, v14
    s_nop 0
    v_permlane16_swap_b32 v13, v15
    s_add_u32 s37, s56, 65536
    buffer_store_dwordx4 v[12:15], v9, s[24:27], s37 offen offset:0 nt
    s_waitcnt vmcnt(5)
    v_lshlrev_b32 v248, 16, v188
    v_and_b32 v249, 0xffff0000, v188
    v_lshlrev_b32 v250, 16, v192
    v_and_b32 v251, 0xffff0000, v192
    v_pk_add_f32 v[248:249], v[248:249], v[250:251]
    v_pk_fma_f32 v[128:129], v[248:249], s[64:65], v[128:129]
    v_cvt_pk_bf16_f32 v16, v128, v129
    v_lshlrev_b32 v252, 16, v189
    v_and_b32 v253, 0xffff0000, v189
    v_lshlrev_b32 v254, 16, v193
    v_and_b32 v255, 0xffff0000, v193
    v_pk_add_f32 v[252:253], v[252:253], v[254:255]
    v_pk_fma_f32 v[130:131], v[252:253], s[64:65], v[130:131]
    v_cvt_pk_bf16_f32 v17, v130, v131
    v_lshlrev_b32 v248, 16, v190
    v_and_b32 v249, 0xffff0000, v190
    v_lshlrev_b32 v250, 16, v194
    v_and_b32 v251, 0xffff0000, v194
    v_pk_add_f32 v[248:249], v[248:249], v[250:251]
    v_pk_fma_f32 v[144:145], v[248:249], s[64:65], v[144:145]
    v_cvt_pk_bf16_f32 v18, v144, v145
    v_lshlrev_b32 v252, 16, v191
    v_and_b32 v253, 0xffff0000, v191
    v_lshlrev_b32 v254, 16, v195
    v_and_b32 v255, 0xffff0000, v195
    v_pk_add_f32 v[252:253], v[252:253], v[254:255]
    v_pk_fma_f32 v[146:147], v[252:253], s[64:65], v[146:147]
    v_cvt_pk_bf16_f32 v19, v146, v147
    v_permlane16_swap_b32 v16, v18
    s_nop 0
    v_permlane16_swap_b32 v17, v19
    s_add_u32 s37, s56, 65536
    buffer_store_dwordx4 v[16:19], v9, s[24:27], s37 offen offset:192 nt
    s_waitcnt vmcnt(4)
    v_lshlrev_b32 v248, 16, v200
    v_and_b32 v249, 0xffff0000, v200
    v_lshlrev_b32 v250, 16, v204
    v_and_b32 v251, 0xffff0000, v204
    v_pk_add_f32 v[248:249], v[248:249], v[250:251]
    v_pk_fma_f32 v[100:101], v[248:249], s[64:65], v[100:101]
    v_cvt_pk_bf16_f32 v12, v100, v101
    v_lshlrev_b32 v252, 16, v201
    v_and_b32 v253, 0xffff0000, v201
    v_lshlrev_b32 v254, 16, v205
    v_and_b32 v255, 0xffff0000, v205
    v_pk_add_f32 v[252:253], v[252:253], v[254:255]
    v_pk_fma_f32 v[102:103], v[252:253], s[64:65], v[102:103]
    v_cvt_pk_bf16_f32 v13, v102, v103
    v_lshlrev_b32 v248, 16, v202
    v_and_b32 v249, 0xffff0000, v202
    v_lshlrev_b32 v250, 16, v206
    v_and_b32 v251, 0xffff0000, v206
    v_pk_add_f32 v[248:249], v[248:249], v[250:251]
    v_pk_fma_f32 v[116:117], v[248:249], s[64:65], v[116:117]
    v_cvt_pk_bf16_f32 v14, v116, v117
    v_lshlrev_b32 v252, 16, v203
    v_and_b32 v253, 0xffff0000, v203
    v_lshlrev_b32 v254, 16, v207
    v_and_b32 v255, 0xffff0000, v207
    v_pk_add_f32 v[252:253], v[252:253], v[254:255]
    v_pk_fma_f32 v[118:119], v[252:253], s[64:65], v[118:119]
    v_cvt_pk_bf16_f32 v15, v118, v119
    v_permlane16_swap_b32 v12, v14
    s_nop 0
    v_permlane16_swap_b32 v13, v15
    s_add_u32 s37, s56, 98304
    buffer_store_dwordx4 v[12:15], v9, s[24:27], s37 offen offset:128 nt
    s_branch L_g2_fin
L_g2_k2:
    s_waitcnt lgkmcnt(8)
    v_mfma_f32_16x16x32_bf16 v[24:27], v[216:219], v[184:187], v[24:27]
    ds_read_b64_tr_b16 v[240:241], v15 offset:0
    s_add_u32 s48, s48, 1
    s_cmp_eq_u32 s48, 3
    s_cselect_b32 s49, s50, s51
    s_cselect_b32 s48, 0, s48
    v_mfma_f32_16x16x32_bf16 v[24:27], v[220:223], v[200:203], v[24:27]
    ds_read_b64_tr_b16 v[242:243], v15 offset:8192
    v_mfma_f32_16x16x32_bf16 v[28:31], v[220:223], v[204:207], v[28:31]
    ds_read_b64_tr_b16 v[244:245], v15 offset:16384
    v_mfma_f32_16x16x32_bf16 v[28:31], v[216:219], v[188:191], v[28:31]
    ds_read_b64_tr_b16 v[246:247], v15 offset:24576
    v_mfma_f32_16x16x32_bf16 v[32:35], v[216:219], v[192:195], v[32:35]
    v_add_u32 v15, s49, v15
    v_mfma_f32_16x16x32_bf16 v[32:35], v[220:223], v[208:211], v[32:35]
    v_add_u32 v12, s49, v12
    v_mfma_f32_16x16x32_bf16 v[36:39], v[220:223], v[212:215], v[36:39]
    v_add_u32 v13, s49, v13
    v_mfma_f32_16x16x32_bf16 v[36:39], v[216:219], v[196:199], v[36:39]
    s_waitcnt lgkmcnt(8)
    v_mfma_f32_16x16x32_bf16 v[52:55], v[224:227], v[196:199], v[52:55]
    ds_read_b64_tr_b16 v[216:217], v16 offset:0
    v_mfma_f32_16x16x32_bf16 v[52:55], v[228:231], v[212:215], v[52:55]
    ds_read_b64_tr_b16 v[218:219], v16 offset:8192
    v_mfma_f32_16x16x32_bf16 v[48:51], v[228:231], v[208:211], v[48:51]
    ds_read_b64_tr_b16 v[220:221], v16 offset:16384
    v_mfma_f32_16x16x32_bf16 v[48:51], v[224:227], v[192:195], v[48:51]
    ds_read_b64_tr_b16 v[222:223], v16 offset:24576
    v_mfma_f32_16x16x32_bf16 v[44:47], v[224:227], v[188:191], v[44:47]
    v_add_u32 v16, s49, v16
    v_mfma_f32_16x16x32_bf16 v[44:47], v[228:231], v[204:207], v[44:47]
    v_add_u32 v20, s49, v20
    v_mfma_f32_16x16x32_bf16 v[40:43], v[228:231], v[200:203], v[40:43]
    v_add_u32 v21, s49, v21
    v_mfma_f32_16x16x32_bf16 v[40:43], v[224:227], v[184:187], v[40:43]
    s_waitcnt lgkmcnt(8)
    v_mfma_f32_16x16x32_bf16 v[56:59], v[232:235], v[184:187], v[56:59]
    ds_read_b64_tr_b16 v[224:225], v17 offset:0
    v_mfma_f32_16x16x32_bf16 v[56:59], v[236:239], v[200:203], v[56:59]
    ds_read_b64_tr_b16 v[226:227], v17 offset:8192
    v_mfma_f32_16x16x32_bf16 v[60:63], v[236:239], v[204:207], v[60:63]
    ds_read_b64_tr_b16 v[228:229], v17 offset:16384
    v_mfma_f32_16x16x32_bf16 v[60:63], v[232:235], v[188:191], v[60:63]
    ds_read_b64_tr_b16 v[230:231], v17 offset:24576
    v_mfma_f32_16x16x32_bf16 v[64:67], v[232:235], v[192:195], v[64:67]
    v_add_u32 v17, s49, v17
    v_cvt_pk_bf16_f32 v28, v28, v29
    v_cvt_pk_bf16_f32 v29, v30, v31
    v_mfma_f32_16x16x32_bf16 v[64:67], v[236:239], v[208:211], v[64:67]
    v_add_u32 v14, s49, v14
    v_cvt_pk_bf16_f32 v30, v44, v45
    v_mfma_f32_16x16x32_bf16 v[68:71], v[236:239], v[212:215], v[68:71]
    v_cvt_pk_bf16_f32 v31, v46, v47
    v_mfma_f32_16x16x32_bf16 v[68:71], v[232:235], v[196:199], v[68:71]
    s_add_u32 s37, s61, 8192
    buffer_store_dwordx4 v[28:31], v11, s[28:31], s37 offen offset:1024 sc1
    v_cvt_pk_bf16_f32 v32, v32, v33
    s_waitcnt lgkmcnt(8)
    v_mfma_f32_16x16x32_bf16 v[84:87], v[240:243], v[196:199], v[84:87]
    ds_read_b64_tr_b16 v[232:233], v18 offset:0
    v_cvt_pk_bf16_f32 v33, v34, v35
    v_mfma_f32_16x16x32_bf16 v[84:87], v[244:247], v[212:215], v[84:87]
    ds_read_b64_tr_b16 v[234:235], v18 offset:8192
    v_cvt_pk_bf16_f32 v34, v48, v49
    v_mfma_f32_16x16x32_bf16 v[80:83], v[244:247], v[208:211], v[80:83]
    ds_read_b64_tr_b16 v[236:237], v18 offset:16384
    v_cvt_pk_bf16_f32 v35, v50, v51
    s_add_u32 s37, s61, 16384
    buffer_store_dwordx4 v[32:35], v11, s[28:31], s37 offen offset:0 sc1
    v_mfma_f32_16x16x32_bf16 v[80:83], v[240:243], v[192:195], v[80:83]
    ds_read_b64_tr_b16 v[238:239], v18 offset:24576
    v_mfma_f32_16x16x32_bf16 v[76:79], v[240:243], v[188:191], v[76:79]
    v_add_u32 v18, s49, v18
    v_mfma_f32_16x16x32_bf16 v[76:79], v[244:247], v[204:207], v[76:79]
    v_mfma_f32_16x16x32_bf16 v[72:75], v[244:247], v[200:203], v[72:75]
    v_mfma_f32_16x16x32_bf16 v[72:75], v[240:243], v[184:187], v[72:75]
    s_waitcnt lgkmcnt(8)
    v_mfma_f32_16x16x32_bf16 v[88:91], v[216:219], v[184:187], v[88:91]
    ds_read_b64_tr_b16 v[240:241], v19 offset:0
    v_mfma_f32_16x16x32_bf16 v[88:91], v[220:223], v[200:203], v[88:91]
    ds_read_b64_tr_b16 v[242:243], v19 offset:8192
    v_mfma_f32_16x16x32_bf16 v[92:95], v[220:223], v[204:207], v[92:95]
    ds_read_b64_tr_b16 v[244:245], v19 offset:16384
    v_mfma_f32_16x16x32_bf16 v[92:95], v[216:219], v[188:191], v[92:95]
    ds_read_b64_tr_b16 v[246:247], v19 offset:24576
    v_mfma_f32_16x16x32_bf16 v[96:99], v[216:219], v[192:195], v[96:99]
    v_add_u32 v19, s49, v19
    v_cvt_pk_bf16_f32 v56, v56, v57
    v_cvt_pk_bf16_f32 v57, v58, v59
    v_mfma_f32_16x16x32_bf16 v[96:99], v[220:223], v[208:211], v[96:99]
    v_cvt_pk_bf16_f32 v58, v72, v73
    v_mfma_f32_16x16x32_bf16 v[100:103], v[220:223], v[212:215], v[100:103]
    v_cvt_pk_bf16_f32 v59, v74, v75
    v_mfma_f32_16x16x32_bf16 v[100:103], v[216:219], v[196:199], v[100:103]
    s_add_u32 s37, s61, 0
    buffer_store_dwordx4 v[56:59], v11, s[28:31], s37 offen offset:3072 sc1
    v_cvt_pk_bf16_f32 v60, v60, v61
    s_waitcnt lgkmcnt(0)
    s_barrier
    v_mfma_f32_16x16x32_bf16 v[116:119], v[224:227], v[196:199], v[116:119]
    ds_read_b64_tr_b16 v[216:217], v12 offset:0
    v_cvt_pk_bf16_f32 v61, v62, v63
    v_mfma_f32_16x16x32_bf16 v[116:119], v[228:231], v[212:215], v[116:119]
    ds_read_b64_tr_b16 v[218:219], v12 offset:8192
    v_cvt_pk_bf16_f32 v62, v76, v77
    v_mfma_f32_16x16x32_bf16 v[112:115], v[228:231], v[208:211], v[112:115]
    ds_read_b64_tr_b16 v[220:221], v12 offset:16384
    v_cvt_pk_bf16_f32 v63, v78, v79
    s_add_u32 s37, s61, 8192
    buffer_store_dwordx4 v[60:63], v11, s[28:31], s37 offen offset:2048 sc1
    v_mfma_f32_16x16x32_bf16 v[112:115], v[224:227], v[192:195], v[112:115]
    ds_read_b64_tr_b16 v[222:223], v12 offset:24576
    v_cvt_pk_bf16_f32 v68, v68, v69
    v_mfma_f32_16x16x32_bf16 v[108:111], v[224:227], v[188:191], v[108:111]
    ds_read_b128 v[152:155], v20 offset:0
    v_cvt_pk_bf16_f32 v69, v70, v71
    v_mfma_f32_16x16x32_bf16 v[108:111], v[228:231], v[204:207], v[108:111]
    ds_read_b128 v[168:171], v21 offset:0
    v_cvt_pk_bf16_f32 v70, v84, v85
    v_cvt_pk_bf16_f32 v71, v86, v87
    v_mfma_f32_16x16x32_bf16 v[104:107], v[228:231], v[200:203], v[104:107]
    ds_read_b128 v[172:175], v21 offset:2048
    s_add_u32 s37, s61, 24576
    buffer_store_dwordx4 v[68:71], v11, s[28:31], s37 offen offset:3072 sc1
    v_mfma_f32_16x16x32_bf16 v[104:107], v[224:227], v[184:187], v[104:107]
    ds_read_b128 v[156:159], v20 offset:2048
    v_mfma_f32_16x16x32_bf16 v[120:123], v[232:235], v[184:187], v[120:123]
    ds_read_b128 v[160:163], v20 offset:4096
    v_mfma_f32_16x16x32_bf16 v[120:123], v[236:239], v[200:203], v[120:123]
    ds_read_b128 v[176:179], v21 offset:4096
    v_mfma_f32_16x16x32_bf16 v[124:127], v[236:239], v[204:207], v[124:127]
    ds_read_b128 v[180:183], v21 offset:6144
    v_mfma_f32_16x16x32_bf16 v[124:127], v[232:235], v[188:191], v[124:127]
    ds_read_b128 v[164:167], v20 offset:6144
    v_mfma_f32_16x16x32_bf16 v[128:131], v[232:235], v[192:195], v[128:131]
    ds_read_b64_tr_b16 v[224:225], v13 offset:0
    v_cvt_pk_bf16_f32 v88, v88, v89
    v_cvt_pk_bf16_f32 v89, v90, v91
    v_mfma_f32_16x16x32_bf16 v[128:131], v[236:239], v[208:211], v[128:131]
    ds_read_b64_tr_b16 v[226:227], v13 offset:8192
    v_cvt_pk_bf16_f32 v90, v104, v105
    v_mfma_f32_16x16x32_bf16 v[132:135], v[236:239], v[212:215], v[132:135]
    ds_read_b64_tr_b16 v[228:229], v13 offset:16384
    v_cvt_pk_bf16_f32 v91, v106, v107
    v_mfma_f32_16x16x32_bf16 v[132:135], v[232:235], v[196:199], v[132:135]
    ds_read_b64_tr_b16 v[230:231], v13 offset:24576
    s_add_u32 s37, s61, 4096
    buffer_store_dwordx4 v[88:91], v11, s[28:31], s37 offen offset:0 sc1
    v_cvt_pk_bf16_f32 v96, v96, v97
    v_mfma_f32_16x16x32_bf16 v[148:151], v[240:243], v[196:199], v[148:151]
    ds_read_b64_tr_b16 v[232:233], v14 offset:0
    v_cvt_pk_bf16_f32 v97, v98, v99
    v_mfma_f32_16x16x32_bf16 v[148:151], v[244:247], v[212:215], v[148:151]
    ds_read_b64_tr_b16 v[234:235], v14 offset:8192
    v_cvt_pk_bf16_f32 v98, v112, v113
    v_mfma_f32_16x16x32_bf16 v[144:147], v[244:247], v[208:211], v[144:147]
    ds_read_b64_tr_b16 v[236:237], v14 offset:16384
    v_cvt_pk_bf16_f32 v99, v114, v115
    s_add_u32 s37, s61, 20480
    buffer_store_dwordx4 v[96:99], v11, s[28:31], s37 offen offset:1024 sc1
    v_mfma_f32_16x16x32_bf16 v[144:147], v[240:243], v[192:195], v[144:147]
    ds_read_b64_tr_b16 v[238:239], v14 offset:24576
    v_cvt_pk_bf16_f32 v100, v100, v101
    v_mfma_f32_16x16x32_bf16 v[140:143], v[240:243], v[188:191], v[140:143]
    v_cvt_pk_bf16_f32 v101, v102, v103
    v_mfma_f32_16x16x32_bf16 v[140:143], v[244:247], v[204:207], v[140:143]
    v_cvt_pk_bf16_f32 v102, v116, v117
    v_cvt_pk_bf16_f32 v103, v118, v119
    v_mfma_f32_16x16x32_bf16 v[136:139], v[244:247], v[200:203], v[136:139]
    s_add_u32 s37, s61, 28672
    buffer_store_dwordx4 v[100:103], v11, s[28:31], s37 offen offset:0 sc1
    v_mfma_f32_16x16x32_bf16 v[136:139], v[240:243], v[184:187], v[136:139]
    buffer_load_dword v7, v10, s[28:31], s60 offen sc1
    s_waitcnt lgkmcnt(8)
    v_mfma_f32_16x16x32_bf16 v[24:27], v[216:219], v[152:155], v[24:27]
    ds_read_b64_tr_b16 v[240:241], v15 offset:0
    s_add_u32 s48, s48, 1
    s_cmp_eq_u32 s48, 3
    s_cselect_b32 s49, s50, s51
    s_cselect_b32 s48, 0, s48
    v_mfma_f32_16x16x32_bf16 v[24:27], v[220:223], v[168:171], v[24:27]
    ds_read_b64_tr_b16 v[242:243], v15 offset:8192
    ds_read_b64_tr_b16 v[244:245], v15 offset:16384
    ds_read_b64_tr_b16 v[246:247], v15 offset:24576
    v_add_u32 v15, s49, v15
    v_cvt_pk_bf16_f32 v124, v124, v125
    v_cvt_pk_bf16_f32 v125, v126, v127
    v_add_u32 v12, s49, v12
    v_cvt_pk_bf16_f32 v126, v140, v141
    v_cvt_pk_bf16_f32 v127, v142, v143
    v_mfma_f32_16x16x32_bf16 v[36:39], v[220:223], v[180:183], v[36:39]
    v_add_u32 v13, s49, v13
    s_add_u32 s37, s61, 12288
    buffer_store_dwordx4 v[124:127], v11, s[28:31], s37 offen offset:3072 sc1
    v_cvt_pk_bf16_f32 v128, v128, v129
    v_mfma_f32_16x16x32_bf16 v[36:39], v[216:219], v[164:167], v[36:39]
    v_cvt_pk_bf16_f32 v129, v130, v131
    v_cvt_pk_bf16_f32 v130, v144, v145
    s_waitcnt lgkmcnt(8)
    v_mfma_f32_16x16x32_bf16 v[52:55], v[224:227], v[164:167], v[52:55]
    ds_read_b64_tr_b16 v[216:217], v16 offset:0
    v_cvt_pk_bf16_f32 v131, v146, v147
    s_add_u32 s37, s61, 20480
    buffer_store_dwordx4 v[128:131], v11, s[28:31], s37 offen offset:2048 sc1
    v_mfma_f32_16x16x32_bf16 v[52:55], v[228:231], v[180:183], v[52:55]
    ds_read_b64_tr_b16 v[218:219], v16 offset:8192
    ds_read_b64_tr_b16 v[220:221], v16 offset:16384
    ds_read_b64_tr_b16 v[222:223], v16 offset:24576
    v_add_u32 v16, s49, v16
    v_add_u32 v20, s49, v20
    v_mfma_f32_16x16x32_bf16 v[40:43], v[228:231], v[168:171], v[40:43]
    v_add_u32 v21, s49, v21
    v_mfma_f32_16x16x32_bf16 v[40:43], v[224:227], v[152:155], v[40:43]
    s_waitcnt lgkmcnt(8)
    ds_read_b64_tr_b16 v[224:225], v17 offset:0
    ds_read_b64_tr_b16 v[226:227], v17 offset:8192
    ds_read_b64_tr_b16 v[228:229], v17 offset:16384
    ds_read_b64_tr_b16 v[230:231], v17 offset:24576
    v_mfma_f32_16x16x32_bf16 v[64:67], v[232:235], v[160:163], v[64:67]
    v_add_u32 v17, s49, v17
    v_mfma_f32_16x16x32_bf16 v[64:67], v[236:239], v[176:179], v[64:67]
    v_add_u32 v14, s49, v14
    s_waitcnt lgkmcnt(8)
    ds_read_b64_tr_b16 v[232:233], v18 offset:0
    ds_read_b64_tr_b16 v[234:235], v18 offset:8192
    v_mfma_f32_16x16x32_bf16 v[80:83], v[244:247], v[176:179], v[80:83]
    ds_read_b64_tr_b16 v[236:237], v18 offset:16384
    v_mfma_f32_16x16x32_bf16 v[80:83], v[240:243], v[160:163], v[80:83]
    ds_read_b64_tr_b16 v[238:239], v18 offset:24576
    v_add_u32 v18, s49, v18
    s_waitcnt lgkmcnt(8)
    ds_read_b64_tr_b16 v[240:241], v19 offset:0
    ds_read_b64_tr_b16 v[242:243], v19 offset:8192
    v_mfma_f32_16x16x32_bf16 v[92:95], v[220:223], v[172:175], v[92:95]
    ds_read_b64_tr_b16 v[244:245], v19 offset:16384
    v_mfma_f32_16x16x32_bf16 v[92:95], v[216:219], v[156:159], v[92:95]
    ds_read_b64_tr_b16 v[246:247], v19 offset:24576
    v_add_u32 v19, s49, v19
    s_waitcnt lgkmcnt(0)
    s_barrier
    ds_read_b64_tr_b16 v[216:217], v12 offset:0
    ds_read_b64_tr_b16 v[218:219], v12 offset:8192
    ds_read_b64_tr_b16 v[220:221], v12 offset:16384
    ds_read_b64_tr_b16 v[222:223], v12 offset:24576
    v_mfma_f32_16x16x32_bf16 v[108:111], v[224:227], v[156:159], v[108:111]
    ds_read_b128 v[184:187], v20 offset:0
    v_mfma_f32_16x16x32_bf16 v[108:111], v[228:231], v[172:175], v[108:111]
    ds_read_b128 v[200:203], v21 offset:0
    ds_read_b128 v[204:207], v21 offset:2048
    ds_read_b128 v[188:191], v20 offset:2048
    v_mfma_f32_16x16x32_bf16 v[120:123], v[232:235], v[152:155], v[120:123]
    ds_read_b128 v[192:195], v20 offset:4096
    v_mfma_f32_16x16x32_bf16 v[120:123], v[236:239], v[168:171], v[120:123]
    ds_read_b128 v[208:211], v21 offset:4096
    ds_read_b128 v[212:215], v21 offset:6144
    ds_read_b128 v[196:199], v20 offset:6144
    ds_read_b64_tr_b16 v[224:225], v13 offset:0
    ds_read_b64_tr_b16 v[226:227], v13 offset:8192
    v_mfma_f32_16x16x32_bf16 v[132:135], v[236:239], v[180:183], v[132:135]
    ds_read_b64_tr_b16 v[228:229], v13 offset:16384
    v_mfma_f32_16x16x32_bf16 v[132:135], v[232:235], v[164:167], v[132:135]
    ds_read_b64_tr_b16 v[230:231], v13 offset:24576
    v_mfma_f32_16x16x32_bf16 v[148:151], v[240:243], v[164:167], v[148:151]
    ds_read_b64_tr_b16 v[232:233], v14 offset:0
    v_mfma_f32_16x16x32_bf16 v[148:151], v[244:247], v[180:183], v[148:151]
    ds_read_b64_tr_b16 v[234:235], v14 offset:8192
    ds_read_b64_tr_b16 v[236:237], v14 offset:16384
    ds_read_b64_tr_b16 v[238:239], v14 offset:24576
    v_mfma_f32_16x16x32_bf16 v[136:139], v[244:247], v[168:171], v[136:139]
    v_mfma_f32_16x16x32_bf16 v[136:139], v[240:243], v[152:155], v[136:139]
    s_waitcnt vmcnt(0)
    s_mov_b64 exec, 1
    buffer_store_dword v4, v5, s[28:31], s63 offen sc1
    s_mov_b64 exec, -1
    s_waitcnt lgkmcnt(8)
    v_mfma_f32_16x16x32_bf16 v[24:27], v[216:219], v[184:187], v[24:27]
    ds_read_b64_tr_b16 v[240:241], v15 offset:0
    v_mfma_f32_16x16x32_bf16 v[24:27], v[220:223], v[200:203], v[24:27]
    ds_read_b64_tr_b16 v[242:243], v15 offset:8192
    ds_read_b64_tr_b16 v[244:245], v15 offset:16384
    ds_read_b64_tr_b16 v[246:247], v15 offset:24576
    v_mfma_f32_16x16x32_bf16 v[36:39], v[220:223], v[212:215], v[36:39]
    v_mfma_f32_16x16x32_bf16 v[36:39], v[216:219], v[196:199], v[36:39]
    s_waitcnt lgkmcnt(8)
    v_mfma_f32_16x16x32_bf16 v[52:55], v[224:227], v[196:199], v[52:55]
    ds_read_b64_tr_b16 v[216:217], v16 offset:0
    v_mfma_f32_16x16x32_bf16 v[52:55], v[228:231], v[212:215], v[52:55]
    ds_read_b64_tr_b16 v[218:219], v16 offset:8192
    ds_read_b64_tr_b16 v[220:221], v16 offset:16384
    ds_read_b64_tr_b16 v[222:223], v16 offset:24576
    v_mfma_f32_16x16x32_bf16 v[40:43], v[228:231], v[200:203], v[40:43]
    v_mfma_f32_16x16x32_bf16 v[40:43], v[224:227], v[184:187], v[40:43]
    s_waitcnt lgkmcnt(8)
    ds_read_b64_tr_b16 v[224:225], v17 offset:0
    ds_read_b64_tr_b16 v[226:227], v17 offset:8192
    ds_read_b64_tr_b16 v[228:229], v17 offset:16384
    ds_read_b64_tr_b16 v[230:231], v17 offset:24576
    v_mfma_f32_16x16x32_bf16 v[64:67], v[232:235], v[192:195], v[64:67]
    v_mfma_f32_16x16x32_bf16 v[64:67], v[236:239], v[208:211], v[64:67]
    s_waitcnt lgkmcnt(8)
    ds_read_b64_tr_b16 v[232:233], v18 offset:0
    ds_read_b64_tr_b16 v[234:235], v18 offset:8192
    v_mfma_f32_16x16x32_bf16 v[80:83], v[244:247], v[208:211], v[80:83]
    ds_read_b64_tr_b16 v[236:237], v18 offset:16384
    v_mfma_f32_16x16x32_bf16 v[80:83], v[240:243], v[192:195], v[80:83]
    ds_read_b64_tr_b16 v[238:239], v18 offset:24576
    s_waitcnt lgkmcnt(8)
    ds_read_b64_tr_b16 v[240:241], v19 offset:0
    ds_read_b64_tr_b16 v[242:243], v19 offset:8192
    v_mfma_f32_16x16x32_bf16 v[92:95], v[220:223], v[204:207], v[92:95]
    ds_read_b64_tr_b16 v[244:245], v19 offset:16384
    v_mfma_f32_16x16x32_bf16 v[92:95], v[216:219], v[188:191], v[92:95]
    ds_read_b64_tr_b16 v[246:247], v19 offset:24576
    s_waitcnt lgkmcnt(0)
    v_mfma_f32_16x16x32_bf16 v[108:111], v[224:227], v[188:191], v[108:111]
    v_mfma_f32_16x16x32_bf16 v[108:111], v[228:231], v[204:207], v[108:111]
    v_mfma_f32_16x16x32_bf16 v[120:123], v[232:235], v[184:187], v[120:123]
    v_mfma_f32_16x16x32_bf16 v[120:123], v[236:239], v[200:203], v[120:123]
    v_mfma_f32_16x16x32_bf16 v[132:135], v[236:239], v[212:215], v[132:135]
    v_mfma_f32_16x16x32_bf16 v[132:135], v[232:235], v[196:199], v[132:135]
    v_mfma_f32_16x16x32_bf16 v[148:151], v[240:243], v[196:199], v[148:151]
    v_mfma_f32_16x16x32_bf16 v[148:151], v[244:247], v[212:215], v[148:151]
    v_mfma_f32_16x16x32_bf16 v[136:139], v[244:247], v[200:203], v[136:139]
    v_mfma_f32_16x16x32_bf16 v[136:139], v[240:243], v[184:187], v[136:139]
    s_waitcnt vmcnt(2)
    s_mov_b64 exec, 0x18
    v_cmp_ne_u32 vcc, s74, v7
    s_mov_b64 exec, -1
    s_mov_b64 s[66:67], vcc
    s_cmp_lg_u64 s[66:67], 0
    s_cbranch_scc1 L_g2_nx2
    s_add_u32 s38, s57, 0
    buffer_load_dwordx4 v[160:163], v11, s[28:31], s38 offen offset:0 sc1
    s_add_u32 s38, s57, 0
    buffer_load_dwordx4 v[172:175], v11, s[28:31], s38 offen offset:3072 sc1
    s_add_u32 s38, s57, 32768
    buffer_load_dwordx4 v[184:187], v11, s[28:31], s38 offen offset:2048 sc1
    s_add_u32 s38, s57, 65536
    buffer_load_dwordx4 v[196:199], v11, s[28:31], s38 offen offset:1024 sc1
    s_add_u32 s38, s57, 98304
    buffer_load_dwordx4 v[208:211], v11, s[28:31], s38 offen offset:0 sc1
    s_add_u32 s38, s57, 98304
    buffer_load_dwordx4 v[220:223], v11, s[28:31], s38 offen offset:3072 sc1
L_g2_nx2:
    s_mov_b64 exec, 27
    s_mov_b32 s83, 0x20000
L_g2_tw2:
    buffer_load_dword v6, v3, s[28:31], 0 offen sc1
    s_waitcnt vmcnt(0)
L_g2_tw2_w:
    v_cmp_ne_u32 vcc, s74, v6
    s_nop 0
    s_mov_b64 s[80:81], vcc
    s_cmp_eq_u64 s[80:81], 0
    s_cbranch_scc1 L_g2_tw2_ok
    s_sleep 4
    s_sub_u32 s83, s83, 1
    s_cmp_lg_u32 s83, 0
    s_cbranch_scc1 L_g2_tw2
L_g2_tw2_ok:
    s_mov_b64 exec, -1
    s_cmp_eq_u64 s[66:67], 0
    s_cbranch_scc1 L_g2_hx2
    s_add_u32 s38, s57, 0
    buffer_load_dwordx4 v[160:163], v11, s[28:31], s38 offen offset:0 sc1
    s_add_u32 s38, s57, 0
    buffer_load_dwordx4 v[172:175], v11, s[28:31], s38 offen offset:3072 sc1
    s_add_u32 s38, s57, 32768
    buffer_load_dwordx4 v[184:187], v11, s[28:31], s38 offen offset:2048 sc1
    s_add_u32 s38, s57, 65536
    buffer_load_dwordx4 v[196:199], v11, s[28:31], s38 offen offset:1024 sc1
    s_add_u32 s38, s57, 98304
    buffer_load_dwordx4 v[208:211], v11, s[28:31], s38 offen offset:0 sc1
    s_add_u32 s38, s57, 98304
    buffer_load_dwordx4 v[220:223], v11, s[28:31], s38 offen offset:3072 sc1
L_g2_hx2:
    s_add_u32 s37, s61, 0
    buffer_load_dwordx4 v[152:155], v11, s[28:31], s37 offen offset:0 sc1
    buffer_load_dwordx4 v[156:159], v11, s[28:31], s37 offen offset:1024 sc1
    s_add_u32 s37, s61, 4096
    buffer_load_dwordx4 v[164:167], v11, s[28:31], s37 offen offset:2048 sc1
    buffer_load_dwordx4 v[168:171], v11, s[28:31], s37 offen offset:3072 sc1
    s_add_u32 s37, s61, 12288
    buffer_load_dwordx4 v[176:179], v11, s[28:31], s37 offen offset:0 sc1
    buffer_load_dwordx4 v[180:183], v11, s[28:31], s37 offen offset:1024 sc1
    s_add_u32 s37, s61, 16384
    buffer_load_dwordx4 v[188:191], v11, s[28:31], s37 offen offset:2048 sc1
    buffer_load_dwordx4 v[192:195], v11, s[28:31], s37 offen offset:3072 sc1
    s_add_u32 s37, s61, 24576
    buffer_load_dwordx4 v[200:203], v11, s[28:31], s37 offen offset:0 sc1
    buffer_load_dwordx4 v[204:207], v11, s[28:31], s37 offen offset:1024 sc1
    s_add_u32 s37, s61, 28672
    buffer_load_dwordx4 v[212:215], v11, s[28:31], s37 offen offset:2048 sc1
    buffer_load_dwordx4 v[216:219], v11, s[28:31], s37 offen offset:3072 sc1
    s_waitcnt vmcnt(12)
    v_lshlrev_b32 v248, 16, v160
    v_and_b32 v249, 0xffff0000, v160
    v_pk_fma_f32 v[24:25], v[24:25], s[64:65], v[248:249]
    v_lshlrev_b32 v250, 16, v161
    v_and_b32 v251, 0xffff0000, v161
    v_pk_fma_f32 v[26:27], v[26:27], s[64:65], v[250:251]
    v_lshlrev_b32 v248, 16, v162
    v_and_b32 v249, 0xffff0000, v162
    v_pk_fma_f32 v[40:41], v[40:41], s[64:65], v[248:249]
    v_lshlrev_b32 v250, 16, v163
    v_and_b32 v251, 0xffff0000, v163
    v_pk_fma_f32 v[42:43], v[42:43], s[64:65], v[250:251]
    v_lshlrev_b32 v248, 16, v172
    v_and_b32 v249, 0xffff0000, v172
    v_pk_fma_f32 v[120:121], v[120:121], s[64:65], v[248:249]
    v_lshlrev_b32 v250, 16, v173
    v_and_b32 v251, 0xffff0000, v173
    v_pk_fma_f32 v[122:123], v[122:123], s[64:65], v[250:251]
    v_lshlrev_b32 v248, 16, v174
    v_and_b32 v249, 0xffff0000, v174
    v_pk_fma_f32 v[136:137], v[136:137], s[64:65], v[248:249]
    v_lshlrev_b32 v250, 16, v175
    v_and_b32 v251, 0xffff0000, v175
    v_pk_fma_f32 v[138:139], v[138:139], s[64:65], v[250:251]
    v_lshlrev_b32 v248, 16, v184
    v_and_b32 v249, 0xffff0000, v184
    v_pk_fma_f32 v[92:93], v[92:93], s[64:65], v[248:249]
    v_lshlrev_b32 v250, 16, v185
    v_and_b32 v251, 0xffff0000, v185
    v_pk_fma_f32 v[94:95], v[94:95], s[64:65], v[250:251]
    v_lshlrev_b32 v248, 16, v186
    v_and_b32 v249, 0xffff0000, v186
    v_pk_fma_f32 v[108:109], v[108:109], s[64:65], v[248:249]
    v_lshlrev_b32 v250, 16, v187
    v_and_b32 v251, 0xffff0000, v187
    v_pk_fma_f32 v[110:111], v[110:111], s[64:65], v[250:251]
    v_lshlrev_b32 v248, 16, v196
    v_and_b32 v249, 0xffff0000, v196
    v_pk_fma_f32 v[64:65], v[64:65], s[64:65], v[248:249]
    v_lshlrev_b32 v250, 16, v197
    v_and_b32 v251, 0xffff0000, v197
    v_pk_fma_f32 v[66:67], v[66:67], s[64:65], v[250:251]
    v_lshlrev_b32 v248, 16, v198
    v_and_b32 v249, 0xffff0000, v198
    v_pk_fma_f32 v[80:81], v[80:81], s[64:65], v[248:249]
    v_lshlrev_b32 v250, 16, v199
    v_and_b32 v251, 0xffff0000, v199
    v_pk_fma_f32 v[82:83], v[82:83], s[64:65], v[250:251]
    v_lshlrev_b32 v248, 16, v208
    v_and_b32 v249, 0xffff0000, v208
    v_pk_fma_f32 v[36:37], v[36:37], s[64:65], v[248:249]
    v_lshlrev_b32 v250, 16, v209
    v_and_b32 v251, 0xffff0000, v209
    v_pk_fma_f32 v[38:39], v[38:39], s[64:65], v[250:251]
    v_lshlrev_b32 v248, 16, v210
    v_and_b32 v249, 0xffff0000, v210
    v_pk_fma_f32 v[52:53], v[52:53], s[64:65], v[248:249]
    v_lshlrev_b32 v250, 16, v211
    v_and_b32 v251, 0xffff0000, v211
    v_pk_fma_f32 v[54:55], v[54:55], s[64:65], v[250:251]
    v_lshlrev_b32 v248, 16, v220
    v_and_b32 v249, 0xffff0000, v220
    v_pk_fma_f32 v[132:133], v[132:133], s[64:65], v[248:249]
    v_lshlrev_b32 v250, 16, v221
    v_and_b32 v251, 0xffff0000, v221
    v_pk_fma_f32 v[134:135], v[134:135], s[64:65], v[250:251]
    v_lshlrev_b32 v248, 16, v222
    v_and_b32 v249, 0xffff0000, v222
    v_pk_fma_f32 v[148:149], v[148:149], s[64:65], v[248:249]
    v_lshlrev_b32 v250, 16, v223
    v_and_b32 v251, 0xffff0000, v223
    v_pk_fma_f32 v[150:151], v[150:151], s[64:65], v[250:251]
    s_waitcnt vmcnt(10)
    v_lshlrev_b32 v248, 16, v152
    v_and_b32 v249, 0xffff0000, v152
    v_lshlrev_b32 v250, 16, v156
    v_and_b32 v251, 0xffff0000, v156
    v_pk_add_f32 v[248:249], v[248:249], v[250:251]
    v_pk_fma_f32 v[24:25], v[248:249], s[64:65], v[24:25]
    v_cvt_pk_bf16_f32 v12, v24, v25
    v_lshlrev_b32 v252, 16, v153
    v_and_b32 v253, 0xffff0000, v153
    v_lshlrev_b32 v254, 16, v157
    v_and_b32 v255, 0xffff0000, v157
    v_pk_add_f32 v[252:253], v[252:253], v[254:255]
    v_pk_fma_f32 v[26:27], v[252:253], s[64:65], v[26:27]
    v_cvt_pk_bf16_f32 v13, v26, v27
    v_lshlrev_b32 v248, 16, v154
    v_and_b32 v249, 0xffff0000, v154
    v_lshlrev_b32 v250, 16, v158
    v_and_b32 v251, 0xffff0000, v158
    v_pk_add_f32 v[248:249], v[248:249], v[250:251]
    v_pk_fma_f32 v[40:41], v[248:249], s[64:65], v[40:41]
    v_cvt_pk_bf16_f32 v14, v40, v41
    v_lshlrev_b32 v252, 16, v155
    v_and_b32 v253, 0xffff0000, v155
    v_lshlrev_b32 v254, 16, v159
    v_and_b32 v255, 0xffff0000, v159
    v_pk_add_f32 v[252:253], v[252:253], v[254:255]
    v_pk_fma_f32 v[42:43], v[252:253], s[64:65], v[42:43]
    v_cvt_pk_bf16_f32 v15, v42, v43
    v_permlane16_swap_b32 v12, v14
    s_nop 0
    v_permlane16_swap_b32 v13, v15
    s_add_u32 s37, s56, 0
    buffer_store_dwordx4 v[12:15], v9, s[24:27], s37 offen offset:0 nt
    s_waitcnt vmcnt(9)
    v_lshlrev_b32 v248, 16, v164
    v_and_b32 v249, 0xffff0000, v164
    v_lshlrev_b32 v250, 16, v168
    v_and_b32 v251, 0xffff0000, v168
    v_pk_add_f32 v[248:249], v[248:249], v[250:251]
    v_pk_fma_f32 v[120:121], v[248:249], s[64:65], v[120:121]
    v_cvt_pk_bf16_f32 v16, v120, v121
    v_lshlrev_b32 v252, 16, v165
    v_and_b32 v253, 0xffff0000, v165
    v_lshlrev_b32 v254, 16, v169
    v_and_b32 v255, 0xffff0000, v169
    v_pk_add_f32 v[252:253], v[252:253], v[254:255]
    v_pk_fma_f32 v[122:123], v[252:253], s[64:65], v[122:123]
    v_cvt_pk_bf16_f32 v17, v122, v123
    v_lshlrev_b32 v248, 16, v166
    v_and_b32 v249, 0xffff0000, v166
    v_lshlrev_b32 v250, 16, v170
    v_and_b32 v251, 0xffff0000, v170
    v_pk_add_f32 v[248:249], v[248:249], v[250:251]
    v_pk_fma_f32 v[136:137], v[248:249], s[64:65], v[136:137]
    v_cvt_pk_bf16_f32 v18, v136, v137
    v_lshlrev_b32 v252, 16, v167
    v_and_b32 v253, 0xffff0000, v167
    v_lshlrev_b32 v254, 16, v171
    v_and_b32 v255, 0xffff0000, v171
    v_pk_add_f32 v[252:253], v[252:253], v[254:255]
    v_pk_fma_f32 v[138:139], v[252:253], s[64:65], v[138:139]
    v_cvt_pk_bf16_f32 v19, v138, v139
    v_permlane16_swap_b32 v16, v18
    s_nop 0
    v_permlane16_swap_b32 v17, v19
    s_add_u32 s37, s56, 0
    buffer_store_dwordx4 v[16:19], v9, s[24:27], s37 offen offset:192 nt
    s_waitcnt vmcnt(8)
    v_lshlrev_b32 v248, 16, v176
    v_and_b32 v249, 0xffff0000, v176
    v_lshlrev_b32 v250, 16, v180
    v_and_b32 v251, 0xffff0000, v180
    v_pk_add_f32 v[248:249], v[248:249], v[250:251]
    v_pk_fma_f32 v[92:93], v[248:249], s[64:65], v[92:93]
    v_cvt_pk_bf16_f32 v12, v92, v93
    v_lshlrev_b32 v252, 16, v177
    v_and_b32 v253, 0xffff0000, v177
    v_lshlrev_b32 v254, 16, v181
    v_and_b32 v255, 0xffff0000, v181
    v_pk_add_f32 v[252:253], v[252:253], v[254:255]
    v_pk_fma_f32 v[94:95], v[252:253], s[64:65], v[94:95]
    v_cvt_pk_bf16_f32 v13, v94, v95
    v_lshlrev_b32 v248, 16, v178
    v_and_b32 v249, 0xffff0000, v178
    v_lshlrev_b32 v250, 16, v182
    v_and_b32 v251, 0xffff0000, v182
    v_pk_add_f32 v[248:249], v[248:249], v[250:251]
    v_pk_fma_f32 v[108:109], v[248:249], s[64:65], v[108:109]
    v_cvt_pk_bf16_f32 v14, v108, v109
    v_lshlrev_b32 v252, 16, v179
    v_and_b32 v253, 0xffff0000, v179
    v_lshlrev_b32 v254, 16, v183
    v_and_b32 v255, 0xffff0000, v183
    v_pk_add_f32 v[252:253], v[252:253], v[254:255]
    v_pk_fma_f32 v[110:111], v[252:253], s[64:65], v[110:111]
    v_cvt_pk_bf16_f32 v15, v110, v111
    v_permlane16_swap_b32 v12, v14
    s_nop 0
    v_permlane16_swap_b32 v13, v15
    s_add_u32 s37, s56, 32768
    buffer_store_dwordx4 v[12:15], v9, s[24:27], s37 offen offset:128 nt
    s_waitcnt vmcnt(7)
    v_lshlrev_b32 v248, 16, v188
    v_and_b32 v249, 0xffff0000, v188
    v_lshlrev_b32 v250, 16, v192
    v_and_b32 v251, 0xffff0000, v192
    v_pk_add_f32 v[248:249], v[248:249], v[250:251]
    v_pk_fma_f32 v[64:65], v[248:249], s[64:65], v[64:65]
    v_cvt_pk_bf16_f32 v16, v64, v65
    v_lshlrev_b32 v252, 16, v189
    v_and_b32 v253, 0xffff0000, v189
    v_lshlrev_b32 v254, 16, v193
    v_and_b32 v255, 0xffff0000, v193
    v_pk_add_f32 v[252:253], v[252:253], v[254:255]
    v_pk_fma_f32 v[66:67], v[252:253], s[64:65], v[66:67]
    v_cvt_pk_bf16_f32 v17, v66, v67
    v_lshlrev_b32 v248, 16, v190
    v_and_b32 v249, 0xffff0000, v190
    v_lshlrev_b32 v250, 16, v194
    v_and_b32 v251, 0xffff0000, v194
    v_pk_add_f32 v[248:249], v[248:249], v[250:251]
    v_pk_fma_f32 v[80:81], v[248:249], s[64:65], v[80:81]
    v_cvt_pk_bf16_f32 v18, v80, v81
    v_lshlrev_b32 v252, 16, v191
    v_and_b32 v253, 0xffff0000, v191
    v_lshlrev_b32 v254, 16, v195
    v_and_b32 v255, 0xffff0000, v195
    v_pk_add_f32 v[252:253], v[252:253], v[254:255]
    v_pk_fma_f32 v[82:83], v[252:253], s[64:65], v[82:83]
    v_cvt_pk_bf16_f32 v19, v82, v83
    v_permlane16_swap_b32 v16, v18
    s_nop 0
    v_permlane16_swap_b32 v17, v19
    s_add_u32 s37, s56, 65536
    buffer_store_dwordx4 v[16:19], v9, s[24:27], s37 offen offset:64 nt
    s_waitcnt vmcnt(6)
    v_lshlrev_b32 v248, 16, v200
    v_and_b32 v249, 0xffff0000, v200
    v_lshlrev_b32 v250, 16, v204
    v_and_b32 v251, 0xffff0000, v204
    v_pk_add_f32 v[248:249], v[248:249], v[250:251]
    v_pk_fma_f32 v[36:37], v[248:249], s[64:65], v[36:37]
    v_cvt_pk_bf16_f32 v12, v36, v37
    v_lshlrev_b32 v252, 16, v201
    v_and_b32 v253, 0xffff0000, v201
    v_lshlrev_b32 v254, 16, v205
    v_and_b32 v255, 0xffff0000, v205
    v_pk_add_f32 v[252:253], v[252:253], v[254:255]
    v_pk_fma_f32 v[38:39], v[252:253], s[64:65], v[38:39]
    v_cvt_pk_bf16_f32 v13, v38, v39
    v_lshlrev_b32 v248, 16, v202
    v_and_b32 v249, 0xffff0000, v202
    v_lshlrev_b32 v250, 16, v206
    v_and_b32 v251, 0xffff0000, v206
    v_pk_add_f32 v[248:249], v[248:249], v[250:251]
    v_pk_fma_f32 v[52:53], v[248:249], s[64:65], v[52:53]
    v_cvt_pk_bf16_f32 v14, v52, v53
    v_lshlrev_b32 v252, 16, v203
    v_and_b32 v253, 0xffff0000, v203
    v_lshlrev_b32 v254, 16, v207
    v_and_b32 v255, 0xffff0000, v207
    v_pk_add_f32 v[252:253], v[252:253], v[254:255]
    v_pk_fma_f32 v[54:55], v[252:253], s[64:65], v[54:55]
    v_cvt_pk_bf16_f32 v15, v54, v55
    v_permlane16_swap_b32 v12, v14
    s_nop 0
    v_permlane16_swap_b32 v13, v15
    s_add_u32 s37, s56, 98304
    buffer_store_dwordx4 v[12:15], v9, s[24:27], s37 offen offset:0 nt
    s_waitcnt vmcnt(5)
    v_lshlrev_b32 v248, 16, v212
    v_and_b32 v249, 0xffff0000, v212
    v_lshlrev_b32 v250, 16, v216
    v_and_b32 v251, 0xffff0000, v216
    v_pk_add_f32 v[248:249], v[248:249], v[250:251]
    v_pk_fma_f32 v[132:133], v[248:249], s[64:65], v[132:133]
    v_cvt_pk_bf16_f32 v16, v132, v133
    v_lshlrev_b32 v252, 16, v213
    v_and_b32 v253, 0xffff0000, v213
    v_lshlrev_b32 v254, 16, v217
    v_and_b32 v255, 0xffff0000, v217
    v_pk_add_f32 v[252:253], v[252:253], v[254:255]
    v_pk_fma_f32 v[134:135], v[252:253], s[64:65], v[134:135]
    v_cvt_pk_bf16_f32 v17, v134, v135
    v_lshlrev_b32 v248, 16, v214
    v_and_b32 v249, 0xffff0000, v214
    v_lshlrev_b32 v250, 16, v218
    v_and_b32 v251, 0xffff0000, v218
    v_pk_add_f32 v[248:249], v[248:249], v[250:251]
    v_pk_fma_f32 v[148:149], v[248:249], s[64:65], v[148:149]
    v_cvt_pk_bf16_f32 v18, v148, v149
    v_lshlrev_b32 v252, 16, v215
    v_and_b32 v253, 0xffff0000, v215
    v_lshlrev_b32 v254, 16, v219
    v_and_b32 v255, 0xffff0000, v219
    v_pk_add_f32 v[252:253], v[252:253], v[254:255]
    v_pk_fma_f32 v[150:151], v[252:253], s[64:65], v[150:151]
    v_cvt_pk_bf16_f32 v19, v150, v151
    v_permlane16_swap_b32 v16, v18
    s_nop 0
    v_permlane16_swap_b32 v17, v19
    s_add_u32 s37, s56, 98304
    buffer_store_dwordx4 v[16:19], v9, s[24:27], s37 offen offset:192 nt
L_g2_fin:
    s_endpgm
L_f3_x:
    s_barrier
    s_setprio 1
    v_and_b32 v13, 31, v2
    v_lshrrev_b32 v14, 5, v2
    v_lshlrev_b32 v12, 4, v2
    s_lshl_b32 s3, s14, 1
    s_add_u32 s3, s3, s17
    s_add_u32 s2, s3, 32
    v_lshlrev_b32 v4, 7, v13
    s_mov_b32 s44, 15052800
    s_mov_b32 s83, 0x20000
L_f3_wp:
    buffer_load_dword v9, v4, s[28:31], s44 offen sc1
    s_waitcnt vmcnt(0)
L_f3_wp_w:
    v_cmp_ne_u32 vcc, s74, v9
    s_nop 0
    s_mov_b64 s[80:81], vcc
    s_cmp_eq_u64 s[80:81], 0
    s_cbranch_scc1 L_f3_wp_ok
    s_sleep 8
    s_sub_u32 s83, s83, 1
    s_cmp_lg_u32 s83, 0
    s_cbranch_scc1 L_f3_wp
L_f3_wp_ok:
    s_lshl_b32 s37, s16, 13
    s_lshl_b32 s38, s3, 17
    s_add_u32 s38, s38, 16842752
    s_add_u32 s38, s38, s37
    s_sub_u32 s37, s37, 0x8000
    s_add_u32 m0, s37, 0
    s_add_u32 s39, s38, 0
    buffer_load_dwordx4 v12, s[28:31], s39 offen offset:0 sc1 lds
    buffer_load_dwordx4 v12, s[28:31], s39 offen offset:1024 sc1 lds
    buffer_load_dwordx4 v12, s[28:31], s39 offen offset:2048 sc1 lds
    buffer_load_dwordx4 v12, s[28:31], s39 offen offset:3072 sc1 lds
    s_add_u32 m0, s37, 4096
    s_add_u32 s39, s38, 4096
    buffer_load_dwordx4 v12, s[28:31], s39 offen offset:0 sc1 lds
    buffer_load_dwordx4 v12, s[28:31], s39 offen offset:1024 sc1 lds
    buffer_load_dwordx4 v12, s[28:31], s39 offen offset:2048 sc1 lds
    buffer_load_dwordx4 v12, s[28:31], s39 offen offset:3072 sc1 lds
    s_lshl_b32 s36, s3, 4
    s_add_u32 s36, s36, s16
    s_add_u32 s36, s36, 8
    s_lshl_b32 s39, s36, 13
    s_add_u32 s39, s39, 20971520
    s_add_u32 s40, s39, 4096
    buffer_load_dwordx4 v[136:139], v12, s[28:31], s39 offen offset:0 sc1
    buffer_load_dwordx4 v[140:143], v12, s[28:31], s39 offen offset:1024 sc1
    buffer_load_dwordx4 v[144:147], v12, s[28:31], s39 offen offset:2048 sc1
    buffer_load_dwordx4 v[148:151], v12, s[28:31], s39 offen offset:3072 sc1
    buffer_load_dwordx4 v[152:155], v12, s[28:31], s40 offen offset:0 sc1
    buffer_load_dwordx4 v[156:159], v12, s[28:31], s40 offen offset:1024 sc1
    buffer_load_dwordx4 v[160:163], v12, s[28:31], s40 offen offset:2048 sc1
    buffer_load_dwordx4 v[164:167], v12, s[28:31], s40 offen offset:3072 sc1
    v_cvt_f32_u32 v10, v13
    v_mul_u32_u24 v11, v13, v14
    v_cvt_f32_u32 v11, v11
    v_mul_f32 v11, 0x3e000000, v11
    v_mov_b32 v168, v11
    v_fmamk_f32 v169, v10, 0x3d000000, v11
    v_fmamk_f32 v170, v10, 0x3d800000, v11
    v_fmamk_f32 v171, v10, 0x3dc00000, v11
    v_fmamk_f32 v172, v10, 0x3e800000, v11
    v_fmamk_f32 v173, v10, 0x3e900000, v11
    v_fmamk_f32 v174, v10, 0x3ea00000, v11
    v_fmamk_f32 v175, v10, 0x3eb00000, v11
    v_fmamk_f32 v176, v10, 0x3f000000, v11
    v_fmamk_f32 v177, v10, 0x3f080000, v11
    v_fmamk_f32 v178, v10, 0x3f100000, v11
    v_fmamk_f32 v179, v10, 0x3f180000, v11
    v_fmamk_f32 v180, v10, 0x3f400000, v11
    v_fmamk_f32 v181, v10, 0x3f480000, v11
    v_fmamk_f32 v182, v10, 0x3f500000, v11
    v_fmamk_f32 v183, v10, 0x3f580000, v11
    v_fract_f32 v168, v168
    v_fract_f32 v169, v169
    v_fract_f32 v170, v170
    v_fract_f32 v171, v171
    v_fract_f32 v172, v172
    v_fract_f32 v173, v173
    v_fract_f32 v174, v174
    v_fract_f32 v175, v175
    v_fract_f32 v176, v176
    v_fract_f32 v177, v177
    v_fract_f32 v178, v178
    v_fract_f32 v179, v179
    v_fract_f32 v180, v180
    v_fract_f32 v181, v181
    v_fract_f32 v182, v182
    v_fract_f32 v183, v183
    v_cos_f32 v184, v168
    v_cos_f32 v185, v169
    v_cos_f32 v186, v170
    v_cos_f32 v187, v171
    v_cos_f32 v188, v172
    v_cos_f32 v189, v173
    v_cos_f32 v190, v174
    v_cos_f32 v191, v175
    v_cos_f32 v192, v176
    v_cos_f32 v193, v177
    v_cos_f32 v194, v178
    v_cos_f32 v195, v179
    v_cos_f32 v196, v180
    v_cos_f32 v197, v181
    v_cos_f32 v198, v182
    v_cos_f32 v199, v183
    v_sin_f32 v200, v168
    v_sin_f32 v201, v169
    v_sin_f32 v202, v170
    v_sin_f32 v203, v171
    v_sin_f32 v204, v172
    v_sin_f32 v205, v173
    v_sin_f32 v206, v174
    v_sin_f32 v207, v175
    v_sin_f32 v208, v176
    v_sin_f32 v209, v177
    v_sin_f32 v210, v178
    v_sin_f32 v211, v179
    v_sin_f32 v212, v180
    v_sin_f32 v213, v181
    v_sin_f32 v214, v182
    v_sin_f32 v215, v183
    v_cvt_pk_bf16_f32 v16, v184, v185
    v_cvt_pk_bf16_f32 v24, v200, v201
    v_cvt_pk_bf16_f32 v32, -v200, -v201
    v_cvt_pk_bf16_f32 v17, v186, v187
    v_cvt_pk_bf16_f32 v25, v202, v203
    v_cvt_pk_bf16_f32 v33, -v202, -v203
    v_cvt_pk_bf16_f32 v18, v188, v189
    v_cvt_pk_bf16_f32 v26, v204, v205
    v_cvt_pk_bf16_f32 v34, -v204, -v205
    v_cvt_pk_bf16_f32 v19, v190, v191
    v_cvt_pk_bf16_f32 v27, v206, v207
    v_cvt_pk_bf16_f32 v35, -v206, -v207
    v_cvt_pk_bf16_f32 v20, v192, v193
    v_cvt_pk_bf16_f32 v28, v208, v209
    v_cvt_pk_bf16_f32 v36, -v208, -v209
    v_cvt_pk_bf16_f32 v21, v194, v195
    v_cvt_pk_bf16_f32 v29, v210, v211
    v_cvt_pk_bf16_f32 v37, -v210, -v211
    v_cvt_pk_bf16_f32 v22, v196, v197
    v_cvt_pk_bf16_f32 v30, v212, v213
    v_cvt_pk_bf16_f32 v38, -v212, -v213
    v_cvt_pk_bf16_f32 v23, v198, v199
    v_cvt_pk_bf16_f32 v31, v214, v215
    v_cvt_pk_bf16_f32 v39, -v214, -v215
    v_cvt_f32_u32 v10, v13
    v_mul_u32_u24 v11, v13, v14
    v_cvt_f32_u32 v11, v11
    v_mul_f32 v11, 0x3b800000, v11
    v_mov_b32 v56, v11
    v_fmamk_f32 v57, v10, 0x3a800000, v11
    v_fmamk_f32 v58, v10, 0x3b000000, v11
    v_fmamk_f32 v59, v10, 0x3b400000, v11
    v_fmamk_f32 v60, v10, 0x3c000000, v11
    v_fmamk_f32 v61, v10, 0x3c100000, v11
    v_fmamk_f32 v62, v10, 0x3c200000, v11
    v_fmamk_f32 v63, v10, 0x3c300000, v11
    v_fmamk_f32 v64, v10, 0x3c800000, v11
    v_fmamk_f32 v65, v10, 0x3c880000, v11
    v_fmamk_f32 v66, v10, 0x3c900000, v11
    v_fmamk_f32 v67, v10, 0x3c980000, v11
    v_fmamk_f32 v68, v10, 0x3cc00000, v11
    v_fmamk_f32 v69, v10, 0x3cc80000, v11
    v_fmamk_f32 v70, v10, 0x3cd00000, v11
    v_fmamk_f32 v71, v10, 0x3cd80000, v11
    v_cos_f32 v40, v56
    v_cos_f32 v41, v57
    v_cos_f32 v42, v58
    v_cos_f32 v43, v59
    v_cos_f32 v44, v60
    v_cos_f32 v45, v61
    v_cos_f32 v46, v62
    v_cos_f32 v47, v63
    v_cos_f32 v48, v64
    v_cos_f32 v49, v65
    v_cos_f32 v50, v66
    v_cos_f32 v51, v67
    v_cos_f32 v52, v68
    v_cos_f32 v53, v69
    v_cos_f32 v54, v70
    v_cos_f32 v55, v71
    v_sin_f32 v56, v56
    v_sin_f32 v57, v57
    v_sin_f32 v58, v58
    v_sin_f32 v59, v59
    v_sin_f32 v60, v60
    v_sin_f32 v61, v61
    v_sin_f32 v62, v62
    v_sin_f32 v63, v63
    v_sin_f32 v64, v64
    v_sin_f32 v65, v65
    v_sin_f32 v66, v66
    v_sin_f32 v67, v67
    v_sin_f32 v68, v68
    v_sin_f32 v69, v69
    v_sin_f32 v70, v70
    v_sin_f32 v71, v71
    v_lshl_add_u32 v10, v14, 7, v13
    v_cvt_f32_u32 v10, v10
    v_mul_f32 v10, 0x3a000000, v10
    v_add_f32 v88, 0x0, v10
    v_add_f32 v89, 0x3c800000, v10
    v_add_f32 v90, 0x3d000000, v10
    v_add_f32 v91, 0x3d400000, v10
    v_add_f32 v92, 0x3e000000, v10
    v_add_f32 v93, 0x3e100000, v10
    v_add_f32 v94, 0x3e200000, v10
    v_add_f32 v95, 0x3e300000, v10
    v_add_f32 v96, 0x3e800000, v10
    v_add_f32 v97, 0x3e880000, v10
    v_add_f32 v98, 0x3e900000, v10
    v_add_f32 v99, 0x3e980000, v10
    v_add_f32 v100, 0x3ec00000, v10
    v_add_f32 v101, 0x3ec80000, v10
    v_add_f32 v102, 0x3ed00000, v10
    v_add_f32 v103, 0x3ed80000, v10
    v_cos_f32 v72, v88
    v_cos_f32 v73, v89
    v_cos_f32 v74, v90
    v_cos_f32 v75, v91
    v_cos_f32 v76, v92
    v_cos_f32 v77, v93
    v_cos_f32 v78, v94
    v_cos_f32 v79, v95
    v_cos_f32 v80, v96
    v_cos_f32 v81, v97
    v_cos_f32 v82, v98
    v_cos_f32 v83, v99
    v_cos_f32 v84, v100
    v_cos_f32 v85, v101
    v_cos_f32 v86, v102
    v_cos_f32 v87, v103
    v_sin_f32 v88, v88
    v_sin_f32 v89, v89
    v_sin_f32 v90, v90
    v_sin_f32 v91, v91
    v_sin_f32 v92, v92
    v_sin_f32 v93, v93
    v_sin_f32 v94, v94
    v_sin_f32 v95, v95
    v_sin_f32 v96, v96
    v_sin_f32 v97, v97
    v_sin_f32 v98, v98
    v_sin_f32 v99, v99
    v_sin_f32 v100, v100
    v_sin_f32 v101, v101
    v_sin_f32 v102, v102
    v_sin_f32 v103, v103
    v_lshrrev_b32 v4, 1, v13
    v_and_b32 v5, 7, v4
    s_and_b32 s41, s16, 3
    s_lshl_b32 s42, s41, 1
    v_xor_b32 v5, s42, v5
    v_lshlrev_b32 v5, 4, v5
    v_lshl_add_u32 v5, v4, 11, v5
    v_lshl_add_u32 v5, v14, 8, v5
    v_and_b32 v4, 1, v2
    v_lshl_add_u32 v5, v4, 7, v5
    s_lshr_b32 s42, s16, 2
    s_lshl_b32 s42, s42, 15
    v_add_u32 v5, s42, v5
    v_xor_b32 v6, 16, v5
    s_mul_i32 s41, s16, 8192
    s_add_u32 s41, s41, 65536
    v_add_u32 v7, s41, v12
    v_xor_b32 v15, 64, v7
    s_bfe_u32 s41, s3, 0x30001
    v_and_b32 v4, 7, v0
    v_xor_b32 v8, s41, v4
    v_and_b32 v10, 1, v8
    v_mul_u32_u24 v10, 4160, v10
    v_lshrrev_b32 v9, 5, v0
    v_lshlrev_b32 v11, 6, v9
    v_xor_b32 v10, v10, v11
    v_lshrrev_b32 v8, 1, v8
    v_lshl_add_u32 v10, v8, 4, v10
    v_bfe_u32 v8, v0, 3, 2
    v_lshl_add_u32 v10, v8, 2, v10
    v_add_u32 v10, 65536, v10
    v_lshlrev_b32 v11, 17, v8
    v_and_b32 v8, 7, v9
    v_lshl_add_u32 v11, v8, 14, v11
    v_lshrrev_b32 v8, 3, v9
    v_lshl_add_u32 v11, v8, 19, v11
    v_lshl_add_u32 v11, v4, 4, v11
    v_add_u32 v8, 32768, v10
    v_mov_b32 v10, v8
    s_lshl_b32 s45, s3, 7
    s_add_u32 s45, s45, 25178112
    s_lshl_b32 s37, s16, 13
    s_mov_b32 s17, 1
    v_subrev_u32 v5, 0x8000, v5
    v_subrev_u32 v6, 0x8000, v6
    s_waitcnt vmcnt(0)
    v_lshlrev_b32 v248, 2, v1
    v_add_u32 v248, 163776, v248
    v_mov_b32 v249, 3
    s_waitcnt lgkmcnt(0)
    ds_write_b32 v248, v249
    v_and_b32 v250, 3, v2
    v_and_b32 v251, 4, v1
    v_or_b32 v250, v250, v251
    v_lshlrev_b32 v250, 2, v250
    v_add_u32 v250, 163776, v250
    s_mov_b32 s83, 0x400000
L_fs_z:
    ds_read_b32 v251, v250
    s_sub_u32 s83, s83, 1
    s_cmp_eq_u32 s83, 0
    s_cbranch_scc1 L_fs_zx
    s_waitcnt lgkmcnt(0)
    v_cmp_gt_u32 vcc, 3, v251
    s_nop 4
    s_cbranch_vccnz L_fs_z
L_fs_zx:
    s_branch L_f2_round
L_f3_x2:
    v_and_b32 v13, 31, v2
    v_lshrrev_b32 v14, 5, v2
    v_lshlrev_b32 v12, 4, v2
    s_lshl_b32 s3, s14, 1
    s_add_u32 s3, s3, s17
    s_add_u32 s2, s3, 32
    v_cvt_f32_u32 v10, v13
    v_mul_u32_u24 v11, v13, v14
    v_cvt_f32_u32 v11, v11
    v_mul_f32 v11, 0x3e000000, v11
    v_mov_b32 v168, v11
    v_fmamk_f32 v169, v10, 0x3d000000, v11
    v_fmamk_f32 v170, v10, 0x3d800000, v11
    v_fmamk_f32 v171, v10, 0x3dc00000, v11
    v_fmamk_f32 v172, v10, 0x3e800000, v11
    v_fmamk_f32 v173, v10, 0x3e900000, v11
    v_fmamk_f32 v174, v10, 0x3ea00000, v11
    v_fmamk_f32 v175, v10, 0x3eb00000, v11
    v_fmamk_f32 v176, v10, 0x3f000000, v11
    v_fmamk_f32 v177, v10, 0x3f080000, v11
    v_fmamk_f32 v178, v10, 0x3f100000, v11
    v_fmamk_f32 v179, v10, 0x3f180000, v11
    v_fmamk_f32 v180, v10, 0x3f400000, v11
    v_fmamk_f32 v181, v10, 0x3f480000, v11
    v_fmamk_f32 v182, v10, 0x3f500000, v11
    v_fmamk_f32 v183, v10, 0x3f580000, v11
    v_fract_f32 v168, v168
    v_fract_f32 v169, v169
    v_fract_f32 v170, v170
    v_fract_f32 v171, v171
    v_fract_f32 v172, v172
    v_fract_f32 v173, v173
    v_fract_f32 v174, v174
    v_fract_f32 v175, v175
    v_fract_f32 v176, v176
    v_fract_f32 v177, v177
    v_fract_f32 v178, v178
    v_fract_f32 v179, v179
    v_fract_f32 v180, v180
    v_fract_f32 v181, v181
    v_fract_f32 v182, v182
    v_fract_f32 v183, v183
    v_cos_f32 v184, v168
    v_cos_f32 v185, v169
    v_cos_f32 v186, v170
    v_cos_f32 v187, v171
    v_cos_f32 v188, v172
    v_cos_f32 v189, v173
    v_cos_f32 v190, v174
    v_cos_f32 v191, v175
    v_cos_f32 v192, v176
    v_cos_f32 v193, v177
    v_cos_f32 v194, v178
    v_cos_f32 v195, v179
    v_cos_f32 v196, v180
    v_cos_f32 v197, v181
    v_cos_f32 v198, v182
    v_cos_f32 v199, v183
    v_sin_f32 v200, v168
    v_sin_f32 v201, v169
    v_sin_f32 v202, v170
    v_sin_f32 v203, v171
    v_sin_f32 v204, v172
    v_sin_f32 v205, v173
    v_sin_f32 v206, v174
    v_sin_f32 v207, v175
    v_sin_f32 v208, v176
    v_sin_f32 v209, v177
    v_sin_f32 v210, v178
    v_sin_f32 v211, v179
    v_sin_f32 v212, v180
    v_sin_f32 v213, v181
    v_sin_f32 v214, v182
    v_sin_f32 v215, v183
    v_cvt_pk_bf16_f32 v16, v184, v185
    v_cvt_pk_bf16_f32 v32, -v200, -v201
    v_cvt_pk_bf16_f32 v17, v186, v187
    v_cvt_pk_bf16_f32 v33, -v202, -v203
    v_cvt_pk_bf16_f32 v18, v188, v189
    v_cvt_pk_bf16_f32 v34, -v204, -v205
    v_cvt_pk_bf16_f32 v19, v190, v191
    v_cvt_pk_bf16_f32 v35, -v206, -v207
    v_cvt_pk_bf16_f32 v20, v192, v193
    v_cvt_pk_bf16_f32 v36, -v208, -v209
    v_cvt_pk_bf16_f32 v21, v194, v195
    v_cvt_pk_bf16_f32 v37, -v210, -v211
    v_cvt_pk_bf16_f32 v22, v196, v197
    v_cvt_pk_bf16_f32 v38, -v212, -v213
    v_cvt_pk_bf16_f32 v23, v198, v199
    v_cvt_pk_bf16_f32 v39, -v214, -v215
    s_waitcnt vmcnt(0)
    v_mov_b32 v8, s74
    v_mov_b32 v9, 0
    s_mov_b64 exec, 1
    buffer_store_dword v8, v9, s[28:31], s75 offen sc1
    s_mov_b64 exec, -1
    v_cvt_f32_u32 v10, v13
    v_mul_u32_u24 v11, v13, v14
    v_cvt_f32_u32 v11, v11
    v_mul_f32 v11, 0x3b800000, v11
    v_mov_b32 v56, v11
    v_fmamk_f32 v57, v10, 0x3a800000, v11
    v_fmamk_f32 v58, v10, 0x3b000000, v11
    v_fmamk_f32 v59, v10, 0x3b400000, v11
    v_fmamk_f32 v60, v10, 0x3c000000, v11
    v_fmamk_f32 v61, v10, 0x3c100000, v11
    v_fmamk_f32 v62, v10, 0x3c200000, v11
    v_fmamk_f32 v63, v10, 0x3c300000, v11
    v_fmamk_f32 v64, v10, 0x3c800000, v11
    v_fmamk_f32 v65, v10, 0x3c880000, v11
    v_fmamk_f32 v66, v10, 0x3c900000, v11
    v_fmamk_f32 v67, v10, 0x3c980000, v11
    v_fmamk_f32 v68, v10, 0x3cc00000, v11
    v_fmamk_f32 v69, v10, 0x3cc80000, v11
    v_fmamk_f32 v70, v10, 0x3cd00000, v11
    v_fmamk_f32 v71, v10, 0x3cd80000, v11
    v_cos_f32 v40, v56
    v_cos_f32 v41, v57
    v_cos_f32 v42, v58
    v_cos_f32 v43, v59
    v_cos_f32 v44, v60
    v_cos_f32 v45, v61
    v_cos_f32 v46, v62
    v_cos_f32 v47, v63
    v_cos_f32 v48, v64
    v_cos_f32 v49, v65
    v_cos_f32 v50, v66
    v_cos_f32 v51, v67
    v_cos_f32 v52, v68
    v_cos_f32 v53, v69
    v_cos_f32 v54, v70
    v_cos_f32 v55, v71
    v_sin_f32 v56, v56
    v_sin_f32 v57, v57
    v_sin_f32 v58, v58
    v_sin_f32 v59, v59
    v_sin_f32 v60, v60
    v_sin_f32 v61, v61
    v_sin_f32 v62, v62
    v_sin_f32 v63, v63
    v_sin_f32 v64, v64
    v_sin_f32 v65, v65
    v_sin_f32 v66, v66
    v_sin_f32 v67, v67
    v_sin_f32 v68, v68
    v_sin_f32 v69, v69
    v_sin_f32 v70, v70
    v_sin_f32 v71, v71
    s_lshl_b32 s37, s16, 13
    s_lshl_b32 s46, s2, 16
    v_and_b32 v250, 3, v2
    v_lshlrev_b32 v250, 2, v250
    v_add_u32 v250, 163792, v250
    s_mov_b32 s83, 0x400000
L_fs_c:
    ds_read_b32 v251, v250
    s_sub_u32 s83, s83, 1
    s_cmp_eq_u32 s83, 0
    s_cbranch_scc1 L_fs_cx
    s_waitcnt lgkmcnt(0)
    v_cmp_gt_u32 vcc, 6, v251
    s_nop 4
    s_cbranch_vccnz L_fs_c
L_fs_cx:
    s_branch L_f3_w
L_f3_t:
    s_lshl_b32 s46, s2, 16
    s_waitcnt vmcnt(0)
    s_cmp_ge_u32 s2, 32
    s_cbranch_scc1 L_fs_dl
    s_waitcnt lgkmcnt(0)
    s_barrier
    s_branch L_fs_dx
L_fs_dl:
    v_lshlrev_b32 v248, 2, v1
    v_add_u32 v248, 163776, v248
    v_mov_b32 v249, 6
    s_waitcnt lgkmcnt(0)
    ds_write_b32 v248, v249
    v_and_b32 v250, 3, v2
    v_and_b32 v251, 4, v1
    v_or_b32 v250, v250, v251
    v_lshlrev_b32 v250, 2, v250
    v_add_u32 v250, 163776, v250
    s_mov_b32 s83, 0x400000
L_fs_d:
    ds_read_b32 v251, v250
    s_sub_u32 s83, s83, 1
    s_cmp_eq_u32 s83, 0
    s_cbranch_scc1 L_fs_dx
    s_waitcnt lgkmcnt(0)
    v_cmp_gt_u32 vcc, 6, v251
    s_nop 4
    s_cbranch_vccnz L_fs_d
L_fs_dx:
    s_setprio 0
    s_cmp_lg_u32 s16, 4
    s_cbranch_scc1 L_f3_w
    s_lshl_b32 s41, s2, 7
    s_add_u32 s41, s41, 15138816
    v_mov_b32 v8, s74
    v_mov_b32 v9, 0
    s_mov_b64 exec, 1
    buffer_store_dword v8, v9, s[28:31], s41 offen sc1
    s_mov_b64 exec, -1
L_f3_w:
    s_mov_b32 s42, 0x35800000
    v_mul_f32 v40, s42, v40
    v_mul_f32 v41, s42, v41
    v_mul_f32 v42, s42, v42
    v_mul_f32 v43, s42, v43
    v_mul_f32 v44, s42, v44
    v_mul_f32 v45, s42, v45
    v_mul_f32 v46, s42, v46
    v_mul_f32 v47, s42, v47
    v_mul_f32 v48, s42, v48
    v_mul_f32 v49, s42, v49
    v_mul_f32 v50, s42, v50
    v_mul_f32 v51, s42, v51
    v_mul_f32 v52, s42, v52
    v_mul_f32 v53, s42, v53
    v_mul_f32 v54, s42, v54
    v_mul_f32 v55, s42, v55
    v_mul_f32 v56, s42, v56
    v_mul_f32 v57, s42, v57
    v_mul_f32 v58, s42, v58
    v_mul_f32 v59, s42, v59
    v_mul_f32 v60, s42, v60
    v_mul_f32 v61, s42, v61
    v_mul_f32 v62, s42, v62
    v_mul_f32 v63, s42, v63
    v_mul_f32 v64, s42, v64
    v_mul_f32 v65, s42, v65
    v_mul_f32 v66, s42, v66
    v_mul_f32 v67, s42, v67
    v_mul_f32 v68, s42, v68
    v_mul_f32 v69, s42, v69
    v_mul_f32 v70, s42, v70
    v_mul_f32 v71, s42, v71
    v_cvt_f32_u32 v10, v13
    v_mul_u32_u24 v11, v13, v14
    v_cvt_f32_u32 v11, v11
    v_mul_f32 v11, 0x3e800000, v11
    v_mov_b32 v104, v11
    v_fmamk_f32 v105, v10, 0x3d000000, v11
    v_fmamk_f32 v106, v10, 0x3d800000, v11
    v_fmamk_f32 v107, v10, 0x3dc00000, v11
    v_fmamk_f32 v108, v10, 0x3e000000, v11
    v_fmamk_f32 v109, v10, 0x3e200000, v11
    v_fmamk_f32 v110, v10, 0x3e400000, v11
    v_fmamk_f32 v111, v10, 0x3e600000, v11
    v_fract_f32 v104, v104
    v_fract_f32 v105, v105
    v_fract_f32 v106, v106
    v_fract_f32 v107, v107
    v_fract_f32 v108, v108
    v_fract_f32 v109, v109
    v_fract_f32 v110, v110
    v_fract_f32 v111, v111
    v_cos_f32 v112, v104
    v_cos_f32 v113, v105
    v_cos_f32 v114, v106
    v_cos_f32 v115, v107
    v_cos_f32 v116, v108
    v_cos_f32 v117, v109
    v_cos_f32 v118, v110
    v_cos_f32 v119, v111
    v_sin_f32 v120, v104
    v_sin_f32 v121, v105
    v_sin_f32 v122, v106
    v_sin_f32 v123, v107
    v_sin_f32 v124, v108
    v_sin_f32 v125, v109
    v_sin_f32 v126, v110
    v_sin_f32 v127, v111
    v_cvt_pk_bf16_f32 v72, v112, -v120
    v_cvt_pk_bf16_f32 v80, v120, v112
    v_cvt_pk_bf16_f32 v73, v113, -v121
    v_cvt_pk_bf16_f32 v81, v121, v113
    v_cvt_pk_bf16_f32 v74, v114, -v122
    v_cvt_pk_bf16_f32 v82, v122, v114
    v_cvt_pk_bf16_f32 v75, v115, -v123
    v_cvt_pk_bf16_f32 v83, v123, v115
    v_cvt_pk_bf16_f32 v76, v116, -v124
    v_cvt_pk_bf16_f32 v84, v124, v116
    v_cvt_pk_bf16_f32 v77, v117, -v125
    v_cvt_pk_bf16_f32 v85, v125, v117
    v_cvt_pk_bf16_f32 v78, v118, -v126
    v_cvt_pk_bf16_f32 v86, v126, v118
    v_cvt_pk_bf16_f32 v79, v119, -v127
    v_cvt_pk_bf16_f32 v87, v127, v119
    v_lshlrev_b32 v10, 2, v14
    v_sub_u32 v10, v13, v10
    v_mov_b32 v11, 0x3f80
    v_mov_b32 v9, 0x3f800000
    v_cmp_eq_u32 vcc, 0, v10
    s_nop 1
    v_cndmask_b32 v24, 0, v11, vcc
    v_cmp_eq_u32 vcc, 1, v10
    s_nop 1
    v_cndmask_b32 v24, v24, v9, vcc
    v_cmp_eq_u32 vcc, 2, v10
    s_nop 1
    v_cndmask_b32 v25, 0, v11, vcc
    v_cmp_eq_u32 vcc, 3, v10
    s_nop 1
    v_cndmask_b32 v25, v25, v9, vcc
    v_cmp_eq_u32 vcc, 8, v10
    s_nop 1
    v_cndmask_b32 v26, 0, v11, vcc
    v_cmp_eq_u32 vcc, 9, v10
    s_nop 1
    v_cndmask_b32 v26, v26, v9, vcc
    v_cmp_eq_u32 vcc, 10, v10
    s_nop 1
    v_cndmask_b32 v27, 0, v11, vcc
    v_cmp_eq_u32 vcc, 11, v10
    s_nop 1
    v_cndmask_b32 v27, v27, v9, vcc
    v_cmp_eq_u32 vcc, 16, v10
    s_nop 1
    v_cndmask_b32 v28, 0, v11, vcc
    v_cmp_eq_u32 vcc, 17, v10
    s_nop 1
    v_cndmask_b32 v28, v28, v9, vcc
    v_cmp_eq_u32 vcc, 18, v10
    s_nop 1
    v_cndmask_b32 v29, 0, v11, vcc
    v_cmp_eq_u32 vcc, 19, v10
    s_nop 1
    v_cndmask_b32 v29, v29, v9, vcc
    v_cmp_eq_u32 vcc, 24, v10
    s_nop 1
    v_cndmask_b32 v30, 0, v11, vcc
    v_cmp_eq_u32 vcc, 25, v10
    s_nop 1
    v_cndmask_b32 v30, v30, v9, vcc
    v_cmp_eq_u32 vcc, 26, v10
    s_nop 1
    v_cndmask_b32 v31, 0, v11, vcc
    v_cmp_eq_u32 vcc, 27, v10
    s_nop 1
    v_cndmask_b32 v31, v31, v9, vcc
    s_add_u32 s40, s46, s37
    v_bfe_u32 v3, v2, 1, 3
    s_and_b32 s38, s16, 1
    s_lshl_b32 s38, s38, 2
    v_xor_b32 v3, s38, v3
    v_lshlrev_b32 v3, 4, v3
    v_lshl_add_u32 v3, v13, 7, v3
    v_lshl_add_u32 v3, v14, 13, v3
    s_lshr_b32 s38, s16, 1
    s_lshl_b32 s38, s38, 14
    s_add_u32 s38, s38, 65536
    v_add_u32 v3, s38, v3
    v_lshlrev_b32 v15, 6, v13
    v_lshl_add_u32 v15, v14, 3, v15
    s_lshl_b32 s39, s16, 13
    s_add_u32 s39, s39, 0
    v_add_u32 v15, s39, v15
    s_and_b32 s39, s16, 3
    s_lshl_b32 s39, s39, 2
    v_and_b32 v4, 7, v2
    v_xor_b32 v4, s39, v4
    v_lshlrev_b32 v4, 4, v4
    v_lshl_add_u32 v4, v13, 10, v4
    v_lshl_add_u32 v4, v14, 8, v4
    s_lshr_b32 s39, s16, 2
    s_lshl_b32 s39, s39, 15
    s_add_u32 s39, s39, 0
    v_add_u32 v4, s39, v4
    v_and_b32 v7, 255, v0
    s_and_b32 s44, s16, 3
    v_xor_b32 v6, s44, v7
    v_lshlrev_b32 v6, 4, v6
    v_add_u32 v6, s39, v6
    v_xor_b32 v11, 64, v6
    v_lshlrev_b32 v7, 4, v7
    v_lshlrev_b32 v10, 31, v2
    v_or_b32 v10, 0.5, v10
    v_cmp_gt_u32 vcc, 32, v2
    s_nop 1
    v_cndmask_b32 v10, 0, v10, vcc
    ds_read2_b64 v[136:139], v15 offset0:0 offset1:2
    ds_read2_b64 v[140:143], v15 offset0:4 offset1:6
    v_add_u32 v15, 2048, v15
    ds_read2_b64 v[144:147], v15 offset0:0 offset1:2
    ds_read2_b64 v[148:151], v15 offset0:4 offset1:6
    v_add_u32 v15, 2048, v15
    ds_read2_b64 v[152:155], v15 offset0:0 offset1:2
    ds_read2_b64 v[156:159], v15 offset0:4 offset1:6
    v_add_u32 v15, 2048, v15
    ds_read2_b64 v[160:163], v15 offset0:0 offset1:2
    ds_read2_b64 v[164:167], v15 offset0:4 offset1:6
    s_lshl_b32 s39, s16, 12
    s_add_u32 s40, s46, s39
    s_cmp_lg_u32 s16, 4
    s_cbranch_scc1 L_f3_w2
    v_lshlrev_b32 v8, 7, v2
    s_mov_b32 s41, 15138816
    s_mov_b32 s83, 0x20000
L_f3_poll:
    buffer_load_dword v9, v8, s[28:31], s41 offen sc1
    s_waitcnt vmcnt(0)
L_f3_poll_w:
    v_cmp_ne_u32 vcc, s74, v9
    s_nop 0
    s_mov_b64 s[80:81], vcc
    s_cmp_eq_u64 s[80:81], 0
    s_cbranch_scc1 L_f3_poll_ok
    s_sleep 6
    s_sub_u32 s83, s83, 1
    s_cmp_lg_u32 s83, 0
    s_cbranch_scc1 L_f3_poll
L_f3_poll_ok:
L_f3_w2:
    s_waitcnt lgkmcnt(0)
    s_barrier
    s_add_u32 m0, s39, 65536
    s_add_u32 s41, s40, 25165824
    buffer_load_dwordx4 v12, s[28:31], s41 offen offset:0 sc1 lds
    buffer_load_dwordx4 v12, s[28:31], s41 offen offset:1024 sc1 lds
    buffer_load_dwordx4 v12, s[28:31], s41 offen offset:2048 sc1 lds
    buffer_load_dwordx4 v12, s[28:31], s41 offen offset:3072 sc1 lds
    s_add_u32 m0, s39, 98304
    s_add_u32 s41, s40, 25198592
    buffer_load_dwordx4 v12, s[28:31], s41 offen offset:0 sc1 lds
    buffer_load_dwordx4 v12, s[28:31], s41 offen offset:1024 sc1 lds
    buffer_load_dwordx4 v12, s[28:31], s41 offen offset:2048 sc1 lds
    buffer_load_dwordx4 v12, s[28:31], s41 offen offset:3072 sc1 lds
    s_waitcnt vmcnt(4)
    s_barrier
    s_cmp_lt_u32 s16, 4
    s_cbranch_scc1 L_f3_ra
    s_waitcnt vmcnt(0)
    s_barrier
L_f3_ra:
    ds_read_b128 v[104:107], v3 offset:0
    ds_read_b128 v[108:111], v3 offset:4096
    v_xor_b32 v9, 16, v3
    ds_read_b128 v[112:115], v9 offset:0
    ds_read_b128 v[116:119], v9 offset:4096
    v_xor_b32 v8, 32, v3
    ds_read_b128 v[120:123], v8 offset:0
    ds_read_b128 v[124:127], v8 offset:4096
    v_xor_b32 v9, 48, v3
    ds_read_b128 v[128:131], v9 offset:0
    ds_read_b128 v[132:135], v9 offset:4096
    s_waitcnt lgkmcnt(0)
    v_readlane_b32 s48, v104, 0
    v_writelane_b32 v104, 0, 0
    s_lshl_b32 s48, s48, 16
    v_readlane_b32 s50, v112, 0
    v_writelane_b32 v112, 0, 0
    s_lshl_b32 s50, s50, 16
    v_readlane_b32 s52, v120, 0
    v_writelane_b32 v120, 0, 0
    s_lshl_b32 s52, s52, 16
    v_readlane_b32 s54, v128, 0
    v_writelane_b32 v128, 0, 0
    s_lshl_b32 s54, s54, 16
    v_mfma_f32_32x32x16_bf16 v[168:183], v[104:107], v[72:75], 0
    v_mfma_f32_32x32x16_bf16 v[168:183], v[108:111], v[76:79], v[168:183]
    v_mfma_f32_32x32x16_bf16 v[184:199], v[104:107], v[80:83], 0
    v_mfma_f32_32x32x16_bf16 v[184:199], v[108:111], v[84:87], v[184:199]
    v_mfma_f32_32x32x16_bf16 v[200:215], v[112:115], v[72:75], 0
    v_mfma_f32_32x32x16_bf16 v[200:215], v[116:119], v[76:79], v[200:215]
    s_nop 7
    v_fmac_f32 v168, s48, v10
    s_nop 0
    v_mul_f32 v232, v184, v56
    v_mul_f32 v233, v185, v57
    v_mul_f32 v234, v168, v56
    v_mul_f32 v235, v169, v57
    v_fma_f32 v232, v168, v40, -v232
    v_fma_f32 v233, v169, v41, -v233
    v_mfma_f32_32x32x16_bf16 v[216:231], v[112:115], v[80:83], 0
    v_fmac_f32 v234, v184, v40
    v_fmac_f32 v235, v185, v41
    v_cvt_pk_bf16_f32 v88, v232, v233
    v_cvt_pk_bf16_f32 v96, v234, v235
    v_mul_f32 v236, v186, v58
    v_mul_f32 v237, v187, v59
    v_mul_f32 v238, v170, v58
    v_mfma_f32_32x32x16_bf16 v[216:231], v[116:119], v[84:87], v[216:231]
    v_mul_f32 v239, v171, v59
    v_fma_f32 v236, v170, v42, -v236
    v_fma_f32 v237, v171, v43, -v237
    v_fmac_f32 v238, v186, v42
    v_fmac_f32 v239, v187, v43
    v_cvt_pk_bf16_f32 v89, v236, v237
    v_cvt_pk_bf16_f32 v97, v238, v239
    v_pk_mul_f32 v[232:233], v[188:189], v[60:61]
    v_pk_mul_f32 v[234:235], v[172:173], v[60:61]
    v_pk_fma_f32 v[232:233], v[172:173], v[44:45], v[232:233] neg_lo:[0,0,1] neg_hi:[0,0,1]
    v_pk_fma_f32 v[234:235], v[188:189], v[44:45], v[234:235]
    v_cvt_pk_bf16_f32 v90, v232, v233
    v_cvt_pk_bf16_f32 v98, v234, v235
    v_pk_mul_f32 v[236:237], v[190:191], v[62:63]
    v_pk_mul_f32 v[238:239], v[174:175], v[62:63]
    v_pk_fma_f32 v[236:237], v[174:175], v[46:47], v[236:237] neg_lo:[0,0,1] neg_hi:[0,0,1]
    v_pk_fma_f32 v[238:239], v[190:191], v[46:47], v[238:239]
    v_cvt_pk_bf16_f32 v91, v236, v237
    v_cvt_pk_bf16_f32 v99, v238, v239
    v_pk_mul_f32 v[232:233], v[192:193], v[64:65]
    v_pk_mul_f32 v[234:235], v[176:177], v[64:65]
    v_pk_fma_f32 v[232:233], v[176:177], v[48:49], v[232:233] neg_lo:[0,0,1] neg_hi:[0,0,1]
    v_pk_fma_f32 v[234:235], v[192:193], v[48:49], v[234:235]
    v_cvt_pk_bf16_f32 v92, v232, v233
    v_cvt_pk_bf16_f32 v100, v234, v235
    v_pk_mul_f32 v[236:237], v[194:195], v[66:67]
    v_pk_mul_f32 v[238:239], v[178:179], v[66:67]
    v_pk_fma_f32 v[236:237], v[178:179], v[50:51], v[236:237] neg_lo:[0,0,1] neg_hi:[0,0,1]
    v_pk_fma_f32 v[238:239], v[194:195], v[50:51], v[238:239]
    v_cvt_pk_bf16_f32 v93, v236, v237
    v_cvt_pk_bf16_f32 v101, v238, v239
    v_pk_mul_f32 v[232:233], v[196:197], v[68:69]
    v_pk_mul_f32 v[234:235], v[180:181], v[68:69]
    v_pk_fma_f32 v[232:233], v[180:181], v[52:53], v[232:233] neg_lo:[0,0,1] neg_hi:[0,0,1]
    v_pk_fma_f32 v[234:235], v[196:197], v[52:53], v[234:235]
    v_cvt_pk_bf16_f32 v94, v232, v233
    v_cvt_pk_bf16_f32 v102, v234, v235
    v_pk_mul_f32 v[236:237], v[198:199], v[70:71]
    v_pk_mul_f32 v[238:239], v[182:183], v[70:71]
    v_pk_fma_f32 v[236:237], v[182:183], v[54:55], v[236:237] neg_lo:[0,0,1] neg_hi:[0,0,1]
    v_pk_fma_f32 v[238:239], v[198:199], v[54:55], v[238:239]
    v_cvt_pk_bf16_f32 v95, v236, v237
    v_cvt_pk_bf16_f32 v103, v238, v239
    s_cmp_ge_u32 s16, 4
    s_cbranch_scc1 L_f3_rb
    s_waitcnt vmcnt(0)
    s_barrier
L_f3_rb:
    v_mfma_f32_32x32x16_bf16 v[168:183], v[24:27], v[136:139], 0
    v_fmac_f32 v200, s50, v10
    v_mul_f32 v232, v216, v56
    v_mul_f32 v233, v217, v57
    v_mul_f32 v234, v200, v56
    v_mul_f32 v235, v201, v57
    v_fma_f32 v232, v200, v40, -v232
    v_mfma_f32_32x32x16_bf16 v[168:183], v[28:31], v[140:143], v[168:183]
    v_fma_f32 v233, v201, v41, -v233
    v_fmac_f32 v234, v216, v40
    v_fmac_f32 v235, v217, v41
    v_cvt_pk_bf16_f32 v104, v232, v233
    v_cvt_pk_bf16_f32 v112, v234, v235
    v_mfma_f32_32x32x16_bf16 v[168:183], v[88:91], v[16:19], v[168:183]
    v_mul_f32 v236, v218, v58
    v_mul_f32 v237, v219, v59
    v_mul_f32 v238, v202, v58
    v_mul_f32 v239, v203, v59
    v_fma_f32 v236, v202, v42, -v236
    v_mfma_f32_32x32x16_bf16 v[168:183], v[92:95], v[20:23], v[168:183]
    v_fma_f32 v237, v203, v43, -v237
    v_fmac_f32 v238, v218, v42
    v_fmac_f32 v239, v219, v43
    v_cvt_pk_bf16_f32 v105, v236, v237
    v_cvt_pk_bf16_f32 v113, v238, v239
    v_mfma_f32_32x32x16_bf16 v[168:183], v[96:99], v[32:35], v[168:183]
    v_mul_f32 v232, v220, v60
    v_mul_f32 v233, v221, v61
    v_mul_f32 v234, v204, v60
    v_mul_f32 v235, v205, v61
    v_fma_f32 v232, v204, v44, -v232
    v_mfma_f32_32x32x16_bf16 v[168:183], v[100:103], v[36:39], v[168:183]
    v_fma_f32 v233, v205, v45, -v233
    v_fmac_f32 v234, v220, v44
    v_fmac_f32 v235, v221, v45
    v_cvt_pk_bf16_f32 v106, v232, v233
    v_cvt_pk_bf16_f32 v114, v234, v235
    v_pk_mul_f32 v[236:237], v[222:223], v[62:63]
    v_pk_mul_f32 v[238:239], v[206:207], v[62:63]
    v_pk_fma_f32 v[236:237], v[206:207], v[46:47], v[236:237] neg_lo:[0,0,1] neg_hi:[0,0,1]
    v_pk_fma_f32 v[238:239], v[222:223], v[46:47], v[238:239]
    v_cvt_pk_bf16_f32 v107, v236, v237
    v_cvt_pk_bf16_f32 v115, v238, v239
    v_pk_mul_f32 v[232:233], v[224:225], v[64:65]
    v_pk_mul_f32 v[234:235], v[208:209], v[64:65]
    v_pk_fma_f32 v[232:233], v[208:209], v[48:49], v[232:233] neg_lo:[0,0,1] neg_hi:[0,0,1]
    v_pk_fma_f32 v[234:235], v[224:225], v[48:49], v[234:235]
    v_cvt_pk_bf16_f32 v108, v232, v233
    v_cvt_pk_bf16_f32 v116, v234, v235
    v_pk_mul_f32 v[236:237], v[226:227], v[66:67]
    v_pk_mul_f32 v[238:239], v[210:211], v[66:67]
    v_pk_fma_f32 v[236:237], v[210:211], v[50:51], v[236:237] neg_lo:[0,0,1] neg_hi:[0,0,1]
    v_pk_fma_f32 v[238:239], v[226:227], v[50:51], v[238:239]
    v_cvt_pk_bf16_f32 v109, v236, v237
    v_cvt_pk_bf16_f32 v117, v238, v239
    v_pk_mul_f32 v[232:233], v[228:229], v[68:69]
    v_pk_mul_f32 v[234:235], v[212:213], v[68:69]
    v_pk_fma_f32 v[232:233], v[212:213], v[52:53], v[232:233] neg_lo:[0,0,1] neg_hi:[0,0,1]
    v_pk_fma_f32 v[234:235], v[228:229], v[52:53], v[234:235]
    v_cvt_pk_bf16_f32 v110, v232, v233
    v_cvt_pk_bf16_f32 v118, v234, v235
    v_pk_mul_f32 v[236:237], v[230:231], v[70:71]
    v_pk_mul_f32 v[238:239], v[214:215], v[70:71]
    v_pk_fma_f32 v[236:237], v[214:215], v[54:55], v[236:237] neg_lo:[0,0,1] neg_hi:[0,0,1]
    v_pk_fma_f32 v[238:239], v[230:231], v[54:55], v[238:239]
    v_cvt_pk_bf16_f32 v111, v236, v237
    v_cvt_pk_bf16_f32 v119, v238, v239
    v_mfma_f32_32x32x16_bf16 v[200:215], v[24:27], v[144:147], 0
    v_cvt_pk_bf16_f32 v136, v168, v169
    v_cvt_pk_bf16_f32 v137, v170, v171
    v_mfma_f32_32x32x16_bf16 v[200:215], v[28:31], v[148:151], v[200:215]
    v_cvt_pk_bf16_f32 v140, v172, v173
    v_cvt_pk_bf16_f32 v141, v174, v175
    v_mfma_f32_32x32x16_bf16 v[200:215], v[104:107], v[16:19], v[200:215]
    v_cvt_pk_bf16_f32 v138, v176, v177
    v_cvt_pk_bf16_f32 v139, v178, v179
    v_mfma_f32_32x32x16_bf16 v[200:215], v[108:111], v[20:23], v[200:215]
    v_cvt_pk_bf16_f32 v142, v180, v181
    v_cvt_pk_bf16_f32 v143, v182, v183
    v_mfma_f32_32x32x16_bf16 v[200:215], v[112:115], v[32:35], v[200:215]
    ds_write_b128 v4, v[136:139] offset:0
    v_mfma_f32_32x32x16_bf16 v[200:215], v[116:119], v[36:39], v[200:215]
    ds_write_b128 v4, v[140:143] offset:512
    v_mfma_f32_32x32x16_bf16 v[168:183], v[120:123], v[72:75], 0
    v_mfma_f32_32x32x16_bf16 v[168:183], v[124:127], v[76:79], v[168:183]
    s_nop 8
    v_cvt_pk_bf16_f32 v144, v200, v201
    v_cvt_pk_bf16_f32 v145, v202, v203
    v_cvt_pk_bf16_f32 v148, v204, v205
    v_cvt_pk_bf16_f32 v149, v206, v207
    v_mfma_f32_32x32x16_bf16 v[184:199], v[120:123], v[80:83], 0
    v_cvt_pk_bf16_f32 v146, v208, v209
    v_cvt_pk_bf16_f32 v147, v210, v211
    v_cvt_pk_bf16_f32 v150, v212, v213
    v_cvt_pk_bf16_f32 v151, v214, v215
    v_mfma_f32_32x32x16_bf16 v[184:199], v[124:127], v[84:87], v[184:199]
    v_xor_b32 v5, 16, v4
    ds_write_b128 v5, v[144:147] offset:0
    ds_write_b128 v5, v[148:151] offset:512
    v_mfma_f32_32x32x16_bf16 v[200:215], v[128:131], v[72:75], 0
    v_mfma_f32_32x32x16_bf16 v[200:215], v[132:135], v[76:79], v[200:215]
    v_fmac_f32 v168, s52, v10
    s_nop 5
    v_mul_f32 v232, v184, v56
    v_mul_f32 v233, v185, v57
    v_mul_f32 v234, v168, v56
    v_mul_f32 v235, v169, v57
    v_fma_f32 v232, v168, v40, -v232
    v_fma_f32 v233, v169, v41, -v233
    v_mfma_f32_32x32x16_bf16 v[216:231], v[128:131], v[80:83], 0
    v_fmac_f32 v234, v184, v40
    v_fmac_f32 v235, v185, v41
    v_cvt_pk_bf16_f32 v88, v232, v233
    v_cvt_pk_bf16_f32 v96, v234, v235
    v_mul_f32 v236, v186, v58
    v_mul_f32 v237, v187, v59
    v_mul_f32 v238, v170, v58
    v_mfma_f32_32x32x16_bf16 v[216:231], v[132:135], v[84:87], v[216:231]
    v_mul_f32 v239, v171, v59
    v_fma_f32 v236, v170, v42, -v236
    v_fma_f32 v237, v171, v43, -v237
    v_fmac_f32 v238, v186, v42
    v_fmac_f32 v239, v187, v43
    v_cvt_pk_bf16_f32 v89, v236, v237
    v_cvt_pk_bf16_f32 v97, v238, v239
    v_pk_mul_f32 v[232:233], v[188:189], v[60:61]
    v_pk_mul_f32 v[234:235], v[172:173], v[60:61]
    v_pk_fma_f32 v[232:233], v[172:173], v[44:45], v[232:233] neg_lo:[0,0,1] neg_hi:[0,0,1]
    v_pk_fma_f32 v[234:235], v[188:189], v[44:45], v[234:235]
    v_cvt_pk_bf16_f32 v90, v232, v233
    v_cvt_pk_bf16_f32 v98, v234, v235
    v_pk_mul_f32 v[236:237], v[190:191], v[62:63]
    v_pk_mul_f32 v[238:239], v[174:175], v[62:63]
    v_pk_fma_f32 v[236:237], v[174:175], v[46:47], v[236:237] neg_lo:[0,0,1] neg_hi:[0,0,1]
    v_pk_fma_f32 v[238:239], v[190:191], v[46:47], v[238:239]
    v_cvt_pk_bf16_f32 v91, v236, v237
    v_cvt_pk_bf16_f32 v99, v238, v239
    v_pk_mul_f32 v[232:233], v[192:193], v[64:65]
    v_pk_mul_f32 v[234:235], v[176:177], v[64:65]
    v_pk_fma_f32 v[232:233], v[176:177], v[48:49], v[232:233] neg_lo:[0,0,1] neg_hi:[0,0,1]
    v_pk_fma_f32 v[234:235], v[192:193], v[48:49], v[234:235]
    v_cvt_pk_bf16_f32 v92, v232, v233
    v_cvt_pk_bf16_f32 v100, v234, v235
    v_pk_mul_f32 v[236:237], v[194:195], v[66:67]
    v_pk_mul_f32 v[238:239], v[178:179], v[66:67]
    v_pk_fma_f32 v[236:237], v[178:179], v[50:51], v[236:237] neg_lo:[0,0,1] neg_hi:[0,0,1]
    v_pk_fma_f32 v[238:239], v[194:195], v[50:51], v[238:239]
    v_cvt_pk_bf16_f32 v93, v236, v237
    v_cvt_pk_bf16_f32 v101, v238, v239
    v_pk_mul_f32 v[232:233], v[196:197], v[68:69]
    v_pk_mul_f32 v[234:235], v[180:181], v[68:69]
    v_pk_fma_f32 v[232:233], v[180:181], v[52:53], v[232:233] neg_lo:[0,0,1] neg_hi:[0,0,1]
    v_pk_fma_f32 v[234:235], v[196:197], v[52:53], v[234:235]
    v_cvt_pk_bf16_f32 v94, v232, v233
    v_cvt_pk_bf16_f32 v102, v234, v235
    v_pk_mul_f32 v[236:237], v[198:199], v[70:71]
    v_pk_mul_f32 v[238:239], v[182:183], v[70:71]
    v_pk_fma_f32 v[236:237], v[182:183], v[54:55], v[236:237] neg_lo:[0,0,1] neg_hi:[0,0,1]
    v_pk_fma_f32 v[238:239], v[198:199], v[54:55], v[238:239]
    v_cvt_pk_bf16_f32 v95, v236, v237
    v_cvt_pk_bf16_f32 v103, v238, v239
    v_mfma_f32_32x32x16_bf16 v[168:183], v[24:27], v[152:155], 0
    v_fmac_f32 v200, s54, v10
    v_mul_f32 v232, v216, v56
    v_mul_f32 v233, v217, v57
    v_mul_f32 v234, v200, v56
    v_mul_f32 v235, v201, v57
    v_fma_f32 v232, v200, v40, -v232
    v_mfma_f32_32x32x16_bf16 v[168:183], v[28:31], v[156:159], v[168:183]
    v_fma_f32 v233, v201, v41, -v233
    v_fmac_f32 v234, v216, v40
    v_fmac_f32 v235, v217, v41
    v_cvt_pk_bf16_f32 v120, v232, v233
    v_cvt_pk_bf16_f32 v128, v234, v235
    v_mfma_f32_32x32x16_bf16 v[168:183], v[88:91], v[16:19], v[168:183]
    v_mul_f32 v236, v218, v58
    v_mul_f32 v237, v219, v59
    v_mul_f32 v238, v202, v58
    v_mul_f32 v239, v203, v59
    v_fma_f32 v236, v202, v42, -v236
    v_mfma_f32_32x32x16_bf16 v[168:183], v[92:95], v[20:23], v[168:183]
    v_fma_f32 v237, v203, v43, -v237
    v_fmac_f32 v238, v218, v42
    v_fmac_f32 v239, v219, v43
    v_cvt_pk_bf16_f32 v121, v236, v237
    v_cvt_pk_bf16_f32 v129, v238, v239
    v_mfma_f32_32x32x16_bf16 v[168:183], v[96:99], v[32:35], v[168:183]
    v_mul_f32 v232, v220, v60
    v_mul_f32 v233, v221, v61
    v_mul_f32 v234, v204, v60
    v_mul_f32 v235, v205, v61
    v_fma_f32 v232, v204, v44, -v232
    v_mfma_f32_32x32x16_bf16 v[168:183], v[100:103], v[36:39], v[168:183]
    v_fma_f32 v233, v205, v45, -v233
    v_fmac_f32 v234, v220, v44
    v_fmac_f32 v235, v221, v45
    v_cvt_pk_bf16_f32 v122, v232, v233
    v_cvt_pk_bf16_f32 v130, v234, v235
    v_pk_mul_f32 v[236:237], v[222:223], v[62:63]
    v_pk_mul_f32 v[238:239], v[206:207], v[62:63]
    v_pk_fma_f32 v[236:237], v[206:207], v[46:47], v[236:237] neg_lo:[0,0,1] neg_hi:[0,0,1]
    v_pk_fma_f32 v[238:239], v[222:223], v[46:47], v[238:239]
    v_cvt_pk_bf16_f32 v123, v236, v237
    v_cvt_pk_bf16_f32 v131, v238, v239
    v_pk_mul_f32 v[232:233], v[224:225], v[64:65]
    v_pk_mul_f32 v[234:235], v[208:209], v[64:65]
    v_pk_fma_f32 v[232:233], v[208:209], v[48:49], v[232:233] neg_lo:[0,0,1] neg_hi:[0,0,1]
    v_pk_fma_f32 v[234:235], v[224:225], v[48:49], v[234:235]
    v_cvt_pk_bf16_f32 v124, v232, v233
    v_cvt_pk_bf16_f32 v132, v234, v235
    v_pk_mul_f32 v[236:237], v[226:227], v[66:67]
    v_pk_mul_f32 v[238:239], v[210:211], v[66:67]
    v_pk_fma_f32 v[236:237], v[210:211], v[50:51], v[236:237] neg_lo:[0,0,1] neg_hi:[0,0,1]
    v_pk_fma_f32 v[238:239], v[226:227], v[50:51], v[238:239]
    v_cvt_pk_bf16_f32 v125, v236, v237
    v_cvt_pk_bf16_f32 v133, v238, v239
    v_pk_mul_f32 v[232:233], v[228:229], v[68:69]
    v_pk_mul_f32 v[234:235], v[212:213], v[68:69]
    v_pk_fma_f32 v[232:233], v[212:213], v[52:53], v[232:233] neg_lo:[0,0,1] neg_hi:[0,0,1]
    v_pk_fma_f32 v[234:235], v[228:229], v[52:53], v[234:235]
    v_cvt_pk_bf16_f32 v126, v232, v233
    v_cvt_pk_bf16_f32 v134, v234, v235
    v_pk_mul_f32 v[236:237], v[230:231], v[70:71]
    v_pk_mul_f32 v[238:239], v[214:215], v[70:71]
    v_pk_fma_f32 v[236:237], v[214:215], v[54:55], v[236:237] neg_lo:[0,0,1] neg_hi:[0,0,1]
    v_pk_fma_f32 v[238:239], v[230:231], v[54:55], v[238:239]
    v_cvt_pk_bf16_f32 v127, v236, v237
    v_cvt_pk_bf16_f32 v135, v238, v239
    v_mfma_f32_32x32x16_bf16 v[200:215], v[24:27], v[160:163], 0
    v_cvt_pk_bf16_f32 v152, v168, v169
    v_cvt_pk_bf16_f32 v153, v170, v171
    v_mfma_f32_32x32x16_bf16 v[200:215], v[28:31], v[164:167], v[200:215]
    v_cvt_pk_bf16_f32 v156, v172, v173
    v_cvt_pk_bf16_f32 v157, v174, v175
    v_mfma_f32_32x32x16_bf16 v[200:215], v[120:123], v[16:19], v[200:215]
    v_cvt_pk_bf16_f32 v154, v176, v177
    v_cvt_pk_bf16_f32 v155, v178, v179
    v_mfma_f32_32x32x16_bf16 v[200:215], v[124:127], v[20:23], v[200:215]
    v_cvt_pk_bf16_f32 v158, v180, v181
    v_cvt_pk_bf16_f32 v159, v182, v183
    v_mfma_f32_32x32x16_bf16 v[200:215], v[128:131], v[32:35], v[200:215]
    v_xor_b32 v5, 32, v4
    ds_write_b128 v5, v[152:155] offset:0
    v_mfma_f32_32x32x16_bf16 v[200:215], v[132:135], v[36:39], v[200:215]
    ds_write_b128 v5, v[156:159] offset:512
    s_nop 10
    v_cvt_pk_bf16_f32 v160, v200, v201
    v_cvt_pk_bf16_f32 v161, v202, v203
    v_cvt_pk_bf16_f32 v164, v204, v205
    v_cvt_pk_bf16_f32 v165, v206, v207
    v_cvt_pk_bf16_f32 v162, v208, v209
    v_cvt_pk_bf16_f32 v163, v210, v211
    v_cvt_pk_bf16_f32 v166, v212, v213
    v_cvt_pk_bf16_f32 v167, v214, v215
    v_xor_b32 v5, 48, v4
    ds_write_b128 v5, v[160:163] offset:0
    ds_write_b128 v5, v[164:167] offset:512
    s_lshr_b32 s39, s16, 2
    s_lshl_b32 s44, s39, 15
    s_add_u32 s41, s46, s44
    s_add_u32 s41, s41, 25165824
    v_lshlrev_b32 v248, 2, v1
    v_add_u32 v248, 163776, v248
    v_mov_b32 v249, 7
    s_waitcnt lgkmcnt(0)
    ds_write_b32 v248, v249
    v_and_b32 v250, 3, v2
    v_and_b32 v251, 4, v1
    v_or_b32 v250, v250, v251
    v_lshlrev_b32 v250, 2, v250
    v_add_u32 v250, 163776, v250
    s_mov_b32 s83, 0x400000
L_f3_sp:
    ds_read_b32 v251, v250
    s_sub_u32 s83, s83, 1
    s_cmp_eq_u32 s83, 0
    s_cbranch_scc1 L_f3_spx
    s_waitcnt lgkmcnt(0)
    v_cmp_gt_u32 vcc, 7, v251
    s_nop 4
    s_cbranch_vccnz L_f3_sp
L_f3_spx:
    ds_read_b128 v[104:107], v6 offset:0
    ds_read_b128 v[108:111], v11 offset:4096
    ds_read_b128 v[112:115], v6 offset:8192
    ds_read_b128 v[116:119], v11 offset:12288
    ds_read_b128 v[120:123], v6 offset:16384
    ds_read_b128 v[124:127], v11 offset:20480
    ds_read_b128 v[128:131], v6 offset:24576
    ds_read_b128 v[132:135], v11 offset:28672
    s_waitcnt lgkmcnt(7)
    s_add_u32 s44, s41, 0
    buffer_store_dwordx4 v[104:107], v7, s[28:31], s44 offen sc1
    s_waitcnt lgkmcnt(6)
    s_add_u32 s44, s41, 4096
    buffer_store_dwordx4 v[108:111], v7, s[28:31], s44 offen sc1
    s_waitcnt lgkmcnt(5)
    s_add_u32 s44, s41, 8192
    buffer_store_dwordx4 v[112:115], v7, s[28:31], s44 offen sc1
    s_waitcnt lgkmcnt(4)
    s_add_u32 s44, s41, 12288
    buffer_store_dwordx4 v[116:119], v7, s[28:31], s44 offen sc1
    s_waitcnt lgkmcnt(3)
    s_add_u32 s44, s41, 16384
    buffer_store_dwordx4 v[120:123], v7, s[28:31], s44 offen sc1
    s_waitcnt lgkmcnt(2)
    s_add_u32 s44, s41, 20480
    buffer_store_dwordx4 v[124:127], v7, s[28:31], s44 offen sc1
    s_waitcnt lgkmcnt(1)
    s_add_u32 s44, s41, 24576
    buffer_store_dwordx4 v[128:131], v7, s[28:31], s44 offen sc1
    s_waitcnt lgkmcnt(0)
    s_add_u32 s44, s41, 28672
    buffer_store_dwordx4 v[132:135], v7, s[28:31], s44 offen sc1
    s_waitcnt vmcnt(0)
    s_barrier
    s_cmp_lg_u32 s16, 0
    s_cbranch_scc1 L_f3_sig
    s_lshl_b32 s41, s2, 7
    s_add_u32 s41, s41, 15073280
    v_mov_b32 v8, s74
    v_mov_b32 v9, 0
    s_mov_b64 exec, 1
    buffer_store_dword v8, v9, s[28:31], s41 offen sc1
    s_mov_b64 exec, -1
L_f3_sig:
    s_endpgm
L_code_end:
.section .rodata,"a"
.p2align 6
.amdhsa_kernel parallel_sum__spectral_gfnet__dense_activation_mish__prompt_kernel
  .amdhsa_next_free_vgpr 256
  .amdhsa_next_free_sgpr 102
  .amdhsa_accum_offset 256
  .amdhsa_group_segment_fixed_size 0
  .amdhsa_kernarg_size 80
  .amdhsa_user_sgpr_count 2
  .amdhsa_user_sgpr_kernarg_segment_ptr 1
  .amdhsa_system_sgpr_workgroup_id_x 1
  .amdhsa_float_denorm_mode_32 3
  .amdhsa_float_denorm_mode_16_64 3
.end_amdhsa_kernel
```
